```python
import torch

def _softmax(x, axis=-1):
    return torch.softmax(x, dim=axis)

def _gelu(x):
    return torch.nn.functional.gelu(x, approximate='tanh')

def _silu(x):
    return torch.nn.functional.silu(x)

def _sigmoid(x):
    return torch.sigmoid(x)

def _layernorm(x, axis=-1, eps=1e-05):
    m = x.mean(dim=axis, keepdim=True)
    v = x.var(dim=axis, keepdim=True, unbiased=False)
    return (x - m) / torch.sqrt(v + eps)

def _scatter_add(tgt, idx, src, axis=0):
    return tgt.clone().index_add_(axis, idx, src)

def _segment_sum(src, seg, n):
    out = torch.zeros((n,) + src.shape[1:], dtype=src.dtype)
    return out.index_add_(0, seg, src)

def _pad(x, pw):
    flat = tuple((v for pair in reversed(pw) for v in pair))
    return torch.nn.functional.pad(x, flat)
kernel_name = 'adaLN_cond__spectral_gfnet__glu_gated_bilinear__prompt'

def setup_inputs():

    _w = lambda a: (lambda t: t.to(torch.bfloat16) if t.is_floating_point() else t)(torch.as_tensor(a))

    def _A_setup():
        B, S, D = (1, 2048, 576)
        Df = D // 2 + 1
        return {'x': _w((lambda *s: torch.randn(*s, dtype=torch.bfloat16) * 0.05)(B, S, D)), 'w_r': _w((lambda *s: torch.randn(*s, dtype=torch.bfloat16) * 3.2)(S, Df) * 0.02), 'w_i': _w((lambda *s: torch.randn(*s, dtype=torch.bfloat16) * 3.2)(S, Df) * 0.02)}
    _A_in = _A_setup()

    def _B_setup():
        B, S, D, F = (1, 2048, 576, 4608)
        return {'x': _w((lambda *s: torch.randn(*s, dtype=torch.bfloat16) * 0.05)(B, S, D)), 'w_gate': _w((lambda *s: torch.randn(*s, dtype=torch.bfloat16) * 0.4)(D, F) * D ** (-0.5)), 'w_up': _w((lambda *s: torch.randn(*s, dtype=torch.bfloat16) * 0.4)(D, F) * D ** (-0.5)), 'w_down': _w((lambda *s: torch.randn(*s, dtype=torch.bfloat16) * 0.4)(F, D) * F ** (-0.5))}
    _B_in = _B_setup()
    return {'A_x': _A_in['x'], 'A_w_r': _A_in['w_r'], 'A_w_i': _A_in['w_i'], 'B_x': _B_in['x'], 'B_w_gate': _B_in['w_gate'], 'B_w_up': _B_in['w_up'], 'B_w_down': _B_in['w_down'], 'c': _w((lambda *s: torch.randn(*s, dtype=torch.bfloat16) * 0.1)(1, 576) * 8.0), 'w_mod': _w((lambda *s: torch.randn(*s, dtype=torch.bfloat16) * 0.1)(576, 6 * 576) * 576 ** (-0.5) * 8.0)}

def reference(A_x, A_w_r, A_w_i, B_x, B_w_gate, B_w_up, B_w_down, c, w_mod):

    def _A_ref(x, w_r, w_i):
        B, S, D = x.shape
        X = (lambda x, axes=(-2, -1): torch.fft.rfft2(x.float(), dim=axes))(x, axes=(-2, -1))
        W = w_r + 1j * w_i
        X = X * W
        y = (lambda x, s, axes=(-2, -1): torch.fft.irfft2(x, s=s, dim=axes).to(torch.bfloat16))(X, (S, D), axes=(-2, -1))
        return y

    def _B_ref(x, w_gate, w_up, w_down):
        g = torch.einsum('bsd,df->bsf', x, w_gate)
        u = torch.einsum('bsd,df->bsf', x, w_up)
        h = g * u
        return torch.einsum('bsf,fd->bsd', h, w_down)
    x = A_x
    mod = (_silu(c) @ w_mod).reshape(c.shape[0], 6, 1, -1)
    sa, ca, ga, sb, cb, gb = (mod[:, 0].clone(), mod[:, 1].clone(), mod[:, 2].clone(), mod[:, 3].clone(), mod[:, 4].clone(), mod[:, 5].clone())
    h = _layernorm(x, axis=-1) * (1 + ca) + sa
    x = x + ga * _A_ref(h, A_w_r, A_w_i)
    h = _layernorm(x, axis=-1) * (1 + cb) + sb
    x = x + gb * _B_ref(h, B_w_gate, B_w_up, B_w_down)
    return x
```

```asm
; @launch kernel=k0_prep_kernel grid=(252,1,1) block=(512,1,1) lds=20480
; @launch kernel=k1_rdft_kernel grid=(256,1,1) block=(512,1,1) lds=15520
; @launch kernel=k2_sfft_kernel grid=(291,1,1) block=(256,1,1) lds=8192
; @launch kernel=k3_irdft_kernel grid=(256,1,1) block=(512,1,1) lds=29088
; @launch kernel=k4_up_kernel grid=(256,1,1) block=(256,1,1) lds=159744
; @launch kernel=k5_down_kernel grid=(256,1,1) block=(512,1,1) lds=139264
; @launch kernel=k6_fin_kernel grid=(576,1,1) block=(256,1,1) lds=0
.amdgcn_target "amdgcn-amd-amdhsa--gfx950"
.text
.globl k0_prep_kernel
.p2align 8
.type k0_prep_kernel,@function
k0_prep_kernel:
  s_load_dwordx4 s[36:39], s[0:1], 56
  s_load_dwordx4 s[40:43], s[0:1], 80
  s_load_dwordx4 s[8:11], s[0:1], 8
  s_load_dwordx2 s[6:7], s[0:1], 0
  s_sub_u32 s84, s2, 236
  s_cmp_ge_u32 s84, 16
  s_cbranch_scc1 k0_prep_kernel_cpf4
  s_getpc_b64 s[84:85]
k0_prep_kernel_here5:
  s_add_u32 s84, s84, k0_prep_kernel-k0_prep_kernel_here5
  s_addc_u32 s85, s85, -1
  s_mov_b32 s86, k6_fin_kernel_eoc-k0_prep_kernel
  s_mov_b32 s87, 0x20000
  v_lshlrev_b32 v72, 6, v0
  buffer_load_dword v73, v72, s[84:87], 0 offen
  v_add_u32 v72, 32768, v72
  buffer_load_dword v73, v72, s[84:87], 0 offen
k0_prep_kernel_cpf4:
  v_lshrrev_b32 v1, 6, v0
  s_nop 0
  v_readfirstlane_b32 s3, v1
  s_cmp_ge_u32 s2, 108
  s_cbranch_scc1 k0_prep_kernel_t3
  s_and_b32 s34, s2, 1
  s_lshr_b32 s35, s2, 1
  v_and_b32 v1, 7, v0
  v_lshrrev_b32 v2, 3, v0
  v_mul_u32_u24 v3, 6912, v2
  v_lshl_add_u32 v3, v1, 4, v3
  v_lshlrev_b32 v4, 1, v2
  s_mul_i32 s28, s34, 1990656
  s_lshl_b32 s29, s35, 7
  s_add_u32 s28, s28, s29
  s_mul_i32 s33, s34, 576
  v_mov_b32 v24, 0
  v_mov_b32 v25, 0
  v_mov_b32 v26, 0
  v_mov_b32 v27, 0
  v_mov_b32 v52, 0
  s_waitcnt lgkmcnt(0)
  s_mov_b32 s16, s38
  s_mov_b32 s17, s39
  s_mov_b32 s18, 0x3cc000
  s_mov_b32 s19, 0x20000
  s_mov_b32 s20, s36
  s_mov_b32 s21, s37
  s_mov_b32 s22, 0x480
  s_mov_b32 s23, 0x20000
  s_cmp_ge_u32 s3, 4
  s_cbranch_scc1 k0_prep_kernel_h6
  s_add_u32 s29, s28, 1769472
  buffer_load_ushort v52, v4, s[20:23], s33 offen offset:512
  buffer_load_dwordx4 v[24:27], v3, s[16:19], s29 offen nt
k0_prep_kernel_h6:
  buffer_load_ushort v48, v4, s[20:23], s33 offen offset:0
  buffer_load_ushort v49, v4, s[20:23], s33 offen offset:128
  buffer_load_ushort v50, v4, s[20:23], s33 offen offset:256
  buffer_load_ushort v51, v4, s[20:23], s33 offen offset:384
  buffer_load_dwordx4 v[8:11], v3, s[16:19], s28 offen nt
  s_add_u32 s28, s28, 442368
  buffer_load_dwordx4 v[12:15], v3, s[16:19], s28 offen nt
  s_add_u32 s28, s28, 442368
  buffer_load_dwordx4 v[16:19], v3, s[16:19], s28 offen nt
  s_add_u32 s28, s28, 442368
  buffer_load_dwordx4 v[20:23], v3, s[16:19], s28 offen nt
  s_mov_b32 s24, s42
  s_mov_b32 s25, s43
  s_mov_b32 s26, 0x10000
  s_mov_b32 s27, 0x20000
  s_mul_i32 s29, s35, 7282
  s_lshr_b32 s29, s29, 16
  s_mul_i32 s30, s29, 9
  s_sub_u32 s30, s35, s30
  s_lshl_b32 s30, s30, 5
  s_cmp_lt_u32 s29, 2
  s_cselect_b32 s31, 4, 5
  s_cselect_b32 s33, 0, 4608
  s_lshl_b32 s32, s29, 2
  s_lshr_b32 s32, 0x312001, s32
  s_and_b32 s32, s32, 15
  s_lshl_b32 s32, s32, 3
  s_add_u32 s32, s32, s33
  s_mul_i32 s33, s34, 13824
  s_add_u32 s32, s32, s33
  v_lshrrev_b32 v69, 1, v0
  v_add_u32 v69, s30, v69
  v_lshlrev_b32 v69, s31, v69
  v_and_b32 v68, 1, v0
  v_lshl_add_u32 v69, v68, 2, v69
  v_lshrrev_b32 v30, 4, v0
  v_lshlrev_b32 v30, 8, v30
  v_lshl_add_u32 v30, v1, 5, v30
  v_lshlrev_b32 v31, 2, v0
  s_waitcnt vmcnt(4)
  v_lshlrev_b32 v48, 16, v48
  v_lshlrev_b32 v49, 16, v49
  v_lshlrev_b32 v50, 16, v50
  v_lshlrev_b32 v51, 16, v51
  v_lshlrev_b32 v52, 16, v52
  v_mul_f32 v40, 0xbfb8aa3b, v48
  v_mul_f32 v41, 0xbfb8aa3b, v49
  v_mul_f32 v42, 0xbfb8aa3b, v50
  v_mul_f32 v43, 0xbfb8aa3b, v51
  v_mul_f32 v44, 0xbfb8aa3b, v52
  v_exp_f32 v40, v40
  v_exp_f32 v41, v41
  v_exp_f32 v42, v42
  v_exp_f32 v43, v43
  v_exp_f32 v44, v44
  v_add_f32 v40, 1.0, v40
  v_add_f32 v41, 1.0, v41
  v_add_f32 v42, 1.0, v42
  v_add_f32 v43, 1.0, v43
  v_add_f32 v44, 1.0, v44
  v_rcp_f32 v40, v40
  v_rcp_f32 v41, v41
  v_rcp_f32 v42, v42
  v_rcp_f32 v43, v43
  v_rcp_f32 v44, v44
  v_mul_f32 v48, v48, v40
  v_mul_f32 v49, v49, v41
  v_mul_f32 v50, v50, v42
  v_mul_f32 v51, v51, v43
  v_mul_f32 v52, v52, v44
  v_cvt_pk_bf16_f32 v48, v48, v48
  v_cvt_pk_bf16_f32 v49, v49, v49
  v_cvt_pk_bf16_f32 v50, v50, v50
  v_cvt_pk_bf16_f32 v51, v51, v51
  v_cvt_pk_bf16_f32 v52, v52, v52
  v_lshlrev_b32 v48, 16, v48
  v_lshlrev_b32 v49, 16, v49
  v_lshlrev_b32 v50, 16, v50
  v_lshlrev_b32 v51, 16, v51
  v_lshlrev_b32 v52, 16, v52
  v_lshlrev_b32 v5, 16, v24
  v_and_b32 v6, 0xffff0000, v24
  v_mul_f32 v60, v5, v52
  v_mul_f32 v61, v6, v52
  v_lshlrev_b32 v5, 16, v25
  v_and_b32 v6, 0xffff0000, v25
  v_mul_f32 v62, v5, v52
  v_mul_f32 v63, v6, v52
  v_lshlrev_b32 v5, 16, v26
  v_and_b32 v6, 0xffff0000, v26
  v_mul_f32 v64, v5, v52
  v_mul_f32 v65, v6, v52
  v_lshlrev_b32 v5, 16, v27
  v_and_b32 v6, 0xffff0000, v27
  v_mul_f32 v66, v5, v52
  v_mul_f32 v67, v6, v52
  s_waitcnt vmcnt(3)
  v_lshlrev_b32 v5, 16, v8
  v_and_b32 v6, 0xffff0000, v8
  v_fmac_f32 v60, v5, v48
  v_fmac_f32 v61, v6, v48
  v_lshlrev_b32 v5, 16, v9
  v_and_b32 v6, 0xffff0000, v9
  v_fmac_f32 v62, v5, v48
  v_fmac_f32 v63, v6, v48
  v_lshlrev_b32 v5, 16, v10
  v_and_b32 v6, 0xffff0000, v10
  v_fmac_f32 v64, v5, v48
  v_fmac_f32 v65, v6, v48
  v_lshlrev_b32 v5, 16, v11
  v_and_b32 v6, 0xffff0000, v11
  v_fmac_f32 v66, v5, v48
  v_fmac_f32 v67, v6, v48
  s_waitcnt vmcnt(2)
  v_lshlrev_b32 v5, 16, v12
  v_and_b32 v6, 0xffff0000, v12
  v_fmac_f32 v60, v5, v49
  v_fmac_f32 v61, v6, v49
  v_lshlrev_b32 v5, 16, v13
  v_and_b32 v6, 0xffff0000, v13
  v_fmac_f32 v62, v5, v49
  v_fmac_f32 v63, v6, v49
  v_lshlrev_b32 v5, 16, v14
  v_and_b32 v6, 0xffff0000, v14
  v_fmac_f32 v64, v5, v49
  v_fmac_f32 v65, v6, v49
  v_lshlrev_b32 v5, 16, v15
  v_and_b32 v6, 0xffff0000, v15
  v_fmac_f32 v66, v5, v49
  v_fmac_f32 v67, v6, v49
  s_waitcnt vmcnt(1)
  v_lshlrev_b32 v5, 16, v16
  v_and_b32 v6, 0xffff0000, v16
  v_fmac_f32 v60, v5, v50
  v_fmac_f32 v61, v6, v50
  v_lshlrev_b32 v5, 16, v17
  v_and_b32 v6, 0xffff0000, v17
  v_fmac_f32 v62, v5, v50
  v_fmac_f32 v63, v6, v50
  v_lshlrev_b32 v5, 16, v18
  v_and_b32 v6, 0xffff0000, v18
  v_fmac_f32 v64, v5, v50
  v_fmac_f32 v65, v6, v50
  v_lshlrev_b32 v5, 16, v19
  v_and_b32 v6, 0xffff0000, v19
  v_fmac_f32 v66, v5, v50
  v_fmac_f32 v67, v6, v50
  s_waitcnt vmcnt(0)
  v_lshlrev_b32 v5, 16, v20
  v_and_b32 v6, 0xffff0000, v20
  v_fmac_f32 v60, v5, v51
  v_fmac_f32 v61, v6, v51
  v_lshlrev_b32 v5, 16, v21
  v_and_b32 v6, 0xffff0000, v21
  v_fmac_f32 v62, v5, v51
  v_fmac_f32 v63, v6, v51
  v_lshlrev_b32 v5, 16, v22
  v_and_b32 v6, 0xffff0000, v22
  v_fmac_f32 v64, v5, v51
  v_fmac_f32 v65, v6, v51
  v_lshlrev_b32 v5, 16, v23
  v_and_b32 v6, 0xffff0000, v23
  v_fmac_f32 v66, v5, v51
  v_fmac_f32 v67, v6, v51
  v_add_f32_dpp v60, v60, v60 row_ror:8 row_mask:0xf bank_mask:0xf
  v_add_f32_dpp v61, v61, v61 row_ror:8 row_mask:0xf bank_mask:0xf
  v_add_f32_dpp v62, v62, v62 row_ror:8 row_mask:0xf bank_mask:0xf
  v_add_f32_dpp v63, v63, v63 row_ror:8 row_mask:0xf bank_mask:0xf
  v_add_f32_dpp v64, v64, v64 row_ror:8 row_mask:0xf bank_mask:0xf
  v_add_f32_dpp v65, v65, v65 row_ror:8 row_mask:0xf bank_mask:0xf
  v_add_f32_dpp v66, v66, v66 row_ror:8 row_mask:0xf bank_mask:0xf
  v_add_f32_dpp v67, v67, v67 row_ror:8 row_mask:0xf bank_mask:0xf
  ds_write_b128 v30, v[60:63]
  ds_write_b128 v30, v[64:67] offset:16
  s_waitcnt lgkmcnt(0)
  s_barrier
  s_cmp_lg_u32 s3, 0
  s_cbranch_scc1 k0_prep_kernel_end1
  ds_read2st64_b32 v[32:33], v31 offset0:0 offset1:1
  ds_read2st64_b32 v[34:35], v31 offset0:2 offset1:3
  ds_read2st64_b32 v[36:37], v31 offset0:4 offset1:5
  ds_read2st64_b32 v[38:39], v31 offset0:6 offset1:7
  ds_read2st64_b32 v[40:41], v31 offset0:8 offset1:9
  ds_read2st64_b32 v[42:43], v31 offset0:10 offset1:11
  ds_read2st64_b32 v[44:45], v31 offset0:12 offset1:13
  ds_read2st64_b32 v[46:47], v31 offset0:14 offset1:15
  ds_read2st64_b32 v[48:49], v31 offset0:16 offset1:17
  ds_read2st64_b32 v[50:51], v31 offset0:18 offset1:19
  ds_read2st64_b32 v[52:53], v31 offset0:20 offset1:21
  ds_read2st64_b32 v[54:55], v31 offset0:22 offset1:23
  ds_read2st64_b32 v[56:57], v31 offset0:24 offset1:25
  ds_read2st64_b32 v[58:59], v31 offset0:26 offset1:27
  ds_read2st64_b32 v[60:61], v31 offset0:28 offset1:29
  s_waitcnt lgkmcnt(8)
  ds_read2st64_b32 v[62:63], v31 offset0:30 offset1:31
  s_waitcnt lgkmcnt(0)
  v_add_f32 v32, v32, v48
  v_add_f32 v33, v33, v49
  v_add_f32 v34, v34, v50
  v_add_f32 v35, v35, v51
  v_add_f32 v36, v36, v52
  v_add_f32 v37, v37, v53
  v_add_f32 v38, v38, v54
  v_add_f32 v39, v39, v55
  v_add_f32 v40, v40, v56
  v_add_f32 v41, v41, v57
  v_add_f32 v42, v42, v58
  v_add_f32 v43, v43, v59
  v_add_f32 v44, v44, v60
  v_add_f32 v45, v45, v61
  v_add_f32 v46, v46, v62
  v_add_f32 v47, v47, v63
  v_add_f32 v32, v32, v40
  v_add_f32 v33, v33, v41
  v_add_f32 v34, v34, v42
  v_add_f32 v35, v35, v43
  v_add_f32 v36, v36, v44
  v_add_f32 v37, v37, v45
  v_add_f32 v38, v38, v46
  v_add_f32 v39, v39, v47
  v_add_f32 v32, v32, v36
  v_add_f32 v33, v33, v37
  v_add_f32 v34, v34, v38
  v_add_f32 v35, v35, v39
  v_add_f32 v32, v32, v34
  v_add_f32 v33, v33, v35
  v_add_f32 v32, v32, v33
  buffer_store_dword v32, v69, s[24:27], s32 offen sc0 sc1
  s_endpgm
k0_prep_kernel_t3:
  s_sub_u32 s28, s2, 108
  s_cmp_ge_u32 s28, 128
  s_cbranch_scc1 k0_prep_kernel_end1
  s_and_b32 s29, s28, 7
  s_lshl_b32 s29, s29, 1
  s_bfe_u32 s30, s28, 0x10003
  s_add_u32 s29, s29, s30
  s_andn2_b32 s28, s28, 15
  s_add_u32 s28, s28, s29
  v_and_b32 v1, 255, v0
  s_mul_i32 s29, s28, 9248
  v_lshl_add_u32 v1, v1, 4, s29
  s_lshr_b32 s30, s3, 2
  s_mul_i32 s31, s30, 10240
  s_and_b32 s32, s3, 3
  s_lshl_b32 s32, s32, 10
  s_add_u32 s31, s31, s32
  s_mov_b32 m0, s31
  v_lshrrev_b32 v2, 2, v0
  v_and_b32 v3, 3, v0
  v_mul_u32_u24 v4, 2312, v3
  v_lshl_add_u32 v4, v2, 1, v4
  v_lshlrev_b32 v5, 13, v2
  v_lshl_add_u32 v5, v3, 4, v5
  s_lshl_b32 s33, s28, 6
  s_waitcnt lgkmcnt(0)
  s_cmp_eq_u32 s30, 1
  s_cselect_b32 s16, s10, s8
  s_cselect_b32 s17, s11, s9
  s_add_u32 s18, s29, 9248
  s_mov_b32 s19, 0x20000
  buffer_load_dwordx4 v1, s[16:19], 0 offen nt lds
  v_add_u32 v1, 4096, v1
  s_add_u32 m0, s31, 4096
  s_nop 0
  buffer_load_dwordx4 v1, s[16:19], 0 offen nt lds
  s_cmp_ge_u32 s32, 2048
  s_cbranch_scc1 k0_prep_kernel_s7
  v_add_u32 v1, 4096, v1
  s_add_u32 m0, s31, 8192
  s_nop 0
  buffer_load_dwordx4 v1, s[16:19], 0 offen nt lds
k0_prep_kernel_s7:
  s_mov_b32 s12, s6
  s_mov_b32 s13, s7
  s_mov_b32 s14, 0x240000
  s_mov_b32 s15, 0x20000
  s_sub_u32 s34, s2, 108
  s_andn2_b32 s34, s34, 7
  s_and_b32 s35, s3, 3
  s_lshl_b32 s35, s35, 1
  s_add_u32 s34, s34, s35
  s_cmp_ge_u32 s3, 4
  s_cselect_b32 s14, s14, 0
  s_lshl_b32 s34, s34, 3
  s_and_b32 s35, s2, 7
  s_add_u32 s34, s34, s35
  s_mul_i32 s34, s34, 2304
  v_and_b32 v6, 31, v0
  v_lshl_add_u32 v6, v6, 7, s34
  v_and_b32 v7, 32, v0
  v_mul_u32_u24 v7, 576, v7
  v_add_u32 v6, v6, v7
  s_mov_b32 exec_lo, 0x3ffff
  s_mov_b32 exec_hi, 0x3ffff
  buffer_load_dword v6, v6, s[12:15], 0 offen
  s_mov_b64 exec, -1
  s_add_u32 s24, s42, 0x100000
  s_addc_u32 s25, s43, 0
  s_mov_b32 s26, 0x242000
  s_mov_b32 s27, 0x20000
  s_waitcnt vmcnt(1)
  s_barrier
  ds_read_u16 v8, v4 offset:0
  ds_read_u16 v9, v4 offset:578
  ds_read_u16 v10, v4 offset:1156
  ds_read_u16 v11, v4 offset:1734
  ds_read_u16 v24, v4 offset:10240
  ds_read_u16 v25, v4 offset:10818
  ds_read_u16 v26, v4 offset:11396
  ds_read_u16 v27, v4 offset:11974
  s_waitcnt lgkmcnt(7)
  ds_read_u16 v12, v4 offset:256
  ds_read_u16 v13, v4 offset:834
  ds_read_u16 v14, v4 offset:1412
  ds_read_u16 v15, v4 offset:1990
  ds_read_u16 v28, v4 offset:10496
  ds_read_u16 v29, v4 offset:11074
  ds_read_u16 v30, v4 offset:11652
  ds_read_u16 v31, v4 offset:12230
  s_waitcnt lgkmcnt(8)
  v_lshl_or_b32 v8, v24, 16, v8
  v_lshl_or_b32 v9, v25, 16, v9
  v_lshl_or_b32 v10, v26, 16, v10
  v_lshl_or_b32 v11, v27, 16, v11
  buffer_store_dwordx4 v[8:11], v5, s[24:27], s33 offen sc0 sc1
  v_add_u32 v5, 1048576, v5
  s_waitcnt lgkmcnt(0)
  v_lshl_or_b32 v12, v28, 16, v12
  v_lshl_or_b32 v13, v29, 16, v13
  v_lshl_or_b32 v14, v30, 16, v14
  v_lshl_or_b32 v15, v31, 16, v15
  buffer_store_dwordx4 v[12:15], v5, s[24:27], s33 offen sc0 sc1
  v_add_u32 v5, 1048576, v5
  s_cmp_ge_u32 s3, 3
  s_cbranch_scc1 k0_prep_kernel_end1
  ds_read_u16 v16, v4 offset:512
  ds_read_u16 v17, v4 offset:1090
  ds_read_u16 v18, v4 offset:1668
  ds_read_u16 v19, v4 offset:2246
  ds_read_u16 v32, v4 offset:10752
  ds_read_u16 v33, v4 offset:11330
  ds_read_u16 v34, v4 offset:11908
  ds_read_u16 v35, v4 offset:12486
  s_waitcnt lgkmcnt(0)
  v_lshl_or_b32 v16, v32, 16, v16
  v_lshl_or_b32 v17, v33, 16, v17
  v_lshl_or_b32 v18, v34, 16, v18
  v_lshl_or_b32 v19, v35, 16, v19
  buffer_store_dwordx4 v[16:19], v5, s[24:27], s33 offen sc0 sc1
  v_add_u32 v5, 1048576, v5
  s_endpgm
k0_prep_kernel_end1:
  s_endpgm
k0_prep_kernel_eoc:
.globl k1_rdft_kernel
.p2align 8
.type k1_rdft_kernel,@function
k1_rdft_kernel:
  s_load_dwordx2 s[6:7], s[0:1], 0
  s_load_dwordx2 s[4:5], s[0:1], 88
  s_load_dwordx4 s[24:27], s[0:1], 32
  s_cmp_ge_u32 s2, 16
  s_cbranch_scc1 k1_rdft_kernel_cpf2
  s_getpc_b64 s[84:85]
k1_rdft_kernel_here3:
  s_add_u32 s84, s84, k1_rdft_kernel-k1_rdft_kernel_here3
  s_addc_u32 s85, s85, -1
  s_mov_b32 s86, k1_rdft_kernel_eoc-k1_rdft_kernel
  s_mov_b32 s87, 0x20000
  v_lshlrev_b32 v112, 6, v0
  buffer_load_dword v113, v112, s[84:87], 0 offen
k1_rdft_kernel_cpf2:
  v_lshrrev_b32 v1, 6, v0
  s_nop 0
  v_readfirstlane_b32 s3, v1
  s_cmp_ge_u32 s2, 256
  s_cbranch_scc1 k1_rdft_kernel_end1
  s_and_b32 s28, s2, 15
  s_lshl_b32 s28, s28, 1
  s_bfe_u32 s29, s2, 0x10004
  s_add_u32 s28, s28, s29
  s_lshr_b32 s29, s2, 5
  s_lshl_b32 s30, s29, 3
  s_add_u32 s30, s30, s3
  s_lshl_b32 s30, s30, 5
  s_add_u32 s30, s30, s28
  s_mul_i32 s30, s30, 1152
  v_and_b32 v1, 63, v0
  v_and_b32 v2, 15, v0
  v_bfe_u32 v3, v0, 4, 2
  v_lshlrev_b32 v4, 2, v1
  v_lshlrev_b32 v114, 4, v0
  v_mov_b32 v12, 0
  v_cvt_f32_u32 v6, v2
  v_cvt_f32_u32 v7, v3
  v_mul_f32 v86, 0x3d638e39, v6
  v_add_f32 v87, 0x0, v7
  v_mul_f32 v87, v87, v86
  v_cos_f32 v76, v87
  v_sin_f32 v81, v87
  v_add_f32 v87, 0x40800000, v7
  v_mul_f32 v87, v87, v86
  v_cos_f32 v77, v87
  v_sin_f32 v82, v87
  v_add_f32 v87, 0x41000000, v7
  v_mul_f32 v87, v87, v86
  v_cos_f32 v78, v87
  v_sin_f32 v83, v87
  v_add_f32 v87, 0x41400000, v7
  v_mul_f32 v87, v87, v86
  v_cos_f32 v79, v87
  v_sin_f32 v84, v87
  v_add_f32 v87, 0x41800000, v7
  v_mul_f32 v87, v87, v86
  v_cos_f32 v80, v87
  v_sin_f32 v85, v87
  v_cvt_pk_bf16_f32 v36, v76, v77
  v_cvt_pk_bf16_f32 v37, v78, v79
  v_cvt_pk_bf16_f32 v38, v80, 0
  v_mov_b32 v39, 0
  v_cvt_pk_bf16_f32 v40, -v81, -v82
  v_cvt_pk_bf16_f32 v41, -v83, -v84
  v_cvt_pk_bf16_f32 v42, -v85, 0
  v_mov_b32 v43, 0
  v_mov_b32 v91, 0
  v_mov_b32 v95, 0
  v_mul_f32 v7, 0x41000000, v7
  v_add_f32 v87, 0x0, v7
  v_mul_f32 v87, v87, v6
  v_mul_f32 v86, 0x3ae38e39, v87
  v_mul_f32 v87, 0x3d000000, v87
  v_cos_f32 v44, v86
  v_sin_f32 v45, v86
  v_cos_f32 v76, v87
  v_sin_f32 v80, v87
  v_add_f32 v87, 0x40000000, v7
  v_mul_f32 v87, v87, v6
  v_mul_f32 v86, 0x3ae38e39, v87
  v_mul_f32 v87, 0x3d000000, v87
  v_cos_f32 v46, v86
  v_sin_f32 v47, v86
  v_cos_f32 v77, v87
  v_sin_f32 v81, v87
  v_add_f32 v87, 0x40800000, v7
  v_mul_f32 v87, v87, v6
  v_mul_f32 v86, 0x3ae38e39, v87
  v_mul_f32 v87, 0x3d000000, v87
  v_cos_f32 v48, v86
  v_sin_f32 v49, v86
  v_cos_f32 v78, v87
  v_sin_f32 v82, v87
  v_add_f32 v87, 0x40c00000, v7
  v_mul_f32 v87, v87, v6
  v_mul_f32 v86, 0x3ae38e39, v87
  v_mul_f32 v87, 0x3d000000, v87
  v_cos_f32 v50, v86
  v_sin_f32 v51, v86
  v_cos_f32 v79, v87
  v_sin_f32 v83, v87
  v_cvt_pk_bf16_f32 v62, v76, v77
  v_cvt_pk_bf16_f32 v63, v78, v79
  v_cvt_pk_bf16_f32 v64, v80, v81
  v_cvt_pk_bf16_f32 v65, v82, v83
  s_waitcnt lgkmcnt(0)
  s_mov_b32 s8, s6
  s_mov_b32 s9, s7
  s_mov_b32 s10, 0x240000
  s_mov_b32 s11, 0x20000
  s_mov_b32 s12, s4
  s_mov_b32 s13, s5
  s_mov_b32 s14, 0x10000
  s_mov_b32 s15, 0x20000
  s_movk_i32 s33, 13824
  buffer_load_dwordx4 v[16:19], v114, s[12:15], 0 offen
  buffer_load_dwordx4 v[20:23], v114, s[12:15], s33 offen
  buffer_load_dword v8, v4, s[8:11], s30 offen offset:0
  buffer_load_dword v9, v4, s[8:11], s30 offen offset:256
  buffer_load_dword v10, v4, s[8:11], s30 offen offset:512
  buffer_load_dword v11, v4, s[8:11], s30 offen offset:768
  s_mov_b32 exec_hi, 0
  buffer_load_dword v12, v4, s[8:11], s30 offen offset:1024
  s_mov_b32 exec_hi, -1
  v_lshlrev_b32 v5, 6, v1
  s_bitcmp1_b32 s3, 0
  s_cselect_b32 s16, s26, s24
  s_cselect_b32 s17, s27, s25
  s_lshr_b32 s24, s2, 3
  s_cmp_lt_u32 s24, 32
  s_cselect_b32 s18, 0x510000, 0
  s_cmp_ge_u32 s3, 6
  s_cselect_b32 s18, s18, 0
  s_mov_b32 s19, 0x20000
  s_add_u32 s24, s24, 49
  s_lshl_b32 s24, s24, 6
  s_and_b32 s25, s2, 7
  s_mul_i32 s25, s25, 2304
  v_lshrrev_b32 v5, 6, v5
  v_add_u32 v5, s24, v5
  v_mul_u32_u24 v115, 3641, v5
  v_lshrrev_b32 v115, 16, v115
  v_mul_u32_u24 v115, 16128, v115
  v_lshl_add_u32 v5, v5, 7, s25
  v_add_u32 v5, v5, v115
  v_cvt_pk_bf16_f32 v60, -v80, -v81
  v_cvt_pk_bf16_f32 v61, -v82, -v83
  v_add_f32 v87, 0x3f800000, v7
  v_mul_f32 v87, v87, v6
  v_mul_f32 v86, 0x3ae38e39, v87
  v_mul_f32 v87, 0x3d000000, v87
  v_cos_f32 v52, v86
  v_sin_f32 v53, v86
  v_cos_f32 v76, v87
  v_sin_f32 v80, v87
  v_add_f32 v87, 0x40400000, v7
  v_mul_f32 v87, v87, v6
  v_mul_f32 v86, 0x3ae38e39, v87
  v_mul_f32 v87, 0x3d000000, v87
  v_cos_f32 v54, v86
  v_sin_f32 v55, v86
  v_cos_f32 v77, v87
  v_sin_f32 v81, v87
  v_add_f32 v87, 0x40a00000, v7
  v_mul_f32 v87, v87, v6
  v_mul_f32 v86, 0x3ae38e39, v87
  v_mul_f32 v87, 0x3d000000, v87
  v_cos_f32 v56, v86
  v_sin_f32 v57, v86
  v_cos_f32 v78, v87
  v_sin_f32 v82, v87
  v_add_f32 v87, 0x40e00000, v7
  v_mul_f32 v87, v87, v6
  v_mul_f32 v86, 0x3ae38e39, v87
  v_mul_f32 v87, 0x3d000000, v87
  v_cos_f32 v58, v86
  v_sin_f32 v59, v86
  v_cos_f32 v79, v87
  v_sin_f32 v83, v87
  v_cvt_pk_bf16_f32 v68, v76, v77
  v_cvt_pk_bf16_f32 v69, v78, v79
  v_cvt_pk_bf16_f32 v70, v80, v81
  v_cvt_pk_bf16_f32 v71, v82, v83
  v_cvt_pk_bf16_f32 v66, -v80, -v81
  v_cvt_pk_bf16_f32 v67, -v82, -v83
  v_cvt_pk_bf16_f32 v72, -v76, -v77
  v_cvt_pk_bf16_f32 v73, -v78, -v79
  v_mov_b32 v74, v66
  v_mov_b32 v75, v67
  buffer_load_dword v5, v5, s[16:19], 0 offen
  s_add_u32 s20, s4, 0x400000
  s_addc_u32 s21, s5, 0
  s_mov_b32 s22, 0x280000
  s_mov_b32 s23, 0x20000
  v_mul_u32_u24 v2, 1040, v2
  v_lshl_add_u32 v2, v3, 7, v2
  s_lshl_b32 s31, s3, 2
  v_add_u32 v2, s31, v2
  v_lshlrev_b32 v4, 4, v1
  s_mul_i32 s31, s3, 1040
  v_add_u32 v3, s31, v4
  v_lshrrev_b32 v6, 1, v1
  v_lshlrev_b32 v6, 13, v6
  v_and_b32 v7, 16, v4
  v_add_u32 v6, v6, v7
  s_lshr_b32 s31, s28, 4
  s_lshl_b32 s31, s31, 12
  s_and_b32 s32, s28, 15
  s_lshl_b32 s32, s32, 6
  s_add_u32 s31, s31, s32
  s_lshr_b32 s32, s29, 1
  s_lshl_b32 s32, s32, 10
  s_add_u32 s31, s31, s32
  s_and_b32 s32, s29, 1
  s_lshl_b32 s32, s32, 5
  s_add_u32 s31, s31, s32
  s_add_u32 s32, s3, 1
  s_lshl_b32 s32, s32, 18
  s_add_u32 s32, s32, s31
  s_cmp_ge_u32 s3, 5
  s_cbranch_scc1 k1_rdft_kernel_m4
  s_waitcnt vmcnt(6)
  v_add_f32 v16, v16, v20
  v_add_f32 v17, v17, v21
  v_add_f32 v18, v18, v22
  v_add_f32 v19, v19, v23
  v_cvt_pk_bf16_f32 v20, v16, v17
  v_cvt_pk_bf16_f32 v22, v18, v19
  v_lshlrev_b32 v16, 16, v20
  v_and_b32 v17, 0xffff0000, v20
  v_lshlrev_b32 v18, 16, v22
  v_and_b32 v19, 0xffff0000, v22
  v_add_f32 v16, 1.0, v16
  v_add_f32 v17, 1.0, v17
  v_cvt_pk_bf16_f32 v20, v16, v17
  v_lshlrev_b32 v16, 16, v20
  v_and_b32 v17, 0xffff0000, v20
  ds_write_b128 v114, v[16:19] offset:10400
k1_rdft_kernel_m4:
  s_waitcnt vmcnt(1)
  v_lshlrev_b32 v24, 16, v8
  v_and_b32 v25, 0xffff0000, v8
  v_lshlrev_b32 v26, 16, v9
  v_and_b32 v27, 0xffff0000, v9
  v_lshlrev_b32 v28, 16, v10
  v_and_b32 v29, 0xffff0000, v10
  v_lshlrev_b32 v30, 16, v11
  v_and_b32 v31, 0xffff0000, v11
  v_lshlrev_b32 v32, 16, v12
  v_and_b32 v33, 0xffff0000, v12
  v_add_f32 v34, v24, v25
  v_add_f32 v7, v26, v27
  v_add_f32 v35, v28, v29
  v_add_f32 v34, v34, v30
  v_add_f32 v7, v7, v31
  v_add_f32 v35, v35, v32
  v_add_f32 v34, v34, v33
  v_add_f32 v7, v7, v35
  v_add_f32 v34, v34, v7
  s_nop 0
  s_nop 0
  v_add_f32_dpp v34, v34, v34 row_ror:8 row_mask:0xf bank_mask:0xf
  s_nop 0
  s_nop 0
  v_add_f32_dpp v34, v34, v34 row_ror:4 row_mask:0xf bank_mask:0xf
  s_nop 0
  s_nop 0
  v_add_f32_dpp v34, v34, v34 row_ror:2 row_mask:0xf bank_mask:0xf
  s_nop 0
  s_nop 0
  v_add_f32_dpp v34, v34, v34 row_ror:1 row_mask:0xf bank_mask:0xf
  s_nop 0
  s_nop 0
  v_add_f32_dpp v34, v34, v34 row_bcast:15 row_mask:0xa bank_mask:0xf
  s_nop 0
  s_nop 0
  v_add_f32_dpp v34, v34, v34 row_bcast:31 row_mask:0xc bank_mask:0xf
  s_nop 0
  v_readlane_b32 s33, v34, 63
  s_nop 0
  s_waitcnt lgkmcnt(0)
  v_mov_b32 v34, 0x3ae38e39
  v_mul_f32 v34, s33, v34
  v_sub_f32 v24, v24, v34
  v_sub_f32 v25, v25, v34
  v_sub_f32 v26, v26, v34
  v_sub_f32 v27, v27, v34
  v_sub_f32 v28, v28, v34
  v_sub_f32 v29, v29, v34
  v_sub_f32 v30, v30, v34
  v_sub_f32 v31, v31, v34
  s_mov_b32 exec_hi, 0
  v_sub_f32 v32, v32, v34
  v_sub_f32 v33, v33, v34
  s_mov_b32 exec_hi, -1
  v_mul_f32 v35, v24, v24
  v_mul_f32 v7, v25, v25
  v_fmac_f32 v35, v26, v26
  v_fmac_f32 v7, v27, v27
  v_fmac_f32 v35, v28, v28
  v_fmac_f32 v7, v29, v29
  v_fmac_f32 v35, v30, v30
  v_fmac_f32 v7, v31, v31
  v_fmac_f32 v35, v32, v32
  v_fmac_f32 v7, v33, v33
  v_add_f32 v35, v35, v7
  v_cvt_pk_bf16_f32 v7, v34, v34
  v_lshlrev_b32 v7, 16, v7
  v_sub_f32 v34, v34, v7
  s_barrier
  ds_read_b128 v[76:79], v4 offset:10400
  v_add_f32_dpp v35, v35, v35 row_ror:8 row_mask:0xf bank_mask:0xf
  ds_read_b128 v[80:83], v4 offset:11424
  ds_read_b128 v[84:87], v4 offset:12448
  v_add_f32_dpp v35, v35, v35 row_ror:4 row_mask:0xf bank_mask:0xf
  ds_read_b128 v[96:99], v4 offset:13472
  ds_read_b128 v[100:103], v4 offset:14496
  v_add_f32_dpp v35, v35, v35 row_ror:2 row_mask:0xf bank_mask:0xf
  s_nop 1
  v_add_f32_dpp v35, v35, v35 row_ror:1 row_mask:0xf bank_mask:0xf
  s_nop 1
  v_add_f32_dpp v35, v35, v35 row_bcast:15 row_mask:0xa bank_mask:0xf
  s_nop 1
  v_add_f32_dpp v35, v35, v35 row_bcast:31 row_mask:0xc bank_mask:0xf
  s_nop 0
  v_readlane_b32 s33, v35, 63
  v_mov_b32 v35, 0x3ae38e39
  s_nop 0
  v_mul_f32 v35, s33, v35
  v_cvt_pk_bf16_f32 v35, v35, v35
  v_lshlrev_b32 v35, 16, v35
  v_add_f32 v35, 0x3727c5ac, v35
  v_cvt_pk_bf16_f32 v35, v35, v35
  v_lshlrev_b32 v35, 16, v35
  v_sqrt_f32 v35, v35
  s_nop 0
  v_cvt_pk_bf16_f32 v35, v35, v35
  v_lshlrev_b32 v35, 16, v35
  v_rcp_f32 v35, v35
  s_nop 0
  v_mul_f32 v34, v34, v35
  v_fma_f32 v24, v24, v35, v34
  v_fma_f32 v25, v25, v35, v34
  v_fma_f32 v26, v26, v35, v34
  v_fma_f32 v27, v27, v35, v34
  v_fma_f32 v28, v28, v35, v34
  v_fma_f32 v29, v29, v35, v34
  v_fma_f32 v30, v30, v35, v34
  v_fma_f32 v31, v31, v35, v34
  v_fma_f32 v32, v32, v35, v34
  v_fma_f32 v33, v33, v35, v34
  s_waitcnt lgkmcnt(0)
  v_fma_f32 v24, v24, v76, v78
  v_fma_f32 v25, v25, v77, v79
  v_fma_f32 v26, v26, v80, v82
  v_fma_f32 v27, v27, v81, v83
  v_fma_f32 v28, v28, v84, v86
  v_fma_f32 v29, v29, v85, v87
  v_fma_f32 v30, v30, v96, v98
  v_fma_f32 v31, v31, v97, v99
  s_mov_b32 exec_hi, 0
  v_fma_f32 v32, v32, v100, v102
  v_fma_f32 v33, v33, v101, v103
  s_mov_b32 exec_lo, 0x0
  s_mov_b32 exec_hi, 0xffffffff
  v_mov_b32 v32, 0
  v_mov_b32 v33, 0
  s_mov_b64 exec, -1
  v_cvt_pk_bf16_f32 v88, v24, v26
  v_cvt_pk_bf16_f32 v89, v28, v30
  v_cvt_pk_bf16_f32 v90, v32, 0
  v_cvt_pk_bf16_f32 v92, v25, v27
  v_cvt_pk_bf16_f32 v93, v29, v31
  v_cvt_pk_bf16_f32 v94, v33, 0
  v_mfma_f32_16x16x32_bf16 v[96:99], v[88:91], v[36:39], 0
  v_mfma_f32_16x16x32_bf16 v[100:103], v[88:91], v[40:43], 0
  v_mfma_f32_16x16x32_bf16 v[104:107], v[92:95], v[36:39], 0
  v_mfma_f32_16x16x32_bf16 v[108:111], v[92:95], v[40:43], 0
  s_nop 4
  v_mul_f32 v76, v96, v44
  v_mul_f32 v80, v100, v44
  v_fmac_f32 v76, v100, v45
  v_fma_f32 v80, -v96, v45, v80
  v_mul_f32 v77, v97, v46
  v_mul_f32 v81, v101, v46
  v_fmac_f32 v77, v101, v47
  v_fma_f32 v81, -v97, v47, v81
  v_mul_f32 v78, v98, v48
  v_mul_f32 v82, v102, v48
  v_fmac_f32 v78, v102, v49
  v_fma_f32 v82, -v98, v49, v82
  v_mul_f32 v79, v99, v50
  v_mul_f32 v83, v103, v50
  v_fmac_f32 v79, v103, v51
  v_fma_f32 v83, -v99, v51, v83
  v_cvt_pk_bf16_f32 v8, v76, v77
  v_cvt_pk_bf16_f32 v9, v78, v79
  v_cvt_pk_bf16_f32 v10, v80, v81
  v_cvt_pk_bf16_f32 v11, v82, v83
  s_nop 1
  v_mfma_f32_16x16x32_bf16 v[24:27], v[62:65], v[8:11], 0
  v_mfma_f32_16x16x32_bf16 v[28:31], v[60:63], v[8:11], 0
  v_mul_f32 v76, v104, v52
  v_mul_f32 v80, v108, v52
  v_fmac_f32 v76, v108, v53
  v_fma_f32 v80, -v104, v53, v80
  v_mul_f32 v77, v105, v54
  v_mul_f32 v81, v109, v54
  v_fmac_f32 v77, v109, v55
  v_fma_f32 v81, -v105, v55, v81
  v_mul_f32 v78, v106, v56
  v_mul_f32 v82, v110, v56
  v_fmac_f32 v78, v110, v57
  v_fma_f32 v82, -v106, v57, v82
  v_mul_f32 v79, v107, v58
  v_mul_f32 v83, v111, v58
  v_fmac_f32 v79, v111, v59
  v_fma_f32 v83, -v107, v59, v83
  v_cvt_pk_bf16_f32 v12, v76, v77
  v_cvt_pk_bf16_f32 v13, v78, v79
  v_cvt_pk_bf16_f32 v14, v80, v81
  v_cvt_pk_bf16_f32 v15, v82, v83
  s_nop 1
  v_mfma_f32_16x16x32_bf16 v[96:99], v[68:71], v[12:15], v[24:27]
  v_mfma_f32_16x16x32_bf16 v[100:103], v[66:69], v[12:15], v[28:31]
  v_mfma_f32_16x16x32_bf16 v[104:107], v[72:75], v[12:15], v[24:27]
  v_mfma_f32_16x16x32_bf16 v[108:111], v[70:73], v[12:15], v[28:31]
  s_mov_b32 exec_lo, 0x3ff03ff
  s_mov_b32 exec_hi, 0x3ff03ff
  s_nop 3
  v_cvt_pk_bf16_f32 v76, v96, v100
  v_cvt_pk_bf16_f32 v77, v97, v101
  v_cvt_pk_bf16_f32 v78, v98, v102
  v_cvt_pk_bf16_f32 v79, v99, v103
  ds_write2_b32 v2, v76, v77 offset0:0 offset1:8
  ds_write2_b32 v2, v78, v79 offset0:16 offset1:24
  v_cvt_pk_bf16_f32 v80, v104, v108
  v_cvt_pk_bf16_f32 v81, v105, v109
  v_cvt_pk_bf16_f32 v82, v106, v110
  v_cvt_pk_bf16_f32 v83, v107, v111
  ds_write2_b32 v2, v80, v81 offset0:128 offset1:136
  ds_write2_b32 v2, v82, v83 offset0:144 offset1:152
  s_mov_b64 exec, -1
  s_waitcnt lgkmcnt(0)
  s_barrier
  ds_read_b128 v[8:11], v3 offset:1040
  s_cmp_ge_u32 s3, 2
  s_cbranch_scc1 k1_rdft_kernel_x5
  s_mul_i32 s33, s3, 9360
  v_add_u32 v4, s33, v4
  ds_read_b128 v[12:15], v4
  s_mul_i32 s33, s3, 2359296
  s_add_u32 s31, s31, s33
  s_cmp_eq_u32 s3, 0
  s_cselect_b32 exec_hi, 3, 0
  s_waitcnt lgkmcnt(0)
  buffer_store_dwordx4 v[12:15], v6, s[20:23], s31 offen
  s_mov_b32 exec_hi, -1
k1_rdft_kernel_x5:
  s_waitcnt lgkmcnt(0)
  buffer_store_dwordx4 v[8:11], v6, s[20:23], s32 offen
k1_rdft_kernel_end1:
  s_endpgm
k1_rdft_kernel_eoc:
.globl k2_sfft_kernel
.p2align 8
.type k2_sfft_kernel,@function
k2_sfft_kernel:
  s_load_dwordx2 s[4:5], s[0:1], 88
  s_load_dwordx4 s[24:27], s[0:1], 32
  s_cmp_ge_u32 s2, 16
  s_cbranch_scc1 k2_sfft_kernel_cpf3
  s_getpc_b64 s[84:85]
k2_sfft_kernel_here4:
  s_add_u32 s84, s84, k2_sfft_kernel-k2_sfft_kernel_here4
  s_addc_u32 s85, s85, -1
  s_mov_b32 s86, k2_sfft_kernel_eoc-k2_sfft_kernel
  s_mov_b32 s87, 0x20000
  v_lshlrev_b32 v168, 6, v0
  buffer_load_dword v169, v168, s[84:87], 0 offen
k2_sfft_kernel_cpf3:
  v_lshrrev_b32 v1, 6, v0
  s_nop 0
  v_readfirstlane_b32 s3, v1
  s_cmp_ge_u32 s2, 289
  s_cbranch_scc1 k2_sfft_kernel_mc2
  s_cmp_lt_u32 s2, 17
  s_cselect_b32 s35, 0, 15
  s_add_u32 s35, s35, s2
  s_lshl_b32 s28, s35, 13
  s_lshl_b32 s30, s3, 11
  s_lshr_b32 s36, s35, 5
  s_and_b32 s37, s35, 31
  s_mul_i32 s37, s37, 18
  s_add_u32 s36, s36, s37
  s_sub_u32 s37, 576, s36
  s_cmp_gt_u32 s36, 288
  s_cselect_b32 s29, s37, s36
  s_cselect_b32 s36, -4, 4
  s_cselect_b32 s39, -1.0, 1.0
  s_lshl_b32 s29, s29, 13
  s_and_b32 s37, s35, 0xffef
  s_cmp_eq_u32 s37, 0
  s_cselect_b32 s38, 0.5, 1.0
  s_cselect_b32 s39, 0.5, s39
  s_add_u32 s31, s28, 4096
  v_and_b32 v1, 15, v0
  v_bfe_u32 v2, v0, 4, 2
  v_lshlrev_b32 v3, 6, v1
  v_lshl_add_u32 v3, v2, 4, v3
  v_and_b32 v4, 63, v0
  v_lshlrev_b32 v4, 4, v4
  s_lshl_b32 s32, s3, 4
  v_lshl_add_u32 v5, v2, 8, v1
  v_add_u32 v5, s32, v5
  v_mul_i32_i24 v5, s36, v5
  v_and_b32 v40, 0x1fff, v5
  s_mul_i32 s37, s36, 64
  v_add_u32 v41, s37, v5
  v_and_b32 v41, 0x1fff, v41
  s_mul_i32 s37, s36, 128
  v_add_u32 v42, s37, v5
  v_and_b32 v42, 0x1fff, v42
  s_mul_i32 s37, s36, 192
  v_add_u32 v43, s37, v5
  v_and_b32 v43, 0x1fff, v43
  s_mul_i32 s37, s36, 1024
  v_add_u32 v44, s37, v5
  v_and_b32 v44, 0x1fff, v44
  s_mul_i32 s37, s36, 1088
  v_add_u32 v45, s37, v5
  v_and_b32 v45, 0x1fff, v45
  s_mul_i32 s37, s36, 1152
  v_add_u32 v46, s37, v5
  v_and_b32 v46, 0x1fff, v46
  s_mul_i32 s37, s36, 1216
  v_add_u32 v47, s37, v5
  v_and_b32 v47, 0x1fff, v47
  s_lshl_b32 s32, s3, 4
  v_add_u32 v5, s32, v1
  v_cvt_f32_u32 v5, v5
  v_lshlrev_b32 v6, 2, v2
  v_cvt_f32_u32 v6, v6
  v_cvt_f32_u32 v7, v1
  v_mul_f32 v160, 0x3c800000, v5
  v_mul_f32 v161, v160, v6
  v_cos_f32 v152, v161
  v_sin_f32 v156, v161
  v_fmamk_f32 v162, v160, 0x3f800000, v161
  v_cos_f32 v153, v162
  v_sin_f32 v157, v162
  v_fmamk_f32 v162, v160, 0x40000000, v161
  v_cos_f32 v154, v162
  v_sin_f32 v158, v162
  v_fmamk_f32 v162, v160, 0x40400000, v161
  v_cos_f32 v155, v162
  v_sin_f32 v159, v162
  v_bfe_i32 v164, v1, 0, 1
  v_bfe_i32 v165, v1, 1, 1
  v_and_b32 v164, 0x80008000, v164
  v_and_b32 v165, 0x80008000, v165
  v_xor_b32 v166, v165, v164
  v_cmp_ne_u32 vcc, 0, v164
  v_cvt_pk_bf16_f32 v48, v152, v156
  v_cvt_pk_bf16_f32 v52, -v156, v152
  v_cvt_pk_bf16_f32 v49, v153, v157
  v_cvt_pk_bf16_f32 v53, -v157, v153
  v_cvt_pk_bf16_f32 v50, v154, v158
  v_cvt_pk_bf16_f32 v54, -v158, v154
  v_cvt_pk_bf16_f32 v51, v155, v159
  v_cvt_pk_bf16_f32 v55, -v159, v155
  v_cndmask_b32 v56, v48, v52, vcc
  v_cndmask_b32 v60, v52, v48, vcc
  v_cndmask_b32 v57, v49, v53, vcc
  v_cndmask_b32 v61, v53, v49, vcc
  v_cndmask_b32 v58, v50, v54, vcc
  v_cndmask_b32 v62, v54, v50, vcc
  v_cndmask_b32 v59, v51, v55, vcc
  v_cndmask_b32 v63, v55, v51, vcc
  v_xor_b32 v56, v56, v165
  v_xor_b32 v60, v60, v166
  v_xor_b32 v57, v57, v165
  v_xor_b32 v61, v61, v166
  v_xor_b32 v58, v58, v165
  v_xor_b32 v62, v62, v166
  v_xor_b32 v59, v59, v165
  v_xor_b32 v63, v63, v166
  v_xor_b32 v64, v48, v164
  v_xor_b32 v65, v49, v164
  v_xor_b32 v66, v50, v164
  v_xor_b32 v67, v51, v164
  v_xor_b32 v68, v52, v164
  v_xor_b32 v69, v53, v164
  v_xor_b32 v70, v54, v164
  v_xor_b32 v71, v55, v164
  v_xor_b32 v72, v56, v164
  v_xor_b32 v73, v57, v164
  v_xor_b32 v74, v58, v164
  v_xor_b32 v75, v59, v164
  v_xor_b32 v76, v60, v164
  v_xor_b32 v77, v61, v164
  v_xor_b32 v78, v62, v164
  v_xor_b32 v79, v63, v164
  v_mul_f32 v160, 0x3a000000, v5
  v_mul_f32 v161, v160, v6
  v_cos_f32 v104, v161
  v_sin_f32 v105, v161
  v_fmamk_f32 v162, v160, 0x3f800000, v161
  s_waitcnt lgkmcnt(0)
  s_add_u32 s8, s4, 0x400000
  s_addc_u32 s9, s5, 0
  s_mov_b32 s10, 0x280000
  s_mov_b32 s11, 0x20000
  buffer_load_dwordx4 v[8:11], v3, s[8:11], s28 offen offset:0
  buffer_load_dwordx4 v[24:27], v3, s[8:11], s31 offen offset:0
  buffer_load_dwordx4 v[12:15], v3, s[8:11], s28 offen offset:1024
  buffer_load_dwordx4 v[28:31], v3, s[8:11], s31 offen offset:1024
  buffer_load_dwordx4 v[16:19], v3, s[8:11], s28 offen offset:2048
  buffer_load_dwordx4 v[32:35], v3, s[8:11], s31 offen offset:2048
  buffer_load_dwordx4 v[20:23], v3, s[8:11], s28 offen offset:3072
  buffer_load_dwordx4 v[36:39], v3, s[8:11], s31 offen offset:3072
  s_add_u32 s12, s4, 0x100000
  s_addc_u32 s13, s5, 0
  s_mov_b32 s14, 0x280000
  s_mov_b32 s15, 0x20000
  buffer_load_dword v40, v40, s[12:15], s29 offen
  buffer_load_dword v41, v41, s[12:15], s29 offen
  buffer_load_dword v42, v42, s[12:15], s29 offen
  buffer_load_dword v43, v43, s[12:15], s29 offen
  buffer_load_dword v44, v44, s[12:15], s29 offen
  buffer_load_dword v45, v45, s[12:15], s29 offen
  buffer_load_dword v46, v46, s[12:15], s29 offen
  buffer_load_dword v47, v47, s[12:15], s29 offen
  v_lshlrev_b32 v167, 2, v4
  s_bitcmp1_b32 s2, 3
  s_cselect_b32 s20, s26, s24
  s_cselect_b32 s21, s27, s25
  s_lshr_b32 s24, s2, 4
  s_cmp_lt_u32 s24, 17
  s_cselect_b32 s22, 0x510000, 0
  s_cmp_ge_u32 s3, 3
  s_cselect_b32 s22, s22, 0
  s_mov_b32 s23, 0x20000
  s_add_u32 s24, s24, 32
  s_lshl_b32 s24, s24, 6
  s_and_b32 s25, s2, 7
  s_mul_i32 s25, s25, 2304
  v_lshrrev_b32 v167, 6, v167
  v_add_u32 v167, s24, v167
  v_mul_u32_u24 v170, 3641, v167
  v_lshrrev_b32 v170, 16, v170
  v_mul_u32_u24 v170, 16128, v170
  v_lshl_add_u32 v167, v167, 7, s25
  v_add_u32 v167, v167, v170
  v_cos_f32 v106, v162
  v_sin_f32 v107, v162
  v_fmamk_f32 v162, v160, 0x40000000, v161
  v_cos_f32 v108, v162
  v_sin_f32 v109, v162
  v_fmamk_f32 v162, v160, 0x40400000, v161
  v_cos_f32 v110, v162
  v_sin_f32 v111, v162
  v_fmamk_f32 v161, v160, 0x41800000, v161
  v_cos_f32 v112, v161
  v_sin_f32 v113, v161
  v_fmamk_f32 v162, v160, 0x3f800000, v161
  v_cos_f32 v114, v162
  v_sin_f32 v115, v162
  v_fmamk_f32 v162, v160, 0x40000000, v161
  v_cos_f32 v116, v162
  v_sin_f32 v117, v162
  v_fmamk_f32 v162, v160, 0x40400000, v161
  v_cos_f32 v118, v162
  v_sin_f32 v119, v162
  v_mul_f32 v160, 0x3d000000, v7
  v_mul_f32 v161, v160, v6
  v_cos_f32 v152, v161
  v_sin_f32 v156, v161
  v_fmamk_f32 v162, v160, 0x3f800000, v161
  v_cos_f32 v153, v162
  v_sin_f32 v157, v162
  v_fmamk_f32 v162, v160, 0x40000000, v161
  v_cos_f32 v154, v162
  v_sin_f32 v158, v162
  v_fmamk_f32 v162, v160, 0x40400000, v161
  v_cos_f32 v155, v162
  v_sin_f32 v159, v162
  v_cvt_pk_bf16_f32 v82, v152, v153
  v_cvt_pk_bf16_f32 v83, v154, v155
  v_cvt_pk_bf16_f32 v84, v156, v157
  v_cvt_pk_bf16_f32 v85, v158, v159
  v_cvt_pk_bf16_f32 v80, -v156, -v157
  v_cvt_pk_bf16_f32 v81, -v158, -v159
  v_xor_b32 v86, v80, v164
  v_xor_b32 v87, v81, v164
  v_xor_b32 v88, v82, v164
  v_xor_b32 v89, v83, v164
  v_xor_b32 v90, v84, v164
  v_xor_b32 v91, v85, v164
  v_xor_b32 v92, 0x80000000, v80
  v_xor_b32 v93, 0x80000000, v81
  v_xor_b32 v94, 0x80000000, v82
  v_xor_b32 v95, 0x80000000, v83
  v_xor_b32 v96, 0x80000000, v84
  v_xor_b32 v97, 0x80000000, v85
  v_xor_b32 v98, 0x80000000, v86
  v_xor_b32 v99, 0x80000000, v87
  v_xor_b32 v100, 0x80000000, v88
  v_xor_b32 v101, 0x80000000, v89
  v_xor_b32 v102, 0x80000000, v90
  v_xor_b32 v103, 0x80000000, v91
  v_cvt_f32_u32 v5, s32
  v_add_f32 v5, v5, v6
  v_mul_f32 v160, 0x3a000000, v7
  buffer_load_dword v167, v167, s[20:23], 0 offen
  v_mul_f32 v161, v160, v5
  v_cos_f32 v120, v161
  v_sin_f32 v121, v161
  v_fmamk_f32 v162, v160, 0x3f800000, v161
  v_cos_f32 v122, v162
  v_sin_f32 v123, v162
  v_fmamk_f32 v162, v160, 0x40000000, v161
  v_cos_f32 v124, v162
  v_sin_f32 v125, v162
  v_fmamk_f32 v162, v160, 0x40400000, v161
  v_cos_f32 v126, v162
  v_sin_f32 v127, v162
  v_add_f32 v7, 0x41800000, v7
  v_mul_f32 v160, 0x3a000000, v7
  v_mul_f32 v161, v160, v5
  v_cos_f32 v128, v161
  v_sin_f32 v129, v161
  v_fmamk_f32 v162, v160, 0x3f800000, v161
  v_cos_f32 v130, v162
  v_sin_f32 v131, v162
  v_fmamk_f32 v162, v160, 0x40000000, v161
  v_cos_f32 v132, v162
  v_sin_f32 v133, v162
  v_fmamk_f32 v162, v160, 0x40400000, v161
  v_cos_f32 v134, v162
  v_sin_f32 v135, v162
  s_add_u32 s16, s4, 0x700000
  s_addc_u32 s17, s5, 0
  s_mov_b32 s18, 0x280000
  s_mov_b32 s19, 0x20000
  v_lshrrev_b32 v3, 2, v1
  v_lshl_add_u32 v3, v3, 4, v2
  v_mul_u32_u24 v3, 20480, v3
  v_and_b32 v1, 3, v1
  v_lshl_add_u32 v3, v1, 4, v3
  s_mul_i32 s33, s3, 81920
  s_lshl_b32 s34, s35, 6
  s_add_u32 s33, s33, s34
  s_add_u32 s34, s33, 1310720
  v_add_u32 v5, s30, v4
  s_waitcnt vmcnt(15)
  v_mfma_f32_16x16x32_bf16 v[136:139], v[8:11], v[48:51], 0
  v_mfma_f32_16x16x32_bf16 v[140:143], v[8:11], v[52:55], 0
  v_mfma_f32_16x16x32_bf16 v[144:147], v[24:27], v[48:51], 0
  v_mfma_f32_16x16x32_bf16 v[148:151], v[24:27], v[52:55], 0
  s_waitcnt vmcnt(13)
  v_mfma_f32_16x16x32_bf16 v[136:139], v[12:15], v[56:59], v[136:139]
  v_mfma_f32_16x16x32_bf16 v[140:143], v[12:15], v[60:63], v[140:143]
  v_mfma_f32_16x16x32_bf16 v[144:147], v[28:31], v[56:59], v[144:147]
  v_mfma_f32_16x16x32_bf16 v[148:151], v[28:31], v[60:63], v[148:151]
  s_waitcnt vmcnt(11)
  v_mfma_f32_16x16x32_bf16 v[136:139], v[16:19], v[64:67], v[136:139]
  v_mfma_f32_16x16x32_bf16 v[140:143], v[16:19], v[68:71], v[140:143]
  v_mfma_f32_16x16x32_bf16 v[144:147], v[32:35], v[64:67], v[144:147]
  v_mfma_f32_16x16x32_bf16 v[148:151], v[32:35], v[68:71], v[148:151]
  s_waitcnt vmcnt(9)
  v_mfma_f32_16x16x32_bf16 v[136:139], v[20:23], v[72:75], v[136:139]
  v_mfma_f32_16x16x32_bf16 v[140:143], v[20:23], v[76:79], v[140:143]
  v_mfma_f32_16x16x32_bf16 v[144:147], v[36:39], v[72:75], v[144:147]
  v_mfma_f32_16x16x32_bf16 v[148:151], v[36:39], v[76:79], v[148:151]
  s_nop 4
  v_mul_f32 v152, v136, v104
  v_mul_f32 v156, v140, v104
  v_fmac_f32 v152, v140, v105
  v_fma_f32 v156, -v136, v105, v156
  v_mul_f32 v153, v137, v106
  v_mul_f32 v157, v141, v106
  v_fmac_f32 v153, v141, v107
  v_fma_f32 v157, -v137, v107, v157
  v_mul_f32 v154, v138, v108
  v_mul_f32 v158, v142, v108
  v_fmac_f32 v154, v142, v109
  v_fma_f32 v158, -v138, v109, v158
  v_mul_f32 v155, v139, v110
  v_mul_f32 v159, v143, v110
  v_fmac_f32 v155, v143, v111
  v_fma_f32 v159, -v139, v111, v159
  v_cvt_pk_bf16_f32 v8, v152, v153
  v_cvt_pk_bf16_f32 v9, v154, v155
  v_cvt_pk_bf16_f32 v10, v156, v157
  v_cvt_pk_bf16_f32 v11, v158, v159
  v_mul_f32 v152, v144, v112
  v_mul_f32 v156, v148, v112
  v_fmac_f32 v152, v148, v113
  v_fma_f32 v156, -v144, v113, v156
  v_mul_f32 v153, v145, v114
  v_mul_f32 v157, v149, v114
  v_fmac_f32 v153, v149, v115
  v_fma_f32 v157, -v145, v115, v157
  v_mul_f32 v154, v146, v116
  v_mul_f32 v158, v150, v116
  v_fmac_f32 v154, v150, v117
  v_fma_f32 v158, -v146, v117, v158
  v_mul_f32 v155, v147, v118
  v_mul_f32 v159, v151, v118
  v_fmac_f32 v155, v151, v119
  v_fma_f32 v159, -v147, v119, v159
  v_cvt_pk_bf16_f32 v12, v152, v153
  v_cvt_pk_bf16_f32 v13, v154, v155
  v_cvt_pk_bf16_f32 v14, v156, v157
  v_cvt_pk_bf16_f32 v15, v158, v159
  s_waitcnt vmcnt(1)
  v_mfma_f32_16x16x32_bf16 v[136:139], v[82:85], v[8:11], 0
  v_mfma_f32_16x16x32_bf16 v[140:143], v[80:83], v[8:11], 0
  v_lshlrev_b32 v24, 16, v40
  v_and_b32 v25, 0xffff0000, v40
  v_mul_f32 v24, s38, v24
  v_mul_f32 v25, s39, v25
  v_lshlrev_b32 v26, 16, v41
  v_and_b32 v27, 0xffff0000, v41
  v_mul_f32 v26, s38, v26
  v_mul_f32 v27, s39, v27
  v_mfma_f32_16x16x32_bf16 v[144:147], v[94:97], v[8:11], 0
  v_mfma_f32_16x16x32_bf16 v[148:151], v[92:95], v[8:11], 0
  v_lshlrev_b32 v28, 16, v42
  v_and_b32 v29, 0xffff0000, v42
  v_mul_f32 v28, s38, v28
  v_mul_f32 v29, s39, v29
  v_lshlrev_b32 v30, 16, v43
  v_and_b32 v31, 0xffff0000, v43
  v_mul_f32 v30, s38, v30
  v_mul_f32 v31, s39, v31
  v_mfma_f32_16x16x32_bf16 v[136:139], v[88:91], v[12:15], v[136:139]
  v_mfma_f32_16x16x32_bf16 v[140:143], v[86:89], v[12:15], v[140:143]
  v_lshlrev_b32 v32, 16, v44
  v_and_b32 v33, 0xffff0000, v44
  v_mul_f32 v32, s38, v32
  v_mul_f32 v33, s39, v33
  v_lshlrev_b32 v34, 16, v45
  v_and_b32 v35, 0xffff0000, v45
  v_mul_f32 v34, s38, v34
  v_mul_f32 v35, s39, v35
  v_mfma_f32_16x16x32_bf16 v[144:147], v[100:103], v[12:15], v[144:147]
  v_mfma_f32_16x16x32_bf16 v[148:151], v[98:101], v[12:15], v[148:151]
  v_lshlrev_b32 v36, 16, v46
  v_and_b32 v37, 0xffff0000, v46
  v_mul_f32 v36, s38, v36
  v_mul_f32 v37, s39, v37
  v_lshlrev_b32 v38, 16, v47
  v_and_b32 v39, 0xffff0000, v47
  v_mul_f32 v38, s38, v38
  v_mul_f32 v39, s39, v39
  v_mul_f32 v152, v136, v24
  v_mul_f32 v156, v140, v24
  v_fma_f32 v152, -v140, v25, v152
  v_fma_f32 v156, -v136, v25, -v156
  v_mul_f32 v153, v137, v26
  v_mul_f32 v157, v141, v26
  v_fma_f32 v153, -v141, v27, v153
  v_fma_f32 v157, -v137, v27, -v157
  v_mul_f32 v154, v138, v28
  v_mul_f32 v158, v142, v28
  v_fma_f32 v154, -v142, v29, v154
  v_fma_f32 v158, -v138, v29, -v158
  v_mul_f32 v155, v139, v30
  v_mul_f32 v159, v143, v30
  v_fma_f32 v155, -v143, v31, v155
  v_fma_f32 v159, -v139, v31, -v159
  v_cvt_pk_bf16_f32 v16, v152, v153
  v_cvt_pk_bf16_f32 v17, v154, v155
  v_cvt_pk_bf16_f32 v18, v156, v157
  v_cvt_pk_bf16_f32 v19, v158, v159
  v_mul_f32 v152, v144, v32
  v_mul_f32 v156, v148, v32
  v_fma_f32 v152, -v148, v33, v152
  v_fma_f32 v156, -v144, v33, -v156
  v_mul_f32 v153, v145, v34
  v_mul_f32 v157, v149, v34
  v_fma_f32 v153, -v149, v35, v153
  v_fma_f32 v157, -v145, v35, -v157
  v_mul_f32 v154, v146, v36
  v_mul_f32 v158, v150, v36
  v_fma_f32 v154, -v150, v37, v154
  v_fma_f32 v158, -v146, v37, -v158
  v_mul_f32 v155, v147, v38
  v_mul_f32 v159, v151, v38
  v_fma_f32 v155, -v151, v39, v155
  v_fma_f32 v159, -v147, v39, -v159
  v_cvt_pk_bf16_f32 v20, v152, v153
  v_cvt_pk_bf16_f32 v21, v154, v155
  v_cvt_pk_bf16_f32 v22, v156, v157
  v_cvt_pk_bf16_f32 v23, v158, v159
  v_mfma_f32_16x16x32_bf16 v[136:139], v[16:19], v[82:85], 0
  v_mfma_f32_16x16x32_bf16 v[140:143], v[16:19], v[80:83], 0
  v_mfma_f32_16x16x32_bf16 v[144:147], v[16:19], v[94:97], 0
  v_mfma_f32_16x16x32_bf16 v[148:151], v[16:19], v[92:95], 0
  v_mfma_f32_16x16x32_bf16 v[136:139], v[20:23], v[88:91], v[136:139]
  v_mfma_f32_16x16x32_bf16 v[140:143], v[20:23], v[86:89], v[140:143]
  v_mfma_f32_16x16x32_bf16 v[144:147], v[20:23], v[100:103], v[144:147]
  v_mfma_f32_16x16x32_bf16 v[148:151], v[20:23], v[98:101], v[148:151]
  s_nop 4
  v_mul_f32 v152, v136, v120
  v_mul_f32 v156, v140, v120
  v_fmac_f32 v152, v140, v121
  v_fma_f32 v156, -v136, v121, v156
  v_mul_f32 v153, v137, v122
  v_mul_f32 v157, v141, v122
  v_fmac_f32 v153, v141, v123
  v_fma_f32 v157, -v137, v123, v157
  v_mul_f32 v154, v138, v124
  v_mul_f32 v158, v142, v124
  v_fmac_f32 v154, v142, v125
  v_fma_f32 v158, -v138, v125, v158
  v_mul_f32 v155, v139, v126
  v_mul_f32 v159, v143, v126
  v_fmac_f32 v155, v143, v127
  v_fma_f32 v159, -v139, v127, v159
  v_cvt_pk_bf16_f32 v24, v152, v156
  v_cvt_pk_bf16_f32 v25, v153, v157
  v_cvt_pk_bf16_f32 v26, v154, v158
  v_cvt_pk_bf16_f32 v27, v155, v159
  ds_write_b128 v5, v[24:27] offset:0
  v_mul_f32 v152, v144, v128
  v_mul_f32 v156, v148, v128
  v_fmac_f32 v152, v148, v129
  v_fma_f32 v156, -v144, v129, v156
  v_mul_f32 v153, v145, v130
  v_mul_f32 v157, v149, v130
  v_fmac_f32 v153, v149, v131
  v_fma_f32 v157, -v145, v131, v157
  v_mul_f32 v154, v146, v132
  v_mul_f32 v158, v150, v132
  v_fmac_f32 v154, v150, v133
  v_fma_f32 v158, -v146, v133, v158
  v_mul_f32 v155, v147, v134
  v_mul_f32 v159, v151, v134
  v_fmac_f32 v155, v151, v135
  v_fma_f32 v159, -v147, v135, v159
  v_cvt_pk_bf16_f32 v28, v152, v156
  v_cvt_pk_bf16_f32 v29, v153, v157
  v_cvt_pk_bf16_f32 v30, v154, v158
  v_cvt_pk_bf16_f32 v31, v155, v159
  ds_write_b128 v5, v[28:31] offset:1024
  s_waitcnt lgkmcnt(0)
  s_barrier
  ds_read_b128 v[8:11], v4 offset:0
  ds_read_b128 v[12:15], v4 offset:2048
  ds_read_b128 v[16:19], v4 offset:4096
  ds_read_b128 v[20:23], v4 offset:6144
  ds_read_b128 v[24:27], v4 offset:1024
  ds_read_b128 v[28:31], v4 offset:3072
  ds_read_b128 v[32:35], v4 offset:5120
  ds_read_b128 v[36:39], v4 offset:7168
  s_waitcnt lgkmcnt(6)
  v_mfma_f32_16x16x32_bf16 v[136:139], v[48:51], v[8:11], 0
  v_mfma_f32_16x16x32_bf16 v[140:143], v[52:55], v[8:11], 0
  v_mfma_f32_16x16x32_bf16 v[136:139], v[56:59], v[12:15], v[136:139]
  v_mfma_f32_16x16x32_bf16 v[140:143], v[60:63], v[12:15], v[140:143]
  s_waitcnt lgkmcnt(4)
  v_mfma_f32_16x16x32_bf16 v[136:139], v[64:67], v[16:19], v[136:139]
  v_mfma_f32_16x16x32_bf16 v[140:143], v[68:71], v[16:19], v[140:143]
  v_mfma_f32_16x16x32_bf16 v[136:139], v[72:75], v[20:23], v[136:139]
  v_mfma_f32_16x16x32_bf16 v[140:143], v[76:79], v[20:23], v[140:143]
  s_waitcnt lgkmcnt(2)
  v_mfma_f32_16x16x32_bf16 v[144:147], v[48:51], v[24:27], 0
  v_mfma_f32_16x16x32_bf16 v[148:151], v[52:55], v[24:27], 0
  v_mfma_f32_16x16x32_bf16 v[144:147], v[56:59], v[28:31], v[144:147]
  v_mfma_f32_16x16x32_bf16 v[148:151], v[60:63], v[28:31], v[148:151]
  s_waitcnt lgkmcnt(0)
  v_mfma_f32_16x16x32_bf16 v[144:147], v[64:67], v[32:35], v[144:147]
  v_mfma_f32_16x16x32_bf16 v[148:151], v[68:71], v[32:35], v[148:151]
  v_mfma_f32_16x16x32_bf16 v[144:147], v[72:75], v[36:39], v[144:147]
  v_mfma_f32_16x16x32_bf16 v[148:151], v[76:79], v[36:39], v[148:151]
  v_cvt_pk_bf16_f32 v152, v136, -v140
  v_cvt_pk_bf16_f32 v153, v137, -v141
  v_cvt_pk_bf16_f32 v154, v138, -v142
  v_cvt_pk_bf16_f32 v155, v139, -v143
  buffer_store_dwordx4 v[152:155], v3, s[16:19], s33 offen sc0 sc1
  s_nop 2
  v_cvt_pk_bf16_f32 v156, v144, -v148
  v_cvt_pk_bf16_f32 v157, v145, -v149
  v_cvt_pk_bf16_f32 v158, v146, -v150
  v_cvt_pk_bf16_f32 v159, v147, -v151
  buffer_store_dwordx4 v[156:159], v3, s[16:19], s34 offen sc0 sc1
  s_endpgm
k2_sfft_kernel_mc2:
  s_cmp_ge_u32 s2, 291
  s_cbranch_scc1 k2_sfft_kernel_end1
  s_sub_u32 s28, s2, 289
  s_lshl_b32 s28, s28, 8
  v_add_u32 v1, s28, v0
  v_lshlrev_b32 v2, 5, v1
  v_lshlrev_b32 v3, 4, v1
  v_lshlrev_b32 v4, 3, v1
  v_cmp_gt_u32 vcc, 0x120, v1
  s_nop 0
  s_and_saveexec_b64 s[30:31], vcc
  s_cbranch_execz k2_sfft_kernel_end1
  s_movk_i32 s28, 4608
  s_movk_i32 s29, 18432
  s_waitcnt lgkmcnt(0)
  s_mov_b32 s8, s4
  s_mov_b32 s9, s5
  s_mov_b32 s10, 0x10000
  s_mov_b32 s11, 0x20000
  buffer_load_dwordx4 v[8:11], v2, s[8:11], s28 offen
  buffer_load_dwordx4 v[12:15], v2, s[8:11], s28 offen offset:16
  buffer_load_dwordx4 v[16:19], v2, s[8:11], s29 offen
  buffer_load_dwordx4 v[20:23], v2, s[8:11], s29 offen offset:16
  s_mov_b32 s28, 32768
  s_movk_i32 s29, 28672
  s_waitcnt vmcnt(0)
  v_add_f32 v8, v8, v16
  v_add_f32 v9, v9, v17
  v_add_f32 v10, v10, v18
  v_add_f32 v11, v11, v19
  v_add_f32 v12, v12, v20
  v_add_f32 v13, v13, v21
  v_add_f32 v14, v14, v22
  v_add_f32 v15, v15, v23
  v_cvt_pk_bf16_f32 v16, v8, v9
  v_cvt_pk_bf16_f32 v18, v10, v11
  v_cvt_pk_bf16_f32 v20, v12, v13
  v_cvt_pk_bf16_f32 v22, v14, v15
  v_lshlrev_b32 v8, 16, v16
  v_and_b32 v9, 0xffff0000, v16
  v_lshlrev_b32 v10, 16, v18
  v_and_b32 v11, 0xffff0000, v18
  v_lshlrev_b32 v12, 16, v20
  v_and_b32 v13, 0xffff0000, v20
  v_lshlrev_b32 v14, 16, v22
  v_and_b32 v15, 0xffff0000, v22
  v_add_f32 v10, 1.0, v10
  v_add_f32 v11, 1.0, v11
  v_cvt_pk_bf16_f32 v18, v10, v11
  v_lshlrev_b32 v10, 16, v18
  v_and_b32 v11, 0xffff0000, v18
  v_mov_b32 v17, v18
  v_mov_b32 v18, v20
  v_mov_b32 v19, v22
  buffer_store_dwordx4 v[16:19], v3, s[8:11], s28 offen sc0 sc1
  buffer_store_dwordx2 v[14:15], v4, s[8:11], s29 offen sc0 sc1
k2_sfft_kernel_end1:
  s_endpgm
k2_sfft_kernel_eoc:
.globl k3_irdft_kernel
.p2align 8
.type k3_irdft_kernel,@function
k3_irdft_kernel:
  s_load_dwordx2 s[4:5], s[0:1], 88
  s_load_dwordx2 s[6:7], s[0:1], 0
  s_load_dwordx4 s[24:27], s[0:1], 32
  s_cmp_ge_u32 s2, 16
  s_cbranch_scc1 k3_irdft_kernel_cpf2
  s_getpc_b64 s[84:85]
k3_irdft_kernel_here3:
  s_add_u32 s84, s84, k3_irdft_kernel-k3_irdft_kernel_here3
  s_addc_u32 s85, s85, -1
  s_mov_b32 s86, k3_irdft_kernel_eoc-k3_irdft_kernel
  s_mov_b32 s87, 0x20000
  v_lshlrev_b32 v120, 6, v0
  buffer_load_dword v121, v120, s[84:87], 0 offen
k3_irdft_kernel_cpf2:
  v_lshrrev_b32 v1, 6, v0
  s_nop 0
  v_readfirstlane_b32 s3, v1
  s_cmp_ge_u32 s2, 256
  s_cbranch_scc1 k3_irdft_kernel_end1
  s_lshr_b32 s28, s2, 4
  s_lshl_b32 s28, s28, 3
  s_and_b32 s29, s2, 7
  s_add_u32 s28, s28, s29
  s_bfe_u32 s29, s2, 0x10003
  s_and_b32 s30, s28, 15
  s_lshl_b32 s30, s30, 2
  s_and_b32 s31, s3, 3
  s_add_u32 s30, s30, s31
  s_lshl_b32 s30, s30, 4
  s_lshr_b32 s31, s28, 4
  s_lshl_b32 s31, s31, 1
  s_add_u32 s30, s30, s31
  s_add_u32 s30, s30, s29
  s_lshl_b32 s30, s30, 1
  s_lshr_b32 s31, s3, 2
  s_add_u32 s30, s30, s31
  s_mul_i32 s30, s30, 1152
  s_mul_i32 s31, s28, 20480
  s_lshl_b32 s32, s29, 5
  s_add_u32 s31, s31, s32
  s_add_u32 s33, s3, 1
  s_lshl_b32 s32, s33, 11
  s_add_u32 s32, s32, s31
  s_mul_i32 s33, s33, 1040
  s_mov_b32 m0, s33
  v_and_b32 v1, 63, v0
  v_and_b32 v2, 15, v0
  v_bfe_u32 v3, v0, 4, 2
  v_lshlrev_b32 v4, 2, v1
  v_lshlrev_b32 v5, 4, v1
  v_lshlrev_b32 v6, 5, v1
  v_and_b32 v7, 16, v5
  v_sub_u32 v126, v6, v7
  v_mov_b32 v12, 0
  v_mov_b32 v26, 0
  v_mov_b32 v27, 0
  v_mov_b32 v28, 0
  v_mov_b32 v32, 0
  v_mov_b32 v33, 0
  v_mov_b32 v34, 0
  v_mov_b32 v35, 0
  v_mov_b32 v36, 0
  v_mov_b32 v37, 0
  v_mov_b32 v38, 0
  v_mov_b32 v39, 0
  v_cvt_f32_u32 v6, v2
  v_lshlrev_b32 v7, 2, v3
  v_cvt_f32_u32 v7, v7
  v_add_f32 v6, v6, v6
  s_mov_b32 s40, 0x35e38e39
  v_add_f32 v99, 0x0, v7
  v_mul_f32 v99, v99, v6
  v_mul_f32 v98, 0x3ae38e39, v99
  v_mul_f32 v99, 0x3d000000, v99
  v_cos_f32 v64, v98
  v_sin_f32 v65, v98
  v_cos_f32 v88, v99
  v_sin_f32 v92, v99
  v_add_f32 v99, 0x3f800000, v7
  v_mul_f32 v99, v99, v6
  v_mul_f32 v98, 0x3ae38e39, v99
  v_mul_f32 v99, 0x3d000000, v99
  v_cos_f32 v66, v98
  v_sin_f32 v67, v98
  v_cos_f32 v89, v99
  v_sin_f32 v93, v99
  v_add_f32 v99, 0x40000000, v7
  v_mul_f32 v99, v99, v6
  v_mul_f32 v98, 0x3ae38e39, v99
  v_mul_f32 v99, 0x3d000000, v99
  v_cos_f32 v68, v98
  v_sin_f32 v69, v98
  v_cos_f32 v90, v99
  v_sin_f32 v94, v99
  v_add_f32 v99, 0x40400000, v7
  v_mul_f32 v99, v99, v6
  v_mul_f32 v98, 0x3ae38e39, v99
  v_mul_f32 v99, 0x3d000000, v99
  v_cos_f32 v70, v98
  v_sin_f32 v71, v98
  v_cos_f32 v91, v99
  v_sin_f32 v95, v99
  v_cvt_pk_bf16_f32 v40, v88, -v92
  v_cvt_pk_bf16_f32 v44, v92, v88
  v_cvt_pk_bf16_f32 v41, v89, -v93
  v_cvt_pk_bf16_f32 v45, v93, v89
  v_cvt_pk_bf16_f32 v42, v90, -v94
  v_cvt_pk_bf16_f32 v46, v94, v90
  v_cvt_pk_bf16_f32 v43, v91, -v95
  v_cvt_pk_bf16_f32 v47, v95, v91
  v_add_f32 v6, 1.0, v6
  v_add_f32 v99, 0x0, v7
  v_mul_f32 v99, v99, v6
  v_mul_f32 v98, 0x3ae38e39, v99
  v_mul_f32 v99, 0x3d000000, v99
  v_cos_f32 v72, v98
  v_sin_f32 v73, v98
  v_cos_f32 v88, v99
  v_sin_f32 v92, v99
  v_add_f32 v99, 0x3f800000, v7
  v_mul_f32 v99, v99, v6
  v_mul_f32 v98, 0x3ae38e39, v99
  v_mul_f32 v99, 0x3d000000, v99
  v_cos_f32 v74, v98
  v_sin_f32 v75, v98
  s_waitcnt lgkmcnt(0)
  s_add_u32 s16, s4, 0x700000
  s_addc_u32 s17, s5, 0
  s_mov_b32 s18, 0x280000
  s_mov_b32 s19, 0x20000
  buffer_load_dwordx4 v126, s[16:19], s32 offen lds
  s_cmp_ge_u32 s3, 2
  s_cbranch_scc1 k3_irdft_kernel_x4
  s_mul_i32 s33, s3, 9360
  s_mov_b32 m0, s33
  s_mul_i32 s33, s3, 18432
  s_add_u32 s33, s33, s31
  buffer_load_dwordx4 v126, s[16:19], s33 offen lds
k3_irdft_kernel_x4:
  s_mov_b32 s8, s6
  s_mov_b32 s9, s7
  s_mov_b32 s10, 0x240000
  s_mov_b32 s11, 0x20000
  s_add_u32 s12, s4, 0x8000
  s_addc_u32 s13, s5, 0
  s_mov_b32 s14, 0x2000
  s_mov_b32 s15, 0x20000
  buffer_load_dword v8, v4, s[8:11], s30 offen offset:0
  buffer_load_dword v9, v4, s[8:11], s30 offen offset:256
  buffer_load_dword v10, v4, s[8:11], s30 offen offset:512
  buffer_load_dword v11, v4, s[8:11], s30 offen offset:768
  s_mov_b32 exec_hi, 0
  buffer_load_dword v12, v4, s[8:11], s30 offen offset:1024
  s_movk_i32 s33, 4096
  buffer_load_dwordx3 v[26:28], v5, s[12:15], s33 offen
  s_mov_b32 exec_hi, -1
  buffer_load_dwordx3 v[14:16], v5, s[12:15], 0 offen offset:0
  buffer_load_dwordx3 v[18:20], v5, s[12:15], 0 offen offset:1024
  buffer_load_dwordx3 v[22:24], v5, s[12:15], 0 offen offset:2048
  buffer_load_dwordx3 v[122:124], v5, s[12:15], 0 offen offset:3072
  v_lshlrev_b32 v126, 6, v1
  s_bitcmp1_b32 s3, 0
  s_cselect_b32 s16, s26, s24
  s_cselect_b32 s17, s27, s25
  s_lshr_b32 s24, s2, 3
  s_cmp_lt_u32 s24, 32
  s_cselect_b32 s18, 0x510000, 0
  s_cmp_ge_u32 s3, 6
  s_cselect_b32 s18, s18, 0
  s_mov_b32 s19, 0x20000
  s_add_u32 s24, s24, 0
  s_lshl_b32 s24, s24, 6
  s_and_b32 s25, s2, 7
  s_mul_i32 s25, s25, 2304
  v_lshrrev_b32 v126, 6, v126
  v_add_u32 v126, s24, v126
  v_mul_u32_u24 v127, 3641, v126
  v_lshrrev_b32 v127, 16, v127
  v_mul_u32_u24 v127, 16128, v127
  v_lshl_add_u32 v126, v126, 7, s25
  v_add_u32 v126, v126, v127
  v_cos_f32 v89, v99
  v_sin_f32 v93, v99
  v_add_f32 v99, 0x40000000, v7
  v_mul_f32 v99, v99, v6
  v_mul_f32 v98, 0x3ae38e39, v99
  v_mul_f32 v99, 0x3d000000, v99
  v_cos_f32 v76, v98
  v_sin_f32 v77, v98
  v_cos_f32 v90, v99
  v_sin_f32 v94, v99
  v_add_f32 v99, 0x40400000, v7
  v_mul_f32 v99, v99, v6
  v_mul_f32 v98, 0x3ae38e39, v99
  v_mul_f32 v99, 0x3d000000, v99
  v_cos_f32 v78, v98
  v_sin_f32 v79, v98
  buffer_load_dword v126, v126, s[16:19], 0 offen
  v_cos_f32 v91, v99
  v_sin_f32 v95, v99
  v_cvt_pk_bf16_f32 v48, v88, -v92
  v_cvt_pk_bf16_f32 v52, v92, v88
  v_cvt_pk_bf16_f32 v49, v89, -v93
  v_cvt_pk_bf16_f32 v53, v93, v89
  v_cvt_pk_bf16_f32 v50, v90, -v94
  v_cvt_pk_bf16_f32 v54, v94, v90
  v_cvt_pk_bf16_f32 v51, v91, -v95
  v_cvt_pk_bf16_f32 v55, v95, v91
  v_xor_b32 v56, 0x80008000, v48
  v_xor_b32 v57, 0x80008000, v49
  v_xor_b32 v58, 0x80008000, v50
  v_xor_b32 v59, 0x80008000, v51
  v_xor_b32 v60, 0x80008000, v52
  v_xor_b32 v61, 0x80008000, v53
  v_xor_b32 v62, 0x80008000, v54
  v_xor_b32 v63, 0x80008000, v55
  v_mul_f32 v64, s40, v64
  v_mul_f32 v65, s40, v65
  v_mul_f32 v66, s40, v66
  v_mul_f32 v67, s40, v67
  v_mul_f32 v68, s40, v68
  v_mul_f32 v69, s40, v69
  v_mul_f32 v70, s40, v70
  v_mul_f32 v71, s40, v71
  v_mul_f32 v72, s40, v72
  v_mul_f32 v73, s40, v73
  v_mul_f32 v74, s40, v74
  v_mul_f32 v75, s40, v75
  v_mul_f32 v76, s40, v76
  v_mul_f32 v77, s40, v77
  v_mul_f32 v78, s40, v78
  v_mul_f32 v79, s40, v79
  v_and_b32 v6, 3, v2
  v_lshrrev_b32 v99, 2, v2
  v_lshl_add_u32 v6, v6, 2, v99
  v_cvt_f32_u32 v6, v6
  v_mul_f32 v96, 0x3d638e39, v6
  v_mul_f32 v97, v96, v7
  v_cos_f32 v88, v97
  v_sin_f32 v92, v97
  v_fmamk_f32 v98, v96, 0x3f800000, v97
  v_cos_f32 v89, v98
  v_sin_f32 v93, v98
  v_fmamk_f32 v98, v96, 0x40000000, v97
  v_cos_f32 v90, v98
  v_sin_f32 v94, v98
  v_fmamk_f32 v98, v96, 0x40400000, v97
  v_cos_f32 v91, v98
  v_sin_f32 v95, v98
  v_cvt_pk_bf16_f32 v80, v88, v89
  v_cvt_pk_bf16_f32 v81, v90, v91
  v_cvt_pk_bf16_f32 v82, -v92, -v93
  v_cvt_pk_bf16_f32 v83, -v94, -v95
  v_add_f32 v6, 0x41800000, v6
  v_mul_f32 v96, 0x3d638e39, v6
  v_mul_f32 v97, v96, v7
  v_cos_f32 v88, v97
  v_sin_f32 v92, v97
  v_fmamk_f32 v98, v96, 0x3f800000, v97
  v_cos_f32 v89, v98
  v_sin_f32 v93, v98
  v_fmamk_f32 v98, v96, 0x40000000, v97
  v_cos_f32 v90, v98
  v_sin_f32 v94, v98
  v_fmamk_f32 v98, v96, 0x40400000, v97
  v_cos_f32 v91, v98
  v_sin_f32 v95, v98
  v_cvt_pk_bf16_f32 v84, v88, v89
  v_cvt_pk_bf16_f32 v85, v90, v91
  v_cvt_pk_bf16_f32 v86, -v92, -v93
  v_cvt_pk_bf16_f32 v87, -v94, -v95
  s_add_u32 s20, s4, 0xa00000
  s_addc_u32 s21, s5, 0
  s_mov_b32 s22, 0x240000
  s_mov_b32 s23, 0x20000
  s_add_u32 s24, s4, 0xd00000
  s_addc_u32 s25, s5, 0
  s_mov_b32 s26, 0x240000
  s_mov_b32 s27, 0x20000
  v_mul_u32_u24 v2, 1040, v2
  v_lshl_add_u32 v2, v3, 7, v2
  s_lshl_b32 s33, s3, 2
  v_add_u32 v2, s33, v2
  s_mul_i32 s33, s3, 1168
  v_add_u32 v4, s33, v4
  s_waitcnt vmcnt(11)
  s_barrier
  s_mov_b32 exec_lo, 0x3ff03ff
  s_mov_b32 exec_hi, 0x3ff03ff
  ds_read2_b32 v[32:33], v2 offset0:0 offset1:8
  ds_read2_b32 v[34:35], v2 offset0:16 offset1:24
  s_mov_b32 exec_lo, 0x1fe01fe
  s_mov_b32 exec_hi, 0x1fe01fe
  ds_read2_b32 v[36:37], v2 offset0:128 offset1:136
  ds_read2_b32 v[38:39], v2 offset0:144 offset1:152
  s_mov_b64 exec, 1
  ds_read_b32 v36, v2 offset:512
  s_mov_b64 exec, -1
  v_and_b32 v5, 7, v0
  v_lshrrev_b32 v6, 3, v0
  v_mul_u32_u24 v3, 1168, v5
  v_lshlrev_b32 v5, 4, v5
  v_lshl_add_u32 v1, v6, 4, v3
  v_and_b32 v7, 3, v6
  v_lshlrev_b32 v7, 3, v7
  v_sub_u32 v3, v1, v7
  v_lshl_add_u32 v127, v6, 9, v5
  v_lshl_add_u32 v5, v6, 8, v5
  s_lshr_b32 s34, s28, 1
  s_mul_i32 s34, s34, 36864
  s_and_b32 s35, s28, 1
  s_lshl_b32 s35, s35, 8
  s_add_u32 s34, s34, s35
  s_lshl_b32 s36, s29, 7
  s_add_u32 s34, s34, s36
  s_mul_i32 s35, s28, 18432
  s_add_u32 s35, s35, s36
  s_waitcnt lgkmcnt(3)
  v_mfma_f32_16x16x32_bf16 v[100:103], v[32:35], v[40:43], 0
  v_mfma_f32_16x16x32_bf16 v[104:107], v[32:35], v[44:47], 0
  v_mfma_f32_16x16x32_bf16 v[108:111], v[32:35], v[48:51], 0
  v_mfma_f32_16x16x32_bf16 v[112:115], v[32:35], v[52:55], 0
  s_waitcnt lgkmcnt(0)
  v_mfma_f32_16x16x32_bf16 v[100:103], v[36:39], v[40:43], v[100:103]
  v_mfma_f32_16x16x32_bf16 v[104:107], v[36:39], v[44:47], v[104:107]
  v_mfma_f32_16x16x32_bf16 v[108:111], v[36:39], v[56:59], v[108:111]
  v_mfma_f32_16x16x32_bf16 v[112:115], v[36:39], v[60:63], v[112:115]
  s_waitcnt vmcnt(1)
  s_nop 3
  v_mul_f32 v88, v100, v64
  v_mul_f32 v92, v104, v64
  v_fma_f32 v88, -v104, v65, v88
  v_fmac_f32 v92, v100, v65
  v_mul_f32 v89, v101, v66
  v_mul_f32 v93, v105, v66
  v_fma_f32 v89, -v105, v67, v89
  v_fmac_f32 v93, v101, v67
  v_mul_f32 v90, v102, v68
  v_mul_f32 v94, v106, v68
  v_fma_f32 v90, -v106, v69, v90
  v_fmac_f32 v94, v102, v69
  v_mul_f32 v91, v103, v70
  v_mul_f32 v95, v107, v70
  v_fma_f32 v91, -v107, v71, v91
  v_fmac_f32 v95, v103, v71
  v_cvt_pk_bf16_f32 v32, v88, v89
  v_cvt_pk_bf16_f32 v33, v90, v91
  v_cvt_pk_bf16_f32 v34, v92, v93
  v_cvt_pk_bf16_f32 v35, v94, v95
  s_nop 1
  v_mfma_f32_16x16x32_bf16 v[40:43], v[80:83], v[32:35], 0
  v_mfma_f32_16x16x32_bf16 v[44:47], v[84:87], v[32:35], 0
  v_mul_f32 v88, v108, v72
  v_mul_f32 v92, v112, v72
  v_fma_f32 v88, -v112, v73, v88
  v_fmac_f32 v92, v108, v73
  v_mul_f32 v89, v109, v74
  v_mul_f32 v93, v113, v74
  v_fma_f32 v89, -v113, v75, v89
  v_fmac_f32 v93, v109, v75
  v_mul_f32 v90, v110, v76
  v_mul_f32 v94, v114, v76
  v_fma_f32 v90, -v114, v77, v90
  v_fmac_f32 v94, v110, v77
  v_mul_f32 v91, v111, v78
  v_mul_f32 v95, v115, v78
  v_fma_f32 v91, -v115, v79, v91
  v_fmac_f32 v95, v111, v79
  v_cvt_pk_bf16_f32 v36, v88, v89
  v_cvt_pk_bf16_f32 v37, v90, v91
  v_cvt_pk_bf16_f32 v38, v92, v93
  v_cvt_pk_bf16_f32 v39, v94, v95
  s_nop 1
  v_mfma_f32_16x16x32_bf16 v[48:51], v[80:83], v[36:39], 0
  v_mfma_f32_16x16x32_bf16 v[52:55], v[84:87], v[36:39], 0
  v_lshlrev_b32 v64, 16, v8
  v_and_b32 v65, 0xffff0000, v8
  v_lshlrev_b32 v88, 16, v14
  v_and_b32 v89, 0xffff0000, v14
  v_lshlrev_b32 v66, 16, v9
  v_and_b32 v67, 0xffff0000, v9
  v_lshlrev_b32 v90, 16, v18
  v_and_b32 v91, 0xffff0000, v18
  v_lshlrev_b32 v68, 16, v10
  v_and_b32 v69, 0xffff0000, v10
  v_lshlrev_b32 v92, 16, v22
  v_and_b32 v93, 0xffff0000, v22
  v_lshlrev_b32 v70, 16, v11
  v_and_b32 v71, 0xffff0000, v11
  v_lshlrev_b32 v94, 16, v122
  v_and_b32 v95, 0xffff0000, v122
  v_lshlrev_b32 v72, 16, v12
  v_and_b32 v73, 0xffff0000, v12
  v_lshlrev_b32 v96, 16, v26
  v_and_b32 v97, 0xffff0000, v26
  v_fmac_f32 v64, v88, v40
  v_fmac_f32 v66, v90, v41
  v_fmac_f32 v68, v92, v42
  v_fmac_f32 v70, v94, v43
  v_fmac_f32 v72, v96, v44
  v_fmac_f32 v65, v89, v48
  v_fmac_f32 v67, v91, v49
  v_fmac_f32 v69, v93, v50
  v_fmac_f32 v71, v95, v51
  v_fmac_f32 v73, v97, v52
  v_cvt_pk_bf16_f32 v8, v64, v65
  v_cvt_pk_bf16_f32 v9, v66, v67
  v_cvt_pk_bf16_f32 v10, v68, v69
  v_cvt_pk_bf16_f32 v11, v70, v71
  v_cvt_pk_bf16_f32 v12, v72, v73
  v_add_u32 v4, 10400, v4
  v_lshlrev_b32 v64, 16, v8
  v_and_b32 v65, 0xffff0000, v8
  v_lshlrev_b32 v66, 16, v9
  v_and_b32 v67, 0xffff0000, v9
  v_lshlrev_b32 v68, 16, v10
  v_and_b32 v69, 0xffff0000, v10
  v_lshlrev_b32 v70, 16, v11
  v_and_b32 v71, 0xffff0000, v11
  v_lshlrev_b32 v72, 16, v12
  v_and_b32 v73, 0xffff0000, v12
  ds_write2st64_b32 v4, v8, v9 offset0:0 offset1:1
  ds_write2st64_b32 v4, v10, v11 offset0:2 offset1:3
  s_mov_b32 exec_hi, 0
  ds_write_b32 v4, v12 offset:1024
  s_mov_b32 exec_hi, -1
  v_add_f32 v74, v64, v65
  v_add_f32 v76, v66, v67
  v_add_f32 v75, v68, v69
  v_add_f32 v74, v74, v70
  v_add_f32 v76, v76, v71
  v_add_f32 v75, v75, v72
  v_add_f32 v74, v74, v73
  v_add_f32 v76, v76, v75
  v_add_f32 v74, v74, v76
  v_lshlrev_b32 v88, 16, v15
  v_and_b32 v89, 0xffff0000, v15
  v_add_f32_dpp v74, v74, v74 row_ror:8 row_mask:0xf bank_mask:0xf
  v_lshlrev_b32 v100, 16, v16
  v_and_b32 v101, 0xffff0000, v16
  v_add_f32_dpp v74, v74, v74 row_ror:4 row_mask:0xf bank_mask:0xf
  v_lshlrev_b32 v90, 16, v19
  v_and_b32 v91, 0xffff0000, v19
  v_add_f32_dpp v74, v74, v74 row_ror:2 row_mask:0xf bank_mask:0xf
  v_lshlrev_b32 v102, 16, v20
  v_and_b32 v103, 0xffff0000, v20
  v_add_f32_dpp v74, v74, v74 row_ror:1 row_mask:0xf bank_mask:0xf
  v_lshlrev_b32 v92, 16, v23
  v_and_b32 v93, 0xffff0000, v23
  v_add_f32_dpp v74, v74, v74 row_bcast:15 row_mask:0xa bank_mask:0xf
  v_lshlrev_b32 v104, 16, v24
  v_and_b32 v105, 0xffff0000, v24
  v_add_f32_dpp v74, v74, v74 row_bcast:31 row_mask:0xc bank_mask:0xf
  v_lshlrev_b32 v94, 16, v123
  v_readlane_b32 s33, v74, 63
  v_and_b32 v95, 0xffff0000, v123
  v_lshlrev_b32 v106, 16, v124
  v_mov_b32 v74, 0x3ae38e39
  v_mul_f32 v74, s33, v74
  v_sub_f32 v64, v64, v74
  v_sub_f32 v65, v65, v74
  v_sub_f32 v66, v66, v74
  v_sub_f32 v67, v67, v74
  v_sub_f32 v68, v68, v74
  v_sub_f32 v69, v69, v74
  v_sub_f32 v70, v70, v74
  v_sub_f32 v71, v71, v74
  s_mov_b32 exec_hi, 0
  v_sub_f32 v72, v72, v74
  v_sub_f32 v73, v73, v74
  s_mov_b32 exec_hi, -1
  v_mul_f32 v75, v64, v64
  v_mul_f32 v76, v65, v65
  v_fmac_f32 v75, v66, v66
  v_fmac_f32 v76, v67, v67
  v_fmac_f32 v75, v68, v68
  v_fmac_f32 v76, v69, v69
  v_fmac_f32 v75, v70, v70
  v_fmac_f32 v76, v71, v71
  v_fmac_f32 v75, v72, v72
  v_fmac_f32 v76, v73, v73
  v_add_f32 v75, v75, v76
  v_cvt_pk_bf16_f32 v76, v74, v74
  v_lshlrev_b32 v76, 16, v76
  v_sub_f32 v74, v74, v76
  v_and_b32 v107, 0xffff0000, v124
  v_lshlrev_b32 v96, 16, v27
  v_add_f32_dpp v75, v75, v75 row_ror:8 row_mask:0xf bank_mask:0xf
  v_and_b32 v97, 0xffff0000, v27
  v_lshlrev_b32 v108, 16, v28
  v_add_f32_dpp v75, v75, v75 row_ror:4 row_mask:0xf bank_mask:0xf
  v_and_b32 v109, 0xffff0000, v28
  v_add_u32 v4, 9344, v4
  v_add_f32_dpp v75, v75, v75 row_ror:2 row_mask:0xf bank_mask:0xf
  s_nop 1
  v_add_f32_dpp v75, v75, v75 row_ror:1 row_mask:0xf bank_mask:0xf
  s_nop 1
  v_add_f32_dpp v75, v75, v75 row_bcast:15 row_mask:0xa bank_mask:0xf
  s_nop 1
  v_add_f32_dpp v75, v75, v75 row_bcast:31 row_mask:0xc bank_mask:0xf
  s_nop 0
  v_readlane_b32 s33, v75, 63
  v_mov_b32 v75, 0x3ae38e39
  s_nop 0
  v_mul_f32 v75, s33, v75
  v_cvt_pk_bf16_f32 v75, v75, v75
  v_lshlrev_b32 v75, 16, v75
  v_add_f32 v75, 0x3727c5ac, v75
  v_cvt_pk_bf16_f32 v75, v75, v75
  v_lshlrev_b32 v75, 16, v75
  v_sqrt_f32 v75, v75
  s_nop 0
  v_cvt_pk_bf16_f32 v75, v75, v75
  v_lshlrev_b32 v75, 16, v75
  v_rcp_f32 v75, v75
  s_nop 0
  v_mul_f32 v74, v74, v75
  v_fma_f32 v64, v64, v75, v74
  v_fma_f32 v65, v65, v75, v74
  v_fma_f32 v66, v66, v75, v74
  v_fma_f32 v67, v67, v75, v74
  v_fma_f32 v68, v68, v75, v74
  v_fma_f32 v69, v69, v75, v74
  v_fma_f32 v70, v70, v75, v74
  v_fma_f32 v71, v71, v75, v74
  v_fma_f32 v72, v72, v75, v74
  v_fma_f32 v73, v73, v75, v74
  v_fma_f32 v64, v64, v88, v100
  v_fma_f32 v65, v65, v89, v101
  v_fma_f32 v66, v66, v90, v102
  v_fma_f32 v67, v67, v91, v103
  v_fma_f32 v68, v68, v92, v104
  v_fma_f32 v69, v69, v93, v105
  v_fma_f32 v70, v70, v94, v106
  v_fma_f32 v71, v71, v95, v107
  v_fma_f32 v72, v72, v96, v108
  v_fma_f32 v73, v73, v97, v109
  v_cvt_pk_bf16_f32 v32, v64, v65
  v_cvt_pk_bf16_f32 v33, v66, v67
  v_cvt_pk_bf16_f32 v34, v68, v69
  v_cvt_pk_bf16_f32 v35, v70, v71
  v_cvt_pk_bf16_f32 v36, v72, v73
  ds_write2st64_b32 v4, v32, v33 offset0:0 offset1:1
  ds_write2st64_b32 v4, v34, v35 offset0:2 offset1:3
  s_mov_b32 exec_hi, 0
  ds_write_b32 v4, v36 offset:1024
  s_mov_b32 exec_hi, -1
  v_add_u32 v3, 19744, v3
  s_waitcnt lgkmcnt(0)
  s_barrier
  ds_read2_b64 v[8:11], v3 offset0:0 offset1:4
  ds_read_b128 v[12:15], v1 offset:10400
  s_cmp_lg_u32 s3, 0
  s_cbranch_scc1 k3_irdft_kernel_x5
  ds_read2_b64 v[16:19], v3 offset0:128 offset1:132
  ds_read_b128 v[20:23], v1 offset:11424
  s_add_u32 s36, s35, 16384
  s_add_u32 s37, s34, 32768
  s_waitcnt lgkmcnt(0)
  buffer_store_dwordx4 v[16:19], v5, s[24:27], s36 offen sc0 sc1
  buffer_store_dwordx4 v[20:23], v127, s[20:23], s37 offen sc0 sc1
k3_irdft_kernel_x5:
  s_waitcnt lgkmcnt(1)
  buffer_store_dwordx4 v[8:11], v5, s[24:27], s35 offen sc0 sc1
  s_waitcnt lgkmcnt(0)
  buffer_store_dwordx4 v[12:15], v127, s[20:23], s34 offen sc0 sc1
k3_irdft_kernel_end1:
  s_endpgm
k3_irdft_kernel_eoc:
.globl k4_up_kernel
.p2align 8
.type k4_up_kernel,@function
k4_up_kernel:
  s_load_dwordx2 s[4:5], s[0:1], 88
  s_load_dwordx4 s[8:11], s[0:1], 32
  s_load_dwordx2 s[6:7], s[0:1], 48
  s_cmp_ge_u32 s2, 16
  s_cbranch_scc1 k4_up_kernel_cpf2
  s_getpc_b64 s[84:85]
k4_up_kernel_here3:
  s_add_u32 s84, s84, k4_up_kernel-k4_up_kernel_here3
  s_addc_u32 s85, s85, -1
  s_mov_b32 s86, k4_up_kernel_eoc-k4_up_kernel
  s_mov_b32 s87, 0x20000
  v_lshlrev_b32 v254, 6, v0
  buffer_load_dword v255, v254, s[84:87], 0 offen
  v_add_u32 v254, 16384, v254
  buffer_load_dword v255, v254, s[84:87], 0 offen
k4_up_kernel_cpf2:
  v_lshrrev_b32 v1, 6, v0
  s_nop 0
  v_readfirstlane_b32 s3, v1
  s_cmp_ge_u32 s2, 256
  s_cbranch_scc1 k4_up_kernel_end1
  s_and_b32 s28, s2, 3
  s_lshl_b32 s28, s28, 3
  s_bfe_u32 s29, s2, 0x30003
  s_add_u32 s28, s28, s29
  s_and_b32 s29, s2, 4
  s_lshr_b32 s30, s2, 6
  s_add_u32 s29, s29, s30
  s_and_b32 s41, s28, 1
  v_and_b32 v1, 63, v0
  v_lshlrev_b32 v240, 4, v1
  v_lshlrev_b32 v252, 3, v1
  v_add_u32 v2, 0, v1
  v_mul_u32_u24 v3, 43691, v2
  v_lshrrev_b32 v3, 19, v3
  v_mul_u32_u24 v4, 12, v3
  v_sub_u32 v4, v2, v4
  v_lshlrev_b32 v4, 4, v4
  v_and_b32 v5, 4, v3
  v_lshlrev_b32 v5, 3, v5
  v_xor_b32 v4, v4, v5
  v_mul_u32_u24 v3, 9216, v3
  v_add_u32 v3, v3, v4
  v_subrev_u32 v241, 0, v3
  v_add_u32 v2, 64, v1
  v_mul_u32_u24 v3, 43691, v2
  v_lshrrev_b32 v3, 19, v3
  v_mul_u32_u24 v4, 12, v3
  v_sub_u32 v4, v2, v4
  v_lshlrev_b32 v4, 4, v4
  v_and_b32 v5, 4, v3
  v_lshlrev_b32 v5, 3, v5
  v_xor_b32 v4, v4, v5
  v_mul_u32_u24 v3, 9216, v3
  v_add_u32 v3, v3, v4
  v_subrev_u32 v242, 1024, v3
  v_add_u32 v2, 128, v1
  v_mul_u32_u24 v3, 43691, v2
  v_lshrrev_b32 v3, 19, v3
  v_mul_u32_u24 v4, 12, v3
  v_sub_u32 v4, v2, v4
  v_lshlrev_b32 v4, 4, v4
  v_and_b32 v5, 4, v3
  v_lshlrev_b32 v5, 3, v5
  v_xor_b32 v4, v4, v5
  v_mul_u32_u24 v3, 9216, v3
  v_add_u32 v3, v3, v4
  v_subrev_u32 v243, 2048, v3
  s_waitcnt lgkmcnt(0)
  s_cmp_ge_u32 s3, 2
  s_cselect_b32 s12, s10, s8
  s_cselect_b32 s13, s11, s9
  s_mov_b32 s14, 0x510000
  s_mov_b32 s15, 0x20000
  s_mul_i32 s31, s3, 3072
  s_and_b32 s30, s3, 1
  s_mul_i32 s33, s28, 288
  s_mul_i32 s32, s30, 147456
  s_add_u32 s32, s32, s33
  s_mul_i32 s42, s41, 96
  s_add_u32 s32, s32, s42
  s_mul_i32 s43, s30, 294912
  s_add_u32 s43, s43, s33
  s_lshl_b32 s42, s42, 1
  s_sub_u32 s42, 192, s42
  s_add_u32 s43, s43, s42
  s_add_u32 s16, s4, 0xd00000
  s_addc_u32 s17, s5, 0
  s_mov_b32 s18, 0x240000
  s_mov_b32 s19, 0x20000
  s_lshl_b32 s34, s29, 4
  s_lshl_b32 s35, s3, 2
  s_add_u32 s34, s34, s35
  s_mul_i32 s35, s34, 18432
  s_add_u32 m0, s31, 0
  s_add_u32 s38, s32, 0
  buffer_load_dwordx4 v241, s[12:15], s38 offen offset:0 lds
  buffer_load_dwordx4 v242, s[12:15], s38 offen offset:1024 lds
  buffer_load_dwordx4 v243, s[12:15], s38 offen offset:2048 lds
  s_add_u32 s39, s35, 0
  buffer_load_dwordx4 a[0:3], v240, s[16:19], s39 offen
  s_add_u32 s39, s35, 18432
  buffer_load_dwordx4 a[4:7], v240, s[16:19], s39 offen
  s_add_u32 s39, s35, 36864
  buffer_load_dwordx4 a[8:11], v240, s[16:19], s39 offen
  s_add_u32 s39, s35, 55296
  buffer_load_dwordx4 a[12:15], v240, s[16:19], s39 offen
  s_add_u32 m0, s31, 12288
  s_add_u32 s38, s32, 294912
  buffer_load_dwordx4 v241, s[12:15], s38 offen offset:0 lds
  buffer_load_dwordx4 v242, s[12:15], s38 offen offset:1024 lds
  buffer_load_dwordx4 v243, s[12:15], s38 offen offset:2048 lds
  s_add_u32 s39, s35, 1024
  buffer_load_dwordx4 a[16:19], v240, s[16:19], s39 offen
  s_add_u32 s39, s35, 19456
  buffer_load_dwordx4 a[20:23], v240, s[16:19], s39 offen
  s_add_u32 s39, s35, 37888
  buffer_load_dwordx4 a[24:27], v240, s[16:19], s39 offen
  s_add_u32 s39, s35, 56320
  buffer_load_dwordx4 a[28:31], v240, s[16:19], s39 offen
  v_add_u32 v2, 0, v1
  v_mul_u32_u24 v3, 43691, v2
  v_lshrrev_b32 v3, 18, v3
  v_mul_u32_u24 v4, 6, v3
  v_sub_u32 v4, v2, v4
  v_lshl_add_u32 v4, s41, 1, v4
  v_subrev_u32 v5, 6, v4
  v_min_u32 v4, v4, v5
  v_mul_u32_u24 v3, 9216, v3
  v_lshl_add_u32 v3, v4, 4, v3
  v_subrev_u32 v244, 0, v3
  v_add_u32 v2, 64, v1
  v_mul_u32_u24 v3, 43691, v2
  v_lshrrev_b32 v3, 18, v3
  v_mul_u32_u24 v4, 6, v3
  v_sub_u32 v4, v2, v4
  v_lshl_add_u32 v4, s41, 1, v4
  v_subrev_u32 v5, 6, v4
  v_min_u32 v4, v4, v5
  v_mul_u32_u24 v3, 9216, v3
  v_lshl_add_u32 v3, v4, 4, v3
  v_subrev_u32 v245, 1024, v3
  v_add_u32 v2, 128, v1
  v_mul_u32_u24 v3, 43691, v2
  v_lshrrev_b32 v3, 18, v3
  v_mul_u32_u24 v4, 6, v3
  v_sub_u32 v4, v2, v4
  v_lshl_add_u32 v4, s41, 1, v4
  v_subrev_u32 v5, 6, v4
  v_min_u32 v4, v4, v5
  v_mul_u32_u24 v3, 9216, v3
  v_lshl_add_u32 v3, v4, 4, v3
  v_subrev_u32 v246, 2048, v3
  v_bfe_u32 v2, v0, 2, 4
  v_and_b32 v4, 3, v0
  v_lshlrev_b32 v4, 3, v4
  v_mul_u32_u24 v3, 96, v2
  v_add_u32 v249, v3, v4
  v_lshl_add_u32 v3, v3, 1, v4
  v_and_b32 v5, 16, v0
  v_lshlrev_b32 v5, 1, v5
  v_add_u32 v247, v3, v5
  v_sub_u32 v248, v3, v5
  s_add_u32 s20, s4, 0x1000000
  s_addc_u32 s21, s5, 0
  s_mov_b32 s22, 0x1200000
  s_mov_b32 s23, 0x20000
  s_mul_i32 s36, s34, 147456
  s_mul_i32 s37, s28, 4608
  s_add_u32 s36, s36, s37
  s_mul_i32 s37, s41, 1536
  s_add_u32 s37, s37, s36
  s_mul_i32 s40, s41, 2560
  s_sub_u32 s40, s36, s40
  s_add_u32 s40, s40, 3072
  s_lshl_b32 s42, s41, 12
  s_sub_u32 s36, s36, s42
  s_add_u32 s36, s36, 4096
  s_waitcnt vmcnt(11)
  s_barrier
  v_add_u32 v250, 0, v247
  v_add_u32 v251, 0, v248
  ds_read_b64_tr_b16 v[224:225], v250 offset:0
  ds_read_b64_tr_b16 v[226:227], v250 offset:3072
  ds_read_b64_tr_b16 v[228:229], v250 offset:6144
  ds_read_b64_tr_b16 v[230:231], v250 offset:9216
  ds_read_b64_tr_b16 v[232:233], v251 offset:32
  ds_read_b64_tr_b16 v[234:235], v251 offset:3104
  s_waitcnt vmcnt(7)
  s_waitcnt lgkmcnt(4)
  v_mfma_f32_16x16x32_bf16 v[0:3], v[224:227], a[0:3], 0
  ds_read_b64_tr_b16 v[236:237], v251 offset:6176
  v_mfma_f32_16x16x32_bf16 v[4:7], v[224:227], a[4:7], 0
  ds_read_b64_tr_b16 v[238:239], v251 offset:9248
  v_mfma_f32_16x16x32_bf16 v[8:11], v[224:227], a[8:11], 0
  s_add_u32 m0, s31, 24576
  s_add_u32 s38, s32, 589824
  buffer_load_dwordx4 v241, s[12:15], s38 offen offset:0 lds
  v_mfma_f32_16x16x32_bf16 v[12:15], v[224:227], a[12:15], 0
  s_waitcnt lgkmcnt(4)
  v_mfma_f32_16x16x32_bf16 v[16:19], v[228:231], a[0:3], 0
  ds_read_b64_tr_b16 v[224:225], v250 offset:64
  v_mfma_f32_16x16x32_bf16 v[20:23], v[228:231], a[4:7], 0
  ds_read_b64_tr_b16 v[226:227], v250 offset:3136
  v_mfma_f32_16x16x32_bf16 v[24:27], v[228:231], a[8:11], 0
  buffer_load_dwordx4 v242, s[12:15], s38 offen offset:1024 lds
  v_mfma_f32_16x16x32_bf16 v[28:31], v[228:231], a[12:15], 0
  s_waitcnt lgkmcnt(4)
  v_mfma_f32_16x16x32_bf16 v[32:35], v[232:235], a[0:3], 0
  ds_read_b64_tr_b16 v[228:229], v250 offset:6208
  v_mfma_f32_16x16x32_bf16 v[36:39], v[232:235], a[4:7], 0
  ds_read_b64_tr_b16 v[230:231], v250 offset:9280
  v_mfma_f32_16x16x32_bf16 v[40:43], v[232:235], a[8:11], 0
  buffer_load_dwordx4 v243, s[12:15], s38 offen offset:2048 lds
  v_mfma_f32_16x16x32_bf16 v[44:47], v[232:235], a[12:15], 0
  s_waitcnt lgkmcnt(4)
  v_mfma_f32_16x16x32_bf16 v[48:51], v[236:239], a[0:3], 0
  ds_read_b64_tr_b16 v[232:233], v251 offset:96
  v_mfma_f32_16x16x32_bf16 v[52:55], v[236:239], a[4:7], 0
  ds_read_b64_tr_b16 v[234:235], v251 offset:3168
  v_mfma_f32_16x16x32_bf16 v[56:59], v[236:239], a[8:11], 0
  v_mfma_f32_16x16x32_bf16 v[60:63], v[236:239], a[12:15], 0
  s_waitcnt lgkmcnt(4)
  v_mfma_f32_16x16x32_bf16 v[64:67], v[224:227], a[0:3], 0
  ds_read_b64_tr_b16 v[236:237], v251 offset:6240
  v_mfma_f32_16x16x32_bf16 v[68:71], v[224:227], a[4:7], 0
  ds_read_b64_tr_b16 v[238:239], v251 offset:9312
  v_mfma_f32_16x16x32_bf16 v[72:75], v[224:227], a[8:11], 0
  s_add_u32 s39, s35, 2048
  buffer_load_dwordx4 a[32:35], v240, s[16:19], s39 offen
  v_mfma_f32_16x16x32_bf16 v[76:79], v[224:227], a[12:15], 0
  s_waitcnt lgkmcnt(4)
  v_mfma_f32_16x16x32_bf16 v[80:83], v[228:231], a[0:3], 0
  ds_read_b64_tr_b16 v[224:225], v250 offset:128
  v_mfma_f32_16x16x32_bf16 v[84:87], v[228:231], a[4:7], 0
  ds_read_b64_tr_b16 v[226:227], v250 offset:3200
  v_mfma_f32_16x16x32_bf16 v[88:91], v[228:231], a[8:11], 0
  s_add_u32 s39, s35, 20480
  buffer_load_dwordx4 a[36:39], v240, s[16:19], s39 offen
  v_mfma_f32_16x16x32_bf16 v[92:95], v[228:231], a[12:15], 0
  s_waitcnt lgkmcnt(4)
  v_mfma_f32_16x16x32_bf16 v[96:99], v[232:235], a[0:3], 0
  ds_read_b64_tr_b16 v[228:229], v250 offset:6272
  v_mfma_f32_16x16x32_bf16 v[100:103], v[232:235], a[4:7], 0
  ds_read_b64_tr_b16 v[230:231], v250 offset:9344
  v_mfma_f32_16x16x32_bf16 v[104:107], v[232:235], a[8:11], 0
  s_add_u32 s39, s35, 38912
  buffer_load_dwordx4 a[40:43], v240, s[16:19], s39 offen
  v_mfma_f32_16x16x32_bf16 v[108:111], v[232:235], a[12:15], 0
  s_waitcnt lgkmcnt(4)
  v_mfma_f32_16x16x32_bf16 v[112:115], v[236:239], a[0:3], 0
  ds_read_b64_tr_b16 v[232:233], v251 offset:160
  v_mfma_f32_16x16x32_bf16 v[116:119], v[236:239], a[4:7], 0
  ds_read_b64_tr_b16 v[234:235], v251 offset:3232
  v_mfma_f32_16x16x32_bf16 v[120:123], v[236:239], a[8:11], 0
  v_mfma_f32_16x16x32_bf16 v[124:127], v[236:239], a[12:15], 0
  s_waitcnt lgkmcnt(4)
  v_mfma_f32_16x16x32_bf16 v[128:131], v[224:227], a[0:3], 0
  ds_read_b64_tr_b16 v[236:237], v251 offset:6304
  v_mfma_f32_16x16x32_bf16 v[132:135], v[224:227], a[4:7], 0
  ds_read_b64_tr_b16 v[238:239], v251 offset:9376
  v_mfma_f32_16x16x32_bf16 v[136:139], v[224:227], a[8:11], 0
  s_add_u32 s39, s35, 57344
  buffer_load_dwordx4 a[44:47], v240, s[16:19], s39 offen
  v_mfma_f32_16x16x32_bf16 v[140:143], v[224:227], a[12:15], 0
  s_waitcnt vmcnt(11)
  s_barrier
  v_add_u32 v250, 12288, v247
  v_add_u32 v251, 12288, v248
  s_waitcnt lgkmcnt(4)
  v_mfma_f32_16x16x32_bf16 v[144:147], v[228:231], a[0:3], 0
  ds_read_b64_tr_b16 v[224:225], v250 offset:0
  v_mfma_f32_16x16x32_bf16 v[148:151], v[228:231], a[4:7], 0
  ds_read_b64_tr_b16 v[226:227], v250 offset:3072
  v_mfma_f32_16x16x32_bf16 v[152:155], v[228:231], a[8:11], 0
  s_add_u32 m0, s31, 36864
  s_add_u32 s38, s32, 884736
  buffer_load_dwordx4 v241, s[12:15], s38 offen offset:0 lds
  v_mfma_f32_16x16x32_bf16 v[156:159], v[228:231], a[12:15], 0
  s_waitcnt lgkmcnt(4)
  v_mfma_f32_16x16x32_bf16 v[160:163], v[232:235], a[0:3], 0
  ds_read_b64_tr_b16 v[228:229], v250 offset:6144
  v_mfma_f32_16x16x32_bf16 v[164:167], v[232:235], a[4:7], 0
  ds_read_b64_tr_b16 v[230:231], v250 offset:9216
  v_mfma_f32_16x16x32_bf16 v[168:171], v[232:235], a[8:11], 0
  buffer_load_dwordx4 v242, s[12:15], s38 offen offset:1024 lds
  v_mfma_f32_16x16x32_bf16 v[172:175], v[232:235], a[12:15], 0
  s_waitcnt lgkmcnt(4)
  v_mfma_f32_16x16x32_bf16 v[176:179], v[236:239], a[0:3], 0
  ds_read_b64_tr_b16 v[232:233], v251 offset:32
  v_mfma_f32_16x16x32_bf16 v[180:183], v[236:239], a[4:7], 0
  ds_read_b64_tr_b16 v[234:235], v251 offset:3104
  v_mfma_f32_16x16x32_bf16 v[184:187], v[236:239], a[8:11], 0
  v_mfma_f32_16x16x32_bf16 v[188:191], v[236:239], a[12:15], 0
  s_waitcnt vmcnt(9)
  s_waitcnt lgkmcnt(4)
  v_mfma_f32_16x16x32_bf16 v[0:3], v[224:227], a[16:19], v[0:3]
  ds_read_b64_tr_b16 v[236:237], v251 offset:6176
  v_mfma_f32_16x16x32_bf16 v[4:7], v[224:227], a[20:23], v[4:7]
  ds_read_b64_tr_b16 v[238:239], v251 offset:9248
  v_mfma_f32_16x16x32_bf16 v[8:11], v[224:227], a[24:27], v[8:11]
  buffer_load_dwordx4 v243, s[12:15], s38 offen offset:2048 lds
  v_mfma_f32_16x16x32_bf16 v[12:15], v[224:227], a[28:31], v[12:15]
  s_waitcnt lgkmcnt(4)
  v_mfma_f32_16x16x32_bf16 v[16:19], v[228:231], a[16:19], v[16:19]
  ds_read_b64_tr_b16 v[224:225], v250 offset:64
  v_mfma_f32_16x16x32_bf16 v[20:23], v[228:231], a[20:23], v[20:23]
  ds_read_b64_tr_b16 v[226:227], v250 offset:3136
  v_mfma_f32_16x16x32_bf16 v[24:27], v[228:231], a[24:27], v[24:27]
  s_add_u32 s39, s35, 3072
  buffer_load_dwordx4 a[48:51], v240, s[16:19], s39 offen
  v_mfma_f32_16x16x32_bf16 v[28:31], v[228:231], a[28:31], v[28:31]
  s_waitcnt lgkmcnt(4)
  v_mfma_f32_16x16x32_bf16 v[32:35], v[232:235], a[16:19], v[32:35]
  ds_read_b64_tr_b16 v[228:229], v250 offset:6208
  v_mfma_f32_16x16x32_bf16 v[36:39], v[232:235], a[20:23], v[36:39]
  ds_read_b64_tr_b16 v[230:231], v250 offset:9280
  v_mfma_f32_16x16x32_bf16 v[40:43], v[232:235], a[24:27], v[40:43]
  s_add_u32 s39, s35, 21504
  buffer_load_dwordx4 a[52:55], v240, s[16:19], s39 offen
  v_mfma_f32_16x16x32_bf16 v[44:47], v[232:235], a[28:31], v[44:47]
  s_waitcnt lgkmcnt(4)
  v_mfma_f32_16x16x32_bf16 v[48:51], v[236:239], a[16:19], v[48:51]
  ds_read_b64_tr_b16 v[232:233], v251 offset:96
  v_mfma_f32_16x16x32_bf16 v[52:55], v[236:239], a[20:23], v[52:55]
  ds_read_b64_tr_b16 v[234:235], v251 offset:3168
  v_mfma_f32_16x16x32_bf16 v[56:59], v[236:239], a[24:27], v[56:59]
  v_mfma_f32_16x16x32_bf16 v[60:63], v[236:239], a[28:31], v[60:63]
  s_waitcnt lgkmcnt(4)
  v_mfma_f32_16x16x32_bf16 v[64:67], v[224:227], a[16:19], v[64:67]
  ds_read_b64_tr_b16 v[236:237], v251 offset:6240
  v_mfma_f32_16x16x32_bf16 v[68:71], v[224:227], a[20:23], v[68:71]
  ds_read_b64_tr_b16 v[238:239], v251 offset:9312
  v_mfma_f32_16x16x32_bf16 v[72:75], v[224:227], a[24:27], v[72:75]
  s_add_u32 s39, s35, 39936
  buffer_load_dwordx4 a[56:59], v240, s[16:19], s39 offen
  v_mfma_f32_16x16x32_bf16 v[76:79], v[224:227], a[28:31], v[76:79]
  s_waitcnt lgkmcnt(4)
  v_mfma_f32_16x16x32_bf16 v[80:83], v[228:231], a[16:19], v[80:83]
  ds_read_b64_tr_b16 v[224:225], v250 offset:128
  v_mfma_f32_16x16x32_bf16 v[84:87], v[228:231], a[20:23], v[84:87]
  ds_read_b64_tr_b16 v[226:227], v250 offset:3200
  v_mfma_f32_16x16x32_bf16 v[88:91], v[228:231], a[24:27], v[88:91]
  s_add_u32 s39, s35, 58368
  buffer_load_dwordx4 a[60:63], v240, s[16:19], s39 offen
  v_mfma_f32_16x16x32_bf16 v[92:95], v[228:231], a[28:31], v[92:95]
  s_waitcnt lgkmcnt(4)
  v_mfma_f32_16x16x32_bf16 v[96:99], v[232:235], a[16:19], v[96:99]
  ds_read_b64_tr_b16 v[228:229], v250 offset:6272
  v_mfma_f32_16x16x32_bf16 v[100:103], v[232:235], a[20:23], v[100:103]
  ds_read_b64_tr_b16 v[230:231], v250 offset:9344
  v_mfma_f32_16x16x32_bf16 v[104:107], v[232:235], a[24:27], v[104:107]
  s_add_u32 m0, s31, 49152
  s_add_u32 s38, s32, 1179648
  buffer_load_dwordx4 v241, s[12:15], s38 offen offset:0 lds
  v_mfma_f32_16x16x32_bf16 v[108:111], v[232:235], a[28:31], v[108:111]
  s_waitcnt lgkmcnt(4)
  v_mfma_f32_16x16x32_bf16 v[112:115], v[236:239], a[16:19], v[112:115]
  ds_read_b64_tr_b16 v[232:233], v251 offset:160
  v_mfma_f32_16x16x32_bf16 v[116:119], v[236:239], a[20:23], v[116:119]
  ds_read_b64_tr_b16 v[234:235], v251 offset:3232
  v_mfma_f32_16x16x32_bf16 v[120:123], v[236:239], a[24:27], v[120:123]
  v_mfma_f32_16x16x32_bf16 v[124:127], v[236:239], a[28:31], v[124:127]
  s_waitcnt lgkmcnt(4)
  v_mfma_f32_16x16x32_bf16 v[128:131], v[224:227], a[16:19], v[128:131]
  ds_read_b64_tr_b16 v[236:237], v251 offset:6304
  v_mfma_f32_16x16x32_bf16 v[132:135], v[224:227], a[20:23], v[132:135]
  ds_read_b64_tr_b16 v[238:239], v251 offset:9376
  v_mfma_f32_16x16x32_bf16 v[136:139], v[224:227], a[24:27], v[136:139]
  buffer_load_dwordx4 v242, s[12:15], s38 offen offset:1024 lds
  v_mfma_f32_16x16x32_bf16 v[140:143], v[224:227], a[28:31], v[140:143]
  s_waitcnt vmcnt(13)
  s_barrier
  v_add_u32 v250, 24576, v247
  v_add_u32 v251, 24576, v248
  s_waitcnt lgkmcnt(4)
  v_mfma_f32_16x16x32_bf16 v[144:147], v[228:231], a[16:19], v[144:147]
  ds_read_b64_tr_b16 v[224:225], v250 offset:0
  v_mfma_f32_16x16x32_bf16 v[148:151], v[228:231], a[20:23], v[148:151]
  ds_read_b64_tr_b16 v[226:227], v250 offset:3072
  v_mfma_f32_16x16x32_bf16 v[152:155], v[228:231], a[24:27], v[152:155]
  buffer_load_dwordx4 v243, s[12:15], s38 offen offset:2048 lds
  v_mfma_f32_16x16x32_bf16 v[156:159], v[228:231], a[28:31], v[156:159]
  s_waitcnt lgkmcnt(4)
  v_mfma_f32_16x16x32_bf16 v[160:163], v[232:235], a[16:19], v[160:163]
  ds_read_b64_tr_b16 v[228:229], v250 offset:6144
  v_mfma_f32_16x16x32_bf16 v[164:167], v[232:235], a[20:23], v[164:167]
  ds_read_b64_tr_b16 v[230:231], v250 offset:9216
  v_mfma_f32_16x16x32_bf16 v[168:171], v[232:235], a[24:27], v[168:171]
  s_add_u32 s39, s35, 4096
  buffer_load_dwordx4 a[64:67], v240, s[16:19], s39 offen
  v_mfma_f32_16x16x32_bf16 v[172:175], v[232:235], a[28:31], v[172:175]
  s_waitcnt lgkmcnt(4)
  v_mfma_f32_16x16x32_bf16 v[176:179], v[236:239], a[16:19], v[176:179]
  ds_read_b64_tr_b16 v[232:233], v251 offset:32
  v_mfma_f32_16x16x32_bf16 v[180:183], v[236:239], a[20:23], v[180:183]
  ds_read_b64_tr_b16 v[234:235], v251 offset:3104
  v_mfma_f32_16x16x32_bf16 v[184:187], v[236:239], a[24:27], v[184:187]
  v_mfma_f32_16x16x32_bf16 v[188:191], v[236:239], a[28:31], v[188:191]
  s_waitcnt vmcnt(11)
  s_waitcnt lgkmcnt(4)
  v_mfma_f32_16x16x32_bf16 v[0:3], v[224:227], a[32:35], v[0:3]
  ds_read_b64_tr_b16 v[236:237], v251 offset:6176
  v_mfma_f32_16x16x32_bf16 v[4:7], v[224:227], a[36:39], v[4:7]
  ds_read_b64_tr_b16 v[238:239], v251 offset:9248
  v_mfma_f32_16x16x32_bf16 v[8:11], v[224:227], a[40:43], v[8:11]
  s_add_u32 s39, s35, 22528
  buffer_load_dwordx4 a[68:71], v240, s[16:19], s39 offen
  v_mfma_f32_16x16x32_bf16 v[12:15], v[224:227], a[44:47], v[12:15]
  s_waitcnt lgkmcnt(4)
  v_mfma_f32_16x16x32_bf16 v[16:19], v[228:231], a[32:35], v[16:19]
  ds_read_b64_tr_b16 v[224:225], v250 offset:64
  v_mfma_f32_16x16x32_bf16 v[20:23], v[228:231], a[36:39], v[20:23]
  ds_read_b64_tr_b16 v[226:227], v250 offset:3136
  v_mfma_f32_16x16x32_bf16 v[24:27], v[228:231], a[40:43], v[24:27]
  s_add_u32 s39, s35, 40960
  buffer_load_dwordx4 a[72:75], v240, s[16:19], s39 offen
  v_mfma_f32_16x16x32_bf16 v[28:31], v[228:231], a[44:47], v[28:31]
  s_waitcnt lgkmcnt(4)
  v_mfma_f32_16x16x32_bf16 v[32:35], v[232:235], a[32:35], v[32:35]
  ds_read_b64_tr_b16 v[228:229], v250 offset:6208
  v_mfma_f32_16x16x32_bf16 v[36:39], v[232:235], a[36:39], v[36:39]
  ds_read_b64_tr_b16 v[230:231], v250 offset:9280
  v_mfma_f32_16x16x32_bf16 v[40:43], v[232:235], a[40:43], v[40:43]
  s_add_u32 s39, s35, 59392
  buffer_load_dwordx4 a[76:79], v240, s[16:19], s39 offen
  v_mfma_f32_16x16x32_bf16 v[44:47], v[232:235], a[44:47], v[44:47]
  s_waitcnt lgkmcnt(4)
  v_mfma_f32_16x16x32_bf16 v[48:51], v[236:239], a[32:35], v[48:51]
  ds_read_b64_tr_b16 v[232:233], v251 offset:96
  v_mfma_f32_16x16x32_bf16 v[52:55], v[236:239], a[36:39], v[52:55]
  ds_read_b64_tr_b16 v[234:235], v251 offset:3168
  v_mfma_f32_16x16x32_bf16 v[56:59], v[236:239], a[40:43], v[56:59]
  v_mfma_f32_16x16x32_bf16 v[60:63], v[236:239], a[44:47], v[60:63]
  s_waitcnt lgkmcnt(4)
  v_mfma_f32_16x16x32_bf16 v[64:67], v[224:227], a[32:35], v[64:67]
  ds_read_b64_tr_b16 v[236:237], v251 offset:6240
  v_mfma_f32_16x16x32_bf16 v[68:71], v[224:227], a[36:39], v[68:71]
  ds_read_b64_tr_b16 v[238:239], v251 offset:9312
  v_mfma_f32_16x16x32_bf16 v[72:75], v[224:227], a[40:43], v[72:75]
  s_add_u32 m0, s31, 61440
  s_add_u32 s38, s32, 1474560
  buffer_load_dwordx4 v241, s[12:15], s38 offen offset:0 lds
  v_mfma_f32_16x16x32_bf16 v[76:79], v[224:227], a[44:47], v[76:79]
  s_waitcnt lgkmcnt(4)
  v_mfma_f32_16x16x32_bf16 v[80:83], v[228:231], a[32:35], v[80:83]
  ds_read_b64_tr_b16 v[224:225], v250 offset:128
  v_mfma_f32_16x16x32_bf16 v[84:87], v[228:231], a[36:39], v[84:87]
  ds_read_b64_tr_b16 v[226:227], v250 offset:3200
  v_mfma_f32_16x16x32_bf16 v[88:91], v[228:231], a[40:43], v[88:91]
  buffer_load_dwordx4 v242, s[12:15], s38 offen offset:1024 lds
  v_mfma_f32_16x16x32_bf16 v[92:95], v[228:231], a[44:47], v[92:95]
  s_waitcnt lgkmcnt(4)
  v_mfma_f32_16x16x32_bf16 v[96:99], v[232:235], a[32:35], v[96:99]
  ds_read_b64_tr_b16 v[228:229], v250 offset:6272
  v_mfma_f32_16x16x32_bf16 v[100:103], v[232:235], a[36:39], v[100:103]
  ds_read_b64_tr_b16 v[230:231], v250 offset:9344
  v_mfma_f32_16x16x32_bf16 v[104:107], v[232:235], a[40:43], v[104:107]
  buffer_load_dwordx4 v243, s[12:15], s38 offen offset:2048 lds
  v_mfma_f32_16x16x32_bf16 v[108:111], v[232:235], a[44:47], v[108:111]
  s_waitcnt lgkmcnt(4)
  v_mfma_f32_16x16x32_bf16 v[112:115], v[236:239], a[32:35], v[112:115]
  ds_read_b64_tr_b16 v[232:233], v251 offset:160
  v_mfma_f32_16x16x32_bf16 v[116:119], v[236:239], a[36:39], v[116:119]
  ds_read_b64_tr_b16 v[234:235], v251 offset:3232
  v_mfma_f32_16x16x32_bf16 v[120:123], v[236:239], a[40:43], v[120:123]
  v_mfma_f32_16x16x32_bf16 v[124:127], v[236:239], a[44:47], v[124:127]
  s_waitcnt lgkmcnt(4)
  v_mfma_f32_16x16x32_bf16 v[128:131], v[224:227], a[32:35], v[128:131]
  ds_read_b64_tr_b16 v[236:237], v251 offset:6304
  v_mfma_f32_16x16x32_bf16 v[132:135], v[224:227], a[36:39], v[132:135]
  ds_read_b64_tr_b16 v[238:239], v251 offset:9376
  v_mfma_f32_16x16x32_bf16 v[136:139], v[224:227], a[40:43], v[136:139]
  s_add_u32 s39, s35, 5120
  buffer_load_dwordx4 a[80:83], v240, s[16:19], s39 offen
  v_mfma_f32_16x16x32_bf16 v[140:143], v[224:227], a[44:47], v[140:143]
  s_waitcnt vmcnt(15)
  s_barrier
  v_add_u32 v250, 36864, v247
  v_add_u32 v251, 36864, v248
  s_waitcnt lgkmcnt(4)
  v_mfma_f32_16x16x32_bf16 v[144:147], v[228:231], a[32:35], v[144:147]
  ds_read_b64_tr_b16 v[224:225], v250 offset:0
  v_mfma_f32_16x16x32_bf16 v[148:151], v[228:231], a[36:39], v[148:151]
  ds_read_b64_tr_b16 v[226:227], v250 offset:3072
  v_mfma_f32_16x16x32_bf16 v[152:155], v[228:231], a[40:43], v[152:155]
  s_add_u32 s39, s35, 23552
  buffer_load_dwordx4 a[84:87], v240, s[16:19], s39 offen
  v_mfma_f32_16x16x32_bf16 v[156:159], v[228:231], a[44:47], v[156:159]
  s_waitcnt lgkmcnt(4)
  v_mfma_f32_16x16x32_bf16 v[160:163], v[232:235], a[32:35], v[160:163]
  ds_read_b64_tr_b16 v[228:229], v250 offset:6144
  v_mfma_f32_16x16x32_bf16 v[164:167], v[232:235], a[36:39], v[164:167]
  ds_read_b64_tr_b16 v[230:231], v250 offset:9216
  v_mfma_f32_16x16x32_bf16 v[168:171], v[232:235], a[40:43], v[168:171]
  s_add_u32 s39, s35, 41984
  buffer_load_dwordx4 a[88:91], v240, s[16:19], s39 offen
  v_mfma_f32_16x16x32_bf16 v[172:175], v[232:235], a[44:47], v[172:175]
  s_waitcnt lgkmcnt(4)
  v_mfma_f32_16x16x32_bf16 v[176:179], v[236:239], a[32:35], v[176:179]
  ds_read_b64_tr_b16 v[232:233], v251 offset:32
  v_mfma_f32_16x16x32_bf16 v[180:183], v[236:239], a[36:39], v[180:183]
  ds_read_b64_tr_b16 v[234:235], v251 offset:3104
  v_mfma_f32_16x16x32_bf16 v[184:187], v[236:239], a[40:43], v[184:187]
  v_mfma_f32_16x16x32_bf16 v[188:191], v[236:239], a[44:47], v[188:191]
  s_waitcnt vmcnt(13)
  s_waitcnt lgkmcnt(4)
  v_mfma_f32_16x16x32_bf16 v[0:3], v[224:227], a[48:51], v[0:3]
  ds_read_b64_tr_b16 v[236:237], v251 offset:6176
  v_mfma_f32_16x16x32_bf16 v[4:7], v[224:227], a[52:55], v[4:7]
  ds_read_b64_tr_b16 v[238:239], v251 offset:9248
  v_mfma_f32_16x16x32_bf16 v[8:11], v[224:227], a[56:59], v[8:11]
  s_add_u32 s39, s35, 60416
  buffer_load_dwordx4 a[92:95], v240, s[16:19], s39 offen
  v_mfma_f32_16x16x32_bf16 v[12:15], v[224:227], a[60:63], v[12:15]
  s_waitcnt lgkmcnt(4)
  v_mfma_f32_16x16x32_bf16 v[16:19], v[228:231], a[48:51], v[16:19]
  ds_read_b64_tr_b16 v[224:225], v250 offset:64
  v_mfma_f32_16x16x32_bf16 v[20:23], v[228:231], a[52:55], v[20:23]
  ds_read_b64_tr_b16 v[226:227], v250 offset:3136
  v_mfma_f32_16x16x32_bf16 v[24:27], v[228:231], a[56:59], v[24:27]
  s_add_u32 m0, s31, 73728
  s_add_u32 s38, s32, 1769472
  buffer_load_dwordx4 v241, s[12:15], s38 offen offset:0 lds
  v_mfma_f32_16x16x32_bf16 v[28:31], v[228:231], a[60:63], v[28:31]
  s_waitcnt lgkmcnt(4)
  v_mfma_f32_16x16x32_bf16 v[32:35], v[232:235], a[48:51], v[32:35]
  ds_read_b64_tr_b16 v[228:229], v250 offset:6208
  v_mfma_f32_16x16x32_bf16 v[36:39], v[232:235], a[52:55], v[36:39]
  ds_read_b64_tr_b16 v[230:231], v250 offset:9280
  v_mfma_f32_16x16x32_bf16 v[40:43], v[232:235], a[56:59], v[40:43]
  buffer_load_dwordx4 v242, s[12:15], s38 offen offset:1024 lds
  v_mfma_f32_16x16x32_bf16 v[44:47], v[232:235], a[60:63], v[44:47]
  s_waitcnt lgkmcnt(4)
  v_mfma_f32_16x16x32_bf16 v[48:51], v[236:239], a[48:51], v[48:51]
  ds_read_b64_tr_b16 v[232:233], v251 offset:96
  v_mfma_f32_16x16x32_bf16 v[52:55], v[236:239], a[52:55], v[52:55]
  ds_read_b64_tr_b16 v[234:235], v251 offset:3168
  v_mfma_f32_16x16x32_bf16 v[56:59], v[236:239], a[56:59], v[56:59]
  v_mfma_f32_16x16x32_bf16 v[60:63], v[236:239], a[60:63], v[60:63]
  s_waitcnt lgkmcnt(4)
  v_mfma_f32_16x16x32_bf16 v[64:67], v[224:227], a[48:51], v[64:67]
  ds_read_b64_tr_b16 v[236:237], v251 offset:6240
  v_mfma_f32_16x16x32_bf16 v[68:71], v[224:227], a[52:55], v[68:71]
  ds_read_b64_tr_b16 v[238:239], v251 offset:9312
  v_mfma_f32_16x16x32_bf16 v[72:75], v[224:227], a[56:59], v[72:75]
  buffer_load_dwordx4 v243, s[12:15], s38 offen offset:2048 lds
  v_mfma_f32_16x16x32_bf16 v[76:79], v[224:227], a[60:63], v[76:79]
  s_waitcnt lgkmcnt(4)
  v_mfma_f32_16x16x32_bf16 v[80:83], v[228:231], a[48:51], v[80:83]
  ds_read_b64_tr_b16 v[224:225], v250 offset:128
  v_mfma_f32_16x16x32_bf16 v[84:87], v[228:231], a[52:55], v[84:87]
  ds_read_b64_tr_b16 v[226:227], v250 offset:3200
  v_mfma_f32_16x16x32_bf16 v[88:91], v[228:231], a[56:59], v[88:91]
  s_add_u32 s39, s35, 6144
  buffer_load_dwordx4 a[96:99], v240, s[16:19], s39 offen
  v_mfma_f32_16x16x32_bf16 v[92:95], v[228:231], a[60:63], v[92:95]
  s_waitcnt lgkmcnt(4)
  v_mfma_f32_16x16x32_bf16 v[96:99], v[232:235], a[48:51], v[96:99]
  ds_read_b64_tr_b16 v[228:229], v250 offset:6272
  v_mfma_f32_16x16x32_bf16 v[100:103], v[232:235], a[52:55], v[100:103]
  ds_read_b64_tr_b16 v[230:231], v250 offset:9344
  v_mfma_f32_16x16x32_bf16 v[104:107], v[232:235], a[56:59], v[104:107]
  s_add_u32 s39, s35, 24576
  buffer_load_dwordx4 a[100:103], v240, s[16:19], s39 offen
  v_mfma_f32_16x16x32_bf16 v[108:111], v[232:235], a[60:63], v[108:111]
  s_waitcnt lgkmcnt(4)
  v_mfma_f32_16x16x32_bf16 v[112:115], v[236:239], a[48:51], v[112:115]
  ds_read_b64_tr_b16 v[232:233], v251 offset:160
  v_mfma_f32_16x16x32_bf16 v[116:119], v[236:239], a[52:55], v[116:119]
  ds_read_b64_tr_b16 v[234:235], v251 offset:3232
  v_mfma_f32_16x16x32_bf16 v[120:123], v[236:239], a[56:59], v[120:123]
  v_mfma_f32_16x16x32_bf16 v[124:127], v[236:239], a[60:63], v[124:127]
  s_waitcnt lgkmcnt(4)
  v_mfma_f32_16x16x32_bf16 v[128:131], v[224:227], a[48:51], v[128:131]
  ds_read_b64_tr_b16 v[236:237], v251 offset:6304
  v_mfma_f32_16x16x32_bf16 v[132:135], v[224:227], a[52:55], v[132:135]
  ds_read_b64_tr_b16 v[238:239], v251 offset:9376
  v_mfma_f32_16x16x32_bf16 v[136:139], v[224:227], a[56:59], v[136:139]
  s_add_u32 s39, s35, 43008
  buffer_load_dwordx4 a[104:107], v240, s[16:19], s39 offen
  v_mfma_f32_16x16x32_bf16 v[140:143], v[224:227], a[60:63], v[140:143]
  s_waitcnt vmcnt(10)
  s_barrier
  v_add_u32 v250, 49152, v247
  v_add_u32 v251, 49152, v248
  s_waitcnt lgkmcnt(4)
  v_mfma_f32_16x16x32_bf16 v[144:147], v[228:231], a[48:51], v[144:147]
  ds_read_b64_tr_b16 v[224:225], v250 offset:0
  v_mfma_f32_16x16x32_bf16 v[148:151], v[228:231], a[52:55], v[148:151]
  ds_read_b64_tr_b16 v[226:227], v250 offset:3072
  v_mfma_f32_16x16x32_bf16 v[152:155], v[228:231], a[56:59], v[152:155]
  s_add_u32 s39, s35, 61440
  buffer_load_dwordx4 a[108:111], v240, s[16:19], s39 offen
  v_mfma_f32_16x16x32_bf16 v[156:159], v[228:231], a[60:63], v[156:159]
  s_waitcnt lgkmcnt(4)
  v_mfma_f32_16x16x32_bf16 v[160:163], v[232:235], a[48:51], v[160:163]
  ds_read_b64_tr_b16 v[228:229], v250 offset:6144
  v_mfma_f32_16x16x32_bf16 v[164:167], v[232:235], a[52:55], v[164:167]
  ds_read_b64_tr_b16 v[230:231], v250 offset:9216
  v_mfma_f32_16x16x32_bf16 v[168:171], v[232:235], a[56:59], v[168:171]
  s_add_u32 m0, s31, 86016
  s_add_u32 s38, s32, 2064384
  buffer_load_dwordx4 v241, s[12:15], s38 offen offset:0 lds
  v_mfma_f32_16x16x32_bf16 v[172:175], v[232:235], a[60:63], v[172:175]
  s_waitcnt lgkmcnt(4)
  v_mfma_f32_16x16x32_bf16 v[176:179], v[236:239], a[48:51], v[176:179]
  ds_read_b64_tr_b16 v[232:233], v251 offset:32
  v_mfma_f32_16x16x32_bf16 v[180:183], v[236:239], a[52:55], v[180:183]
  ds_read_b64_tr_b16 v[234:235], v251 offset:3104
  v_mfma_f32_16x16x32_bf16 v[184:187], v[236:239], a[56:59], v[184:187]
  v_mfma_f32_16x16x32_bf16 v[188:191], v[236:239], a[60:63], v[188:191]
  s_waitcnt lgkmcnt(4)
  v_mfma_f32_16x16x32_bf16 v[0:3], v[224:227], a[64:67], v[0:3]
  ds_read_b64_tr_b16 v[236:237], v251 offset:6176
  v_mfma_f32_16x16x32_bf16 v[4:7], v[224:227], a[68:71], v[4:7]
  ds_read_b64_tr_b16 v[238:239], v251 offset:9248
  v_mfma_f32_16x16x32_bf16 v[8:11], v[224:227], a[72:75], v[8:11]
  buffer_load_dwordx4 v242, s[12:15], s38 offen offset:1024 lds
  v_mfma_f32_16x16x32_bf16 v[12:15], v[224:227], a[76:79], v[12:15]
  s_waitcnt lgkmcnt(4)
  v_mfma_f32_16x16x32_bf16 v[16:19], v[228:231], a[64:67], v[16:19]
  ds_read_b64_tr_b16 v[224:225], v250 offset:64
  v_mfma_f32_16x16x32_bf16 v[20:23], v[228:231], a[68:71], v[20:23]
  ds_read_b64_tr_b16 v[226:227], v250 offset:3136
  v_mfma_f32_16x16x32_bf16 v[24:27], v[228:231], a[72:75], v[24:27]
  buffer_load_dwordx4 v243, s[12:15], s38 offen offset:2048 lds
  v_mfma_f32_16x16x32_bf16 v[28:31], v[228:231], a[76:79], v[28:31]
  s_waitcnt lgkmcnt(4)
  v_mfma_f32_16x16x32_bf16 v[32:35], v[232:235], a[64:67], v[32:35]
  ds_read_b64_tr_b16 v[228:229], v250 offset:6208
  v_mfma_f32_16x16x32_bf16 v[36:39], v[232:235], a[68:71], v[36:39]
  ds_read_b64_tr_b16 v[230:231], v250 offset:9280
  v_mfma_f32_16x16x32_bf16 v[40:43], v[232:235], a[72:75], v[40:43]
  s_add_u32 s39, s35, 7168
  buffer_load_dwordx4 a[112:115], v240, s[16:19], s39 offen
  v_mfma_f32_16x16x32_bf16 v[44:47], v[232:235], a[76:79], v[44:47]
  s_waitcnt lgkmcnt(4)
  v_mfma_f32_16x16x32_bf16 v[48:51], v[236:239], a[64:67], v[48:51]
  ds_read_b64_tr_b16 v[232:233], v251 offset:96
  v_mfma_f32_16x16x32_bf16 v[52:55], v[236:239], a[68:71], v[52:55]
  ds_read_b64_tr_b16 v[234:235], v251 offset:3168
  v_mfma_f32_16x16x32_bf16 v[56:59], v[236:239], a[72:75], v[56:59]
  v_mfma_f32_16x16x32_bf16 v[60:63], v[236:239], a[76:79], v[60:63]
  s_waitcnt lgkmcnt(4)
  v_mfma_f32_16x16x32_bf16 v[64:67], v[224:227], a[64:67], v[64:67]
  ds_read_b64_tr_b16 v[236:237], v251 offset:6240
  v_mfma_f32_16x16x32_bf16 v[68:71], v[224:227], a[68:71], v[68:71]
  ds_read_b64_tr_b16 v[238:239], v251 offset:9312
  v_mfma_f32_16x16x32_bf16 v[72:75], v[224:227], a[72:75], v[72:75]
  s_add_u32 s39, s35, 25600
  buffer_load_dwordx4 a[116:119], v240, s[16:19], s39 offen
  v_mfma_f32_16x16x32_bf16 v[76:79], v[224:227], a[76:79], v[76:79]
  s_waitcnt lgkmcnt(4)
  v_mfma_f32_16x16x32_bf16 v[80:83], v[228:231], a[64:67], v[80:83]
  ds_read_b64_tr_b16 v[224:225], v250 offset:128
  v_mfma_f32_16x16x32_bf16 v[84:87], v[228:231], a[68:71], v[84:87]
  ds_read_b64_tr_b16 v[226:227], v250 offset:3200
  v_mfma_f32_16x16x32_bf16 v[88:91], v[228:231], a[72:75], v[88:91]
  s_add_u32 s39, s35, 44032
  buffer_load_dwordx4 a[120:123], v240, s[16:19], s39 offen
  v_mfma_f32_16x16x32_bf16 v[92:95], v[228:231], a[76:79], v[92:95]
  s_waitcnt lgkmcnt(4)
  v_mfma_f32_16x16x32_bf16 v[96:99], v[232:235], a[64:67], v[96:99]
  ds_read_b64_tr_b16 v[228:229], v250 offset:6272
  v_mfma_f32_16x16x32_bf16 v[100:103], v[232:235], a[68:71], v[100:103]
  ds_read_b64_tr_b16 v[230:231], v250 offset:9344
  v_mfma_f32_16x16x32_bf16 v[104:107], v[232:235], a[72:75], v[104:107]
  s_add_u32 s39, s35, 62464
  buffer_load_dwordx4 a[124:127], v240, s[16:19], s39 offen
  v_mfma_f32_16x16x32_bf16 v[108:111], v[232:235], a[76:79], v[108:111]
  s_waitcnt lgkmcnt(4)
  v_mfma_f32_16x16x32_bf16 v[112:115], v[236:239], a[64:67], v[112:115]
  ds_read_b64_tr_b16 v[232:233], v251 offset:160
  v_mfma_f32_16x16x32_bf16 v[116:119], v[236:239], a[68:71], v[116:119]
  ds_read_b64_tr_b16 v[234:235], v251 offset:3232
  v_mfma_f32_16x16x32_bf16 v[120:123], v[236:239], a[72:75], v[120:123]
  v_mfma_f32_16x16x32_bf16 v[124:127], v[236:239], a[76:79], v[124:127]
  s_waitcnt lgkmcnt(4)
  v_mfma_f32_16x16x32_bf16 v[128:131], v[224:227], a[64:67], v[128:131]
  ds_read_b64_tr_b16 v[236:237], v251 offset:6304
  v_mfma_f32_16x16x32_bf16 v[132:135], v[224:227], a[68:71], v[132:135]
  ds_read_b64_tr_b16 v[238:239], v251 offset:9376
  v_mfma_f32_16x16x32_bf16 v[136:139], v[224:227], a[72:75], v[136:139]
  s_add_u32 m0, s31, 98304
  s_add_u32 s38, s32, 2359296
  buffer_load_dwordx4 v241, s[12:15], s38 offen offset:0 lds
  v_mfma_f32_16x16x32_bf16 v[140:143], v[224:227], a[76:79], v[140:143]
  v_add_u32 v250, 61440, v247
  v_add_u32 v251, 61440, v248
  s_waitcnt lgkmcnt(4)
  v_mfma_f32_16x16x32_bf16 v[144:147], v[228:231], a[64:67], v[144:147]
  ds_read_b64_tr_b16 v[224:225], v250 offset:0
  v_mfma_f32_16x16x32_bf16 v[148:151], v[228:231], a[68:71], v[148:151]
  ds_read_b64_tr_b16 v[226:227], v250 offset:3072
  v_mfma_f32_16x16x32_bf16 v[152:155], v[228:231], a[72:75], v[152:155]
  buffer_load_dwordx4 v242, s[12:15], s38 offen offset:1024 lds
  v_mfma_f32_16x16x32_bf16 v[156:159], v[228:231], a[76:79], v[156:159]
  s_waitcnt lgkmcnt(4)
  v_mfma_f32_16x16x32_bf16 v[160:163], v[232:235], a[64:67], v[160:163]
  ds_read_b64_tr_b16 v[228:229], v250 offset:6144
  v_mfma_f32_16x16x32_bf16 v[164:167], v[232:235], a[68:71], v[164:167]
  ds_read_b64_tr_b16 v[230:231], v250 offset:9216
  v_mfma_f32_16x16x32_bf16 v[168:171], v[232:235], a[72:75], v[168:171]
  buffer_load_dwordx4 v243, s[12:15], s38 offen offset:2048 lds
  v_mfma_f32_16x16x32_bf16 v[172:175], v[232:235], a[76:79], v[172:175]
  s_waitcnt lgkmcnt(4)
  v_mfma_f32_16x16x32_bf16 v[176:179], v[236:239], a[64:67], v[176:179]
  ds_read_b64_tr_b16 v[232:233], v251 offset:32
  v_mfma_f32_16x16x32_bf16 v[180:183], v[236:239], a[68:71], v[180:183]
  ds_read_b64_tr_b16 v[234:235], v251 offset:3104
  v_mfma_f32_16x16x32_bf16 v[184:187], v[236:239], a[72:75], v[184:187]
  v_mfma_f32_16x16x32_bf16 v[188:191], v[236:239], a[76:79], v[188:191]
  s_waitcnt vmcnt(17)
  s_waitcnt lgkmcnt(4)
  v_mfma_f32_16x16x32_bf16 v[0:3], v[224:227], a[80:83], v[0:3]
  ds_read_b64_tr_b16 v[236:237], v251 offset:6176
  v_mfma_f32_16x16x32_bf16 v[4:7], v[224:227], a[84:87], v[4:7]
  ds_read_b64_tr_b16 v[238:239], v251 offset:9248
  v_mfma_f32_16x16x32_bf16 v[8:11], v[224:227], a[88:91], v[8:11]
  s_add_u32 s39, s35, 8192
  buffer_load_dwordx4 a[128:131], v240, s[16:19], s39 offen
  v_mfma_f32_16x16x32_bf16 v[12:15], v[224:227], a[92:95], v[12:15]
  s_waitcnt lgkmcnt(4)
  v_mfma_f32_16x16x32_bf16 v[16:19], v[228:231], a[80:83], v[16:19]
  ds_read_b64_tr_b16 v[224:225], v250 offset:64
  v_mfma_f32_16x16x32_bf16 v[20:23], v[228:231], a[84:87], v[20:23]
  ds_read_b64_tr_b16 v[226:227], v250 offset:3136
  v_mfma_f32_16x16x32_bf16 v[24:27], v[228:231], a[88:91], v[24:27]
  s_add_u32 s39, s35, 26624
  buffer_load_dwordx4 a[132:135], v240, s[16:19], s39 offen
  v_mfma_f32_16x16x32_bf16 v[28:31], v[228:231], a[92:95], v[28:31]
  s_waitcnt lgkmcnt(4)
  v_mfma_f32_16x16x32_bf16 v[32:35], v[232:235], a[80:83], v[32:35]
  ds_read_b64_tr_b16 v[228:229], v250 offset:6208
  v_mfma_f32_16x16x32_bf16 v[36:39], v[232:235], a[84:87], v[36:39]
  ds_read_b64_tr_b16 v[230:231], v250 offset:9280
  v_mfma_f32_16x16x32_bf16 v[40:43], v[232:235], a[88:91], v[40:43]
  s_add_u32 s39, s35, 45056
  buffer_load_dwordx4 a[136:139], v240, s[16:19], s39 offen
  v_mfma_f32_16x16x32_bf16 v[44:47], v[232:235], a[92:95], v[44:47]
  s_waitcnt lgkmcnt(4)
  v_mfma_f32_16x16x32_bf16 v[48:51], v[236:239], a[80:83], v[48:51]
  ds_read_b64_tr_b16 v[232:233], v251 offset:96
  v_mfma_f32_16x16x32_bf16 v[52:55], v[236:239], a[84:87], v[52:55]
  ds_read_b64_tr_b16 v[234:235], v251 offset:3168
  v_mfma_f32_16x16x32_bf16 v[56:59], v[236:239], a[88:91], v[56:59]
  v_mfma_f32_16x16x32_bf16 v[60:63], v[236:239], a[92:95], v[60:63]
  s_waitcnt lgkmcnt(4)
  v_mfma_f32_16x16x32_bf16 v[64:67], v[224:227], a[80:83], v[64:67]
  ds_read_b64_tr_b16 v[236:237], v251 offset:6240
  v_mfma_f32_16x16x32_bf16 v[68:71], v[224:227], a[84:87], v[68:71]
  ds_read_b64_tr_b16 v[238:239], v251 offset:9312
  v_mfma_f32_16x16x32_bf16 v[72:75], v[224:227], a[88:91], v[72:75]
  s_add_u32 s39, s35, 63488
  buffer_load_dwordx4 a[140:143], v240, s[16:19], s39 offen
  v_mfma_f32_16x16x32_bf16 v[76:79], v[224:227], a[92:95], v[76:79]
  s_waitcnt lgkmcnt(4)
  v_mfma_f32_16x16x32_bf16 v[80:83], v[228:231], a[80:83], v[80:83]
  ds_read_b64_tr_b16 v[224:225], v250 offset:128
  v_mfma_f32_16x16x32_bf16 v[84:87], v[228:231], a[84:87], v[84:87]
  ds_read_b64_tr_b16 v[226:227], v250 offset:3200
  v_mfma_f32_16x16x32_bf16 v[88:91], v[228:231], a[88:91], v[88:91]
  s_add_u32 m0, s31, 110592
  s_add_u32 s38, s32, 2654208
  buffer_load_dwordx4 v241, s[12:15], s38 offen offset:0 lds
  v_mfma_f32_16x16x32_bf16 v[92:95], v[228:231], a[92:95], v[92:95]
  s_waitcnt lgkmcnt(4)
  v_mfma_f32_16x16x32_bf16 v[96:99], v[232:235], a[80:83], v[96:99]
  ds_read_b64_tr_b16 v[228:229], v250 offset:6272
  v_mfma_f32_16x16x32_bf16 v[100:103], v[232:235], a[84:87], v[100:103]
  ds_read_b64_tr_b16 v[230:231], v250 offset:9344
  v_mfma_f32_16x16x32_bf16 v[104:107], v[232:235], a[88:91], v[104:107]
  buffer_load_dwordx4 v242, s[12:15], s38 offen offset:1024 lds
  v_mfma_f32_16x16x32_bf16 v[108:111], v[232:235], a[92:95], v[108:111]
  s_waitcnt lgkmcnt(4)
  v_mfma_f32_16x16x32_bf16 v[112:115], v[236:239], a[80:83], v[112:115]
  ds_read_b64_tr_b16 v[232:233], v251 offset:160
  v_mfma_f32_16x16x32_bf16 v[116:119], v[236:239], a[84:87], v[116:119]
  ds_read_b64_tr_b16 v[234:235], v251 offset:3232
  v_mfma_f32_16x16x32_bf16 v[120:123], v[236:239], a[88:91], v[120:123]
  v_mfma_f32_16x16x32_bf16 v[124:127], v[236:239], a[92:95], v[124:127]
  s_waitcnt lgkmcnt(4)
  v_mfma_f32_16x16x32_bf16 v[128:131], v[224:227], a[80:83], v[128:131]
  ds_read_b64_tr_b16 v[236:237], v251 offset:6304
  v_mfma_f32_16x16x32_bf16 v[132:135], v[224:227], a[84:87], v[132:135]
  ds_read_b64_tr_b16 v[238:239], v251 offset:9376
  v_mfma_f32_16x16x32_bf16 v[136:139], v[224:227], a[88:91], v[136:139]
  buffer_load_dwordx4 v243, s[12:15], s38 offen offset:2048 lds
  v_mfma_f32_16x16x32_bf16 v[140:143], v[224:227], a[92:95], v[140:143]
  s_waitcnt vmcnt(14)
  s_barrier
  v_add_u32 v250, 73728, v247
  v_add_u32 v251, 73728, v248
  s_waitcnt lgkmcnt(4)
  v_mfma_f32_16x16x32_bf16 v[144:147], v[228:231], a[80:83], v[144:147]
  ds_read_b64_tr_b16 v[224:225], v250 offset:0
  v_mfma_f32_16x16x32_bf16 v[148:151], v[228:231], a[84:87], v[148:151]
  ds_read_b64_tr_b16 v[226:227], v250 offset:3072
  v_mfma_f32_16x16x32_bf16 v[152:155], v[228:231], a[88:91], v[152:155]
  s_add_u32 s39, s35, 9216
  buffer_load_dwordx4 a[144:147], v240, s[16:19], s39 offen
  v_mfma_f32_16x16x32_bf16 v[156:159], v[228:231], a[92:95], v[156:159]
  s_waitcnt lgkmcnt(4)
  v_mfma_f32_16x16x32_bf16 v[160:163], v[232:235], a[80:83], v[160:163]
  ds_read_b64_tr_b16 v[228:229], v250 offset:6144
  v_mfma_f32_16x16x32_bf16 v[164:167], v[232:235], a[84:87], v[164:167]
  ds_read_b64_tr_b16 v[230:231], v250 offset:9216
  v_mfma_f32_16x16x32_bf16 v[168:171], v[232:235], a[88:91], v[168:171]
  s_add_u32 s39, s35, 27648
  buffer_load_dwordx4 a[148:151], v240, s[16:19], s39 offen
  v_mfma_f32_16x16x32_bf16 v[172:175], v[232:235], a[92:95], v[172:175]
  s_waitcnt lgkmcnt(4)
  v_mfma_f32_16x16x32_bf16 v[176:179], v[236:239], a[80:83], v[176:179]
  ds_read_b64_tr_b16 v[232:233], v251 offset:32
  v_mfma_f32_16x16x32_bf16 v[180:183], v[236:239], a[84:87], v[180:183]
  ds_read_b64_tr_b16 v[234:235], v251 offset:3104
  v_mfma_f32_16x16x32_bf16 v[184:187], v[236:239], a[88:91], v[184:187]
  v_mfma_f32_16x16x32_bf16 v[188:191], v[236:239], a[92:95], v[188:191]
  s_waitcnt lgkmcnt(4)
  v_mfma_f32_16x16x32_bf16 v[0:3], v[224:227], a[96:99], v[0:3]
  ds_read_b64_tr_b16 v[236:237], v251 offset:6176
  v_mfma_f32_16x16x32_bf16 v[4:7], v[224:227], a[100:103], v[4:7]
  ds_read_b64_tr_b16 v[238:239], v251 offset:9248
  v_mfma_f32_16x16x32_bf16 v[8:11], v[224:227], a[104:107], v[8:11]
  s_add_u32 s39, s35, 46080
  buffer_load_dwordx4 a[152:155], v240, s[16:19], s39 offen
  v_mfma_f32_16x16x32_bf16 v[12:15], v[224:227], a[108:111], v[12:15]
  s_waitcnt lgkmcnt(4)
  v_mfma_f32_16x16x32_bf16 v[16:19], v[228:231], a[96:99], v[16:19]
  ds_read_b64_tr_b16 v[224:225], v250 offset:64
  v_mfma_f32_16x16x32_bf16 v[20:23], v[228:231], a[100:103], v[20:23]
  ds_read_b64_tr_b16 v[226:227], v250 offset:3136
  v_mfma_f32_16x16x32_bf16 v[24:27], v[228:231], a[104:107], v[24:27]
  s_add_u32 s39, s35, 64512
  buffer_load_dwordx4 a[156:159], v240, s[16:19], s39 offen
  v_mfma_f32_16x16x32_bf16 v[28:31], v[228:231], a[108:111], v[28:31]
  s_waitcnt lgkmcnt(4)
  v_mfma_f32_16x16x32_bf16 v[32:35], v[232:235], a[96:99], v[32:35]
  ds_read_b64_tr_b16 v[228:229], v250 offset:6208
  v_mfma_f32_16x16x32_bf16 v[36:39], v[232:235], a[100:103], v[36:39]
  ds_read_b64_tr_b16 v[230:231], v250 offset:9280
  v_mfma_f32_16x16x32_bf16 v[40:43], v[232:235], a[104:107], v[40:43]
  s_add_u32 m0, s31, 122880
  s_add_u32 s38, s32, 2949120
  buffer_load_dwordx4 v241, s[12:15], s38 offen offset:0 lds
  v_mfma_f32_16x16x32_bf16 v[44:47], v[232:235], a[108:111], v[44:47]
  s_waitcnt lgkmcnt(4)
  v_mfma_f32_16x16x32_bf16 v[48:51], v[236:239], a[96:99], v[48:51]
  ds_read_b64_tr_b16 v[232:233], v251 offset:96
  v_mfma_f32_16x16x32_bf16 v[52:55], v[236:239], a[100:103], v[52:55]
  ds_read_b64_tr_b16 v[234:235], v251 offset:3168
  v_mfma_f32_16x16x32_bf16 v[56:59], v[236:239], a[104:107], v[56:59]
  v_mfma_f32_16x16x32_bf16 v[60:63], v[236:239], a[108:111], v[60:63]
  s_waitcnt lgkmcnt(4)
  v_mfma_f32_16x16x32_bf16 v[64:67], v[224:227], a[96:99], v[64:67]
  ds_read_b64_tr_b16 v[236:237], v251 offset:6240
  v_mfma_f32_16x16x32_bf16 v[68:71], v[224:227], a[100:103], v[68:71]
  ds_read_b64_tr_b16 v[238:239], v251 offset:9312
  v_mfma_f32_16x16x32_bf16 v[72:75], v[224:227], a[104:107], v[72:75]
  buffer_load_dwordx4 v242, s[12:15], s38 offen offset:1024 lds
  v_mfma_f32_16x16x32_bf16 v[76:79], v[224:227], a[108:111], v[76:79]
  s_waitcnt lgkmcnt(4)
  v_mfma_f32_16x16x32_bf16 v[80:83], v[228:231], a[96:99], v[80:83]
  ds_read_b64_tr_b16 v[224:225], v250 offset:128
  v_mfma_f32_16x16x32_bf16 v[84:87], v[228:231], a[100:103], v[84:87]
  ds_read_b64_tr_b16 v[226:227], v250 offset:3200
  v_mfma_f32_16x16x32_bf16 v[88:91], v[228:231], a[104:107], v[88:91]
  buffer_load_dwordx4 v243, s[12:15], s38 offen offset:2048 lds
  v_mfma_f32_16x16x32_bf16 v[92:95], v[228:231], a[108:111], v[92:95]
  s_waitcnt lgkmcnt(4)
  v_mfma_f32_16x16x32_bf16 v[96:99], v[232:235], a[96:99], v[96:99]
  ds_read_b64_tr_b16 v[228:229], v250 offset:6272
  v_mfma_f32_16x16x32_bf16 v[100:103], v[232:235], a[100:103], v[100:103]
  ds_read_b64_tr_b16 v[230:231], v250 offset:9344
  v_mfma_f32_16x16x32_bf16 v[104:107], v[232:235], a[104:107], v[104:107]
  s_add_u32 s39, s35, 10240
  buffer_load_dwordx4 a[160:163], v240, s[16:19], s39 offen
  v_mfma_f32_16x16x32_bf16 v[108:111], v[232:235], a[108:111], v[108:111]
  s_waitcnt lgkmcnt(4)
  v_mfma_f32_16x16x32_bf16 v[112:115], v[236:239], a[96:99], v[112:115]
  ds_read_b64_tr_b16 v[232:233], v251 offset:160
  v_mfma_f32_16x16x32_bf16 v[116:119], v[236:239], a[100:103], v[116:119]
  ds_read_b64_tr_b16 v[234:235], v251 offset:3232
  v_mfma_f32_16x16x32_bf16 v[120:123], v[236:239], a[104:107], v[120:123]
  v_mfma_f32_16x16x32_bf16 v[124:127], v[236:239], a[108:111], v[124:127]
  s_waitcnt lgkmcnt(4)
  v_mfma_f32_16x16x32_bf16 v[128:131], v[224:227], a[96:99], v[128:131]
  ds_read_b64_tr_b16 v[236:237], v251 offset:6304
  v_mfma_f32_16x16x32_bf16 v[132:135], v[224:227], a[100:103], v[132:135]
  ds_read_b64_tr_b16 v[238:239], v251 offset:9376
  v_mfma_f32_16x16x32_bf16 v[136:139], v[224:227], a[104:107], v[136:139]
  s_add_u32 s39, s35, 28672
  buffer_load_dwordx4 a[164:167], v240, s[16:19], s39 offen
  v_mfma_f32_16x16x32_bf16 v[140:143], v[224:227], a[108:111], v[140:143]
  v_add_u32 v250, 86016, v247
  v_add_u32 v251, 86016, v248
  s_waitcnt lgkmcnt(4)
  v_mfma_f32_16x16x32_bf16 v[144:147], v[228:231], a[96:99], v[144:147]
  ds_read_b64_tr_b16 v[224:225], v250 offset:0
  v_mfma_f32_16x16x32_bf16 v[148:151], v[228:231], a[100:103], v[148:151]
  ds_read_b64_tr_b16 v[226:227], v250 offset:3072
  v_mfma_f32_16x16x32_bf16 v[152:155], v[228:231], a[104:107], v[152:155]
  s_add_u32 s39, s35, 47104
  buffer_load_dwordx4 a[168:171], v240, s[16:19], s39 offen
  v_mfma_f32_16x16x32_bf16 v[156:159], v[228:231], a[108:111], v[156:159]
  s_waitcnt lgkmcnt(4)
  v_mfma_f32_16x16x32_bf16 v[160:163], v[232:235], a[96:99], v[160:163]
  ds_read_b64_tr_b16 v[228:229], v250 offset:6144
  v_mfma_f32_16x16x32_bf16 v[164:167], v[232:235], a[100:103], v[164:167]
  ds_read_b64_tr_b16 v[230:231], v250 offset:9216
  v_mfma_f32_16x16x32_bf16 v[168:171], v[232:235], a[104:107], v[168:171]
  s_add_u32 s39, s35, 65536
  buffer_load_dwordx4 a[172:175], v240, s[16:19], s39 offen
  v_mfma_f32_16x16x32_bf16 v[172:175], v[232:235], a[108:111], v[172:175]
  s_waitcnt lgkmcnt(4)
  v_mfma_f32_16x16x32_bf16 v[176:179], v[236:239], a[96:99], v[176:179]
  ds_read_b64_tr_b16 v[232:233], v251 offset:32
  v_mfma_f32_16x16x32_bf16 v[180:183], v[236:239], a[100:103], v[180:183]
  ds_read_b64_tr_b16 v[234:235], v251 offset:3104
  v_mfma_f32_16x16x32_bf16 v[184:187], v[236:239], a[104:107], v[184:187]
  v_mfma_f32_16x16x32_bf16 v[188:191], v[236:239], a[108:111], v[188:191]
  s_waitcnt vmcnt(21)
  s_waitcnt lgkmcnt(4)
  v_mfma_f32_16x16x32_bf16 v[0:3], v[224:227], a[112:115], v[0:3]
  ds_read_b64_tr_b16 v[236:237], v251 offset:6176
  v_mfma_f32_16x16x32_bf16 v[4:7], v[224:227], a[116:119], v[4:7]
  ds_read_b64_tr_b16 v[238:239], v251 offset:9248
  v_mfma_f32_16x16x32_bf16 v[8:11], v[224:227], a[120:123], v[8:11]
  s_add_u32 m0, s31, 135168
  s_add_u32 s38, s32, 3244032
  buffer_load_dwordx4 v241, s[12:15], s38 offen offset:0 lds
  v_mfma_f32_16x16x32_bf16 v[12:15], v[224:227], a[124:127], v[12:15]
  s_waitcnt lgkmcnt(4)
  v_mfma_f32_16x16x32_bf16 v[16:19], v[228:231], a[112:115], v[16:19]
  ds_read_b64_tr_b16 v[224:225], v250 offset:64
  v_mfma_f32_16x16x32_bf16 v[20:23], v[228:231], a[116:119], v[20:23]
  ds_read_b64_tr_b16 v[226:227], v250 offset:3136
  v_mfma_f32_16x16x32_bf16 v[24:27], v[228:231], a[120:123], v[24:27]
  buffer_load_dwordx4 v242, s[12:15], s38 offen offset:1024 lds
  v_mfma_f32_16x16x32_bf16 v[28:31], v[228:231], a[124:127], v[28:31]
  s_waitcnt lgkmcnt(4)
  v_mfma_f32_16x16x32_bf16 v[32:35], v[232:235], a[112:115], v[32:35]
  ds_read_b64_tr_b16 v[228:229], v250 offset:6208
  v_mfma_f32_16x16x32_bf16 v[36:39], v[232:235], a[116:119], v[36:39]
  ds_read_b64_tr_b16 v[230:231], v250 offset:9280
  v_mfma_f32_16x16x32_bf16 v[40:43], v[232:235], a[120:123], v[40:43]
  buffer_load_dwordx4 v243, s[12:15], s38 offen offset:2048 lds
  v_mfma_f32_16x16x32_bf16 v[44:47], v[232:235], a[124:127], v[44:47]
  s_waitcnt lgkmcnt(4)
  v_mfma_f32_16x16x32_bf16 v[48:51], v[236:239], a[112:115], v[48:51]
  ds_read_b64_tr_b16 v[232:233], v251 offset:96
  v_mfma_f32_16x16x32_bf16 v[52:55], v[236:239], a[116:119], v[52:55]
  ds_read_b64_tr_b16 v[234:235], v251 offset:3168
  v_mfma_f32_16x16x32_bf16 v[56:59], v[236:239], a[120:123], v[56:59]
  v_mfma_f32_16x16x32_bf16 v[60:63], v[236:239], a[124:127], v[60:63]
  s_waitcnt lgkmcnt(4)
  v_mfma_f32_16x16x32_bf16 v[64:67], v[224:227], a[112:115], v[64:67]
  ds_read_b64_tr_b16 v[236:237], v251 offset:6240
  v_mfma_f32_16x16x32_bf16 v[68:71], v[224:227], a[116:119], v[68:71]
  ds_read_b64_tr_b16 v[238:239], v251 offset:9312
  v_mfma_f32_16x16x32_bf16 v[72:75], v[224:227], a[120:123], v[72:75]
  s_add_u32 s39, s35, 11264
  buffer_load_dwordx4 a[176:179], v240, s[16:19], s39 offen
  v_mfma_f32_16x16x32_bf16 v[76:79], v[224:227], a[124:127], v[76:79]
  s_waitcnt lgkmcnt(4)
  v_mfma_f32_16x16x32_bf16 v[80:83], v[228:231], a[112:115], v[80:83]
  ds_read_b64_tr_b16 v[224:225], v250 offset:128
  v_mfma_f32_16x16x32_bf16 v[84:87], v[228:231], a[116:119], v[84:87]
  ds_read_b64_tr_b16 v[226:227], v250 offset:3200
  v_mfma_f32_16x16x32_bf16 v[88:91], v[228:231], a[120:123], v[88:91]
  s_add_u32 s39, s35, 29696
  buffer_load_dwordx4 a[180:183], v240, s[16:19], s39 offen
  v_mfma_f32_16x16x32_bf16 v[92:95], v[228:231], a[124:127], v[92:95]
  s_waitcnt lgkmcnt(4)
  v_mfma_f32_16x16x32_bf16 v[96:99], v[232:235], a[112:115], v[96:99]
  ds_read_b64_tr_b16 v[228:229], v250 offset:6272
  v_mfma_f32_16x16x32_bf16 v[100:103], v[232:235], a[116:119], v[100:103]
  ds_read_b64_tr_b16 v[230:231], v250 offset:9344
  v_mfma_f32_16x16x32_bf16 v[104:107], v[232:235], a[120:123], v[104:107]
  s_add_u32 s39, s35, 48128
  buffer_load_dwordx4 a[184:187], v240, s[16:19], s39 offen
  v_mfma_f32_16x16x32_bf16 v[108:111], v[232:235], a[124:127], v[108:111]
  s_waitcnt lgkmcnt(4)
  v_mfma_f32_16x16x32_bf16 v[112:115], v[236:239], a[112:115], v[112:115]
  ds_read_b64_tr_b16 v[232:233], v251 offset:160
  v_mfma_f32_16x16x32_bf16 v[116:119], v[236:239], a[116:119], v[116:119]
  ds_read_b64_tr_b16 v[234:235], v251 offset:3232
  v_mfma_f32_16x16x32_bf16 v[120:123], v[236:239], a[120:123], v[120:123]
  v_mfma_f32_16x16x32_bf16 v[124:127], v[236:239], a[124:127], v[124:127]
  s_waitcnt lgkmcnt(4)
  v_mfma_f32_16x16x32_bf16 v[128:131], v[224:227], a[112:115], v[128:131]
  ds_read_b64_tr_b16 v[236:237], v251 offset:6304
  v_mfma_f32_16x16x32_bf16 v[132:135], v[224:227], a[116:119], v[132:135]
  ds_read_b64_tr_b16 v[238:239], v251 offset:9376
  v_mfma_f32_16x16x32_bf16 v[136:139], v[224:227], a[120:123], v[136:139]
  s_add_u32 s39, s35, 66560
  buffer_load_dwordx4 a[188:191], v240, s[16:19], s39 offen
  v_mfma_f32_16x16x32_bf16 v[140:143], v[224:227], a[124:127], v[140:143]
  s_waitcnt vmcnt(18)
  s_barrier
  v_add_u32 v250, 98304, v247
  v_add_u32 v251, 98304, v248
  s_waitcnt lgkmcnt(4)
  v_mfma_f32_16x16x32_bf16 v[144:147], v[228:231], a[112:115], v[144:147]
  ds_read_b64_tr_b16 v[224:225], v250 offset:0
  v_mfma_f32_16x16x32_bf16 v[148:151], v[228:231], a[116:119], v[148:151]
  ds_read_b64_tr_b16 v[226:227], v250 offset:3072
  v_mfma_f32_16x16x32_bf16 v[152:155], v[228:231], a[120:123], v[152:155]
  s_add_u32 m0, s31, 147456
  s_add_u32 s38, s32, 3538944
  buffer_load_dwordx4 v241, s[12:15], s38 offen offset:0 lds
  v_mfma_f32_16x16x32_bf16 v[156:159], v[228:231], a[124:127], v[156:159]
  s_waitcnt lgkmcnt(4)
  v_mfma_f32_16x16x32_bf16 v[160:163], v[232:235], a[112:115], v[160:163]
  ds_read_b64_tr_b16 v[228:229], v250 offset:6144
  v_mfma_f32_16x16x32_bf16 v[164:167], v[232:235], a[116:119], v[164:167]
  ds_read_b64_tr_b16 v[230:231], v250 offset:9216
  v_mfma_f32_16x16x32_bf16 v[168:171], v[232:235], a[120:123], v[168:171]
  buffer_load_dwordx4 v242, s[12:15], s38 offen offset:1024 lds
  v_mfma_f32_16x16x32_bf16 v[172:175], v[232:235], a[124:127], v[172:175]
  s_waitcnt lgkmcnt(4)
  v_mfma_f32_16x16x32_bf16 v[176:179], v[236:239], a[112:115], v[176:179]
  ds_read_b64_tr_b16 v[232:233], v251 offset:32
  v_mfma_f32_16x16x32_bf16 v[180:183], v[236:239], a[116:119], v[180:183]
  ds_read_b64_tr_b16 v[234:235], v251 offset:3104
  v_mfma_f32_16x16x32_bf16 v[184:187], v[236:239], a[120:123], v[184:187]
  v_mfma_f32_16x16x32_bf16 v[188:191], v[236:239], a[124:127], v[188:191]
  s_waitcnt lgkmcnt(4)
  v_mfma_f32_16x16x32_bf16 v[0:3], v[224:227], a[128:131], v[0:3]
  ds_read_b64_tr_b16 v[236:237], v251 offset:6176
  v_mfma_f32_16x16x32_bf16 v[4:7], v[224:227], a[132:135], v[4:7]
  ds_read_b64_tr_b16 v[238:239], v251 offset:9248
  v_mfma_f32_16x16x32_bf16 v[8:11], v[224:227], a[136:139], v[8:11]
  buffer_load_dwordx4 v243, s[12:15], s38 offen offset:2048 lds
  v_mfma_f32_16x16x32_bf16 v[12:15], v[224:227], a[140:143], v[12:15]
  s_waitcnt lgkmcnt(4)
  v_mfma_f32_16x16x32_bf16 v[16:19], v[228:231], a[128:131], v[16:19]
  ds_read_b64_tr_b16 v[224:225], v250 offset:64
  v_mfma_f32_16x16x32_bf16 v[20:23], v[228:231], a[132:135], v[20:23]
  ds_read_b64_tr_b16 v[226:227], v250 offset:3136
  v_mfma_f32_16x16x32_bf16 v[24:27], v[228:231], a[136:139], v[24:27]
  s_add_u32 s39, s35, 12288
  buffer_load_dwordx4 a[192:195], v240, s[16:19], s39 offen
  v_mfma_f32_16x16x32_bf16 v[28:31], v[228:231], a[140:143], v[28:31]
  s_waitcnt lgkmcnt(4)
  v_mfma_f32_16x16x32_bf16 v[32:35], v[232:235], a[128:131], v[32:35]
  ds_read_b64_tr_b16 v[228:229], v250 offset:6208
  v_mfma_f32_16x16x32_bf16 v[36:39], v[232:235], a[132:135], v[36:39]
  ds_read_b64_tr_b16 v[230:231], v250 offset:9280
  v_mfma_f32_16x16x32_bf16 v[40:43], v[232:235], a[136:139], v[40:43]
  s_add_u32 s39, s35, 30720
  buffer_load_dwordx4 a[196:199], v240, s[16:19], s39 offen
  v_mfma_f32_16x16x32_bf16 v[44:47], v[232:235], a[140:143], v[44:47]
  s_waitcnt lgkmcnt(4)
  v_mfma_f32_16x16x32_bf16 v[48:51], v[236:239], a[128:131], v[48:51]
  ds_read_b64_tr_b16 v[232:233], v251 offset:96
  v_mfma_f32_16x16x32_bf16 v[52:55], v[236:239], a[132:135], v[52:55]
  ds_read_b64_tr_b16 v[234:235], v251 offset:3168
  v_mfma_f32_16x16x32_bf16 v[56:59], v[236:239], a[136:139], v[56:59]
  v_mfma_f32_16x16x32_bf16 v[60:63], v[236:239], a[140:143], v[60:63]
  s_waitcnt lgkmcnt(4)
  v_mfma_f32_16x16x32_bf16 v[64:67], v[224:227], a[128:131], v[64:67]
  ds_read_b64_tr_b16 v[236:237], v251 offset:6240
  v_mfma_f32_16x16x32_bf16 v[68:71], v[224:227], a[132:135], v[68:71]
  ds_read_b64_tr_b16 v[238:239], v251 offset:9312
  v_mfma_f32_16x16x32_bf16 v[72:75], v[224:227], a[136:139], v[72:75]
  s_add_u32 s39, s35, 49152
  buffer_load_dwordx4 a[200:203], v240, s[16:19], s39 offen
  v_mfma_f32_16x16x32_bf16 v[76:79], v[224:227], a[140:143], v[76:79]
  s_waitcnt lgkmcnt(4)
  v_mfma_f32_16x16x32_bf16 v[80:83], v[228:231], a[128:131], v[80:83]
  ds_read_b64_tr_b16 v[224:225], v250 offset:128
  v_mfma_f32_16x16x32_bf16 v[84:87], v[228:231], a[132:135], v[84:87]
  ds_read_b64_tr_b16 v[226:227], v250 offset:3200
  v_mfma_f32_16x16x32_bf16 v[88:91], v[228:231], a[136:139], v[88:91]
  s_add_u32 s39, s35, 67584
  buffer_load_dwordx4 a[204:207], v240, s[16:19], s39 offen
  v_mfma_f32_16x16x32_bf16 v[92:95], v[228:231], a[140:143], v[92:95]
  s_waitcnt lgkmcnt(4)
  v_mfma_f32_16x16x32_bf16 v[96:99], v[232:235], a[128:131], v[96:99]
  ds_read_b64_tr_b16 v[228:229], v250 offset:6272
  v_mfma_f32_16x16x32_bf16 v[100:103], v[232:235], a[132:135], v[100:103]
  ds_read_b64_tr_b16 v[230:231], v250 offset:9344
  v_mfma_f32_16x16x32_bf16 v[104:107], v[232:235], a[136:139], v[104:107]
  s_add_u32 m0, s31, 0
  s_add_u32 s38, s32, 3833856
  buffer_load_dwordx4 v241, s[12:15], s38 offen offset:0 lds
  v_mfma_f32_16x16x32_bf16 v[108:111], v[232:235], a[140:143], v[108:111]
  s_waitcnt lgkmcnt(4)
  v_mfma_f32_16x16x32_bf16 v[112:115], v[236:239], a[128:131], v[112:115]
  ds_read_b64_tr_b16 v[232:233], v251 offset:160
  v_mfma_f32_16x16x32_bf16 v[116:119], v[236:239], a[132:135], v[116:119]
  ds_read_b64_tr_b16 v[234:235], v251 offset:3232
  v_mfma_f32_16x16x32_bf16 v[120:123], v[236:239], a[136:139], v[120:123]
  v_mfma_f32_16x16x32_bf16 v[124:127], v[236:239], a[140:143], v[124:127]
  s_waitcnt lgkmcnt(4)
  v_mfma_f32_16x16x32_bf16 v[128:131], v[224:227], a[128:131], v[128:131]
  ds_read_b64_tr_b16 v[236:237], v251 offset:6304
  v_mfma_f32_16x16x32_bf16 v[132:135], v[224:227], a[132:135], v[132:135]
  ds_read_b64_tr_b16 v[238:239], v251 offset:9376
  v_mfma_f32_16x16x32_bf16 v[136:139], v[224:227], a[136:139], v[136:139]
  buffer_load_dwordx4 v242, s[12:15], s38 offen offset:1024 lds
  v_mfma_f32_16x16x32_bf16 v[140:143], v[224:227], a[140:143], v[140:143]
  v_add_u32 v250, 110592, v247
  v_add_u32 v251, 110592, v248
  s_waitcnt lgkmcnt(4)
  v_mfma_f32_16x16x32_bf16 v[144:147], v[228:231], a[128:131], v[144:147]
  ds_read_b64_tr_b16 v[224:225], v250 offset:0
  v_mfma_f32_16x16x32_bf16 v[148:151], v[228:231], a[132:135], v[148:151]
  ds_read_b64_tr_b16 v[226:227], v250 offset:3072
  v_mfma_f32_16x16x32_bf16 v[152:155], v[228:231], a[136:139], v[152:155]
  buffer_load_dwordx4 v243, s[12:15], s38 offen offset:2048 lds
  v_mfma_f32_16x16x32_bf16 v[156:159], v[228:231], a[140:143], v[156:159]
  s_waitcnt lgkmcnt(4)
  v_mfma_f32_16x16x32_bf16 v[160:163], v[232:235], a[128:131], v[160:163]
  ds_read_b64_tr_b16 v[228:229], v250 offset:6144
  v_mfma_f32_16x16x32_bf16 v[164:167], v[232:235], a[132:135], v[164:167]
  ds_read_b64_tr_b16 v[230:231], v250 offset:9216
  v_mfma_f32_16x16x32_bf16 v[168:171], v[232:235], a[136:139], v[168:171]
  s_add_u32 s39, s35, 13312
  buffer_load_dwordx4 a[208:211], v240, s[16:19], s39 offen
  v_mfma_f32_16x16x32_bf16 v[172:175], v[232:235], a[140:143], v[172:175]
  s_waitcnt lgkmcnt(4)
  v_mfma_f32_16x16x32_bf16 v[176:179], v[236:239], a[128:131], v[176:179]
  ds_read_b64_tr_b16 v[232:233], v251 offset:32
  v_mfma_f32_16x16x32_bf16 v[180:183], v[236:239], a[132:135], v[180:183]
  ds_read_b64_tr_b16 v[234:235], v251 offset:3104
  v_mfma_f32_16x16x32_bf16 v[184:187], v[236:239], a[136:139], v[184:187]
  v_mfma_f32_16x16x32_bf16 v[188:191], v[236:239], a[140:143], v[188:191]
  s_waitcnt vmcnt(25)
  s_waitcnt lgkmcnt(4)
  v_mfma_f32_16x16x32_bf16 v[0:3], v[224:227], a[144:147], v[0:3]
  ds_read_b64_tr_b16 v[236:237], v251 offset:6176
  v_mfma_f32_16x16x32_bf16 v[4:7], v[224:227], a[148:151], v[4:7]
  ds_read_b64_tr_b16 v[238:239], v251 offset:9248
  v_mfma_f32_16x16x32_bf16 v[8:11], v[224:227], a[152:155], v[8:11]
  s_add_u32 s39, s35, 31744
  buffer_load_dwordx4 a[212:215], v240, s[16:19], s39 offen
  v_mfma_f32_16x16x32_bf16 v[12:15], v[224:227], a[156:159], v[12:15]
  s_waitcnt lgkmcnt(4)
  v_mfma_f32_16x16x32_bf16 v[16:19], v[228:231], a[144:147], v[16:19]
  ds_read_b64_tr_b16 v[224:225], v250 offset:64
  v_mfma_f32_16x16x32_bf16 v[20:23], v[228:231], a[148:151], v[20:23]
  ds_read_b64_tr_b16 v[226:227], v250 offset:3136
  v_mfma_f32_16x16x32_bf16 v[24:27], v[228:231], a[152:155], v[24:27]
  s_add_u32 s39, s35, 50176
  buffer_load_dwordx4 a[216:219], v240, s[16:19], s39 offen
  v_mfma_f32_16x16x32_bf16 v[28:31], v[228:231], a[156:159], v[28:31]
  s_waitcnt lgkmcnt(4)
  v_mfma_f32_16x16x32_bf16 v[32:35], v[232:235], a[144:147], v[32:35]
  ds_read_b64_tr_b16 v[228:229], v250 offset:6208
  v_mfma_f32_16x16x32_bf16 v[36:39], v[232:235], a[148:151], v[36:39]
  ds_read_b64_tr_b16 v[230:231], v250 offset:9280
  v_mfma_f32_16x16x32_bf16 v[40:43], v[232:235], a[152:155], v[40:43]
  s_add_u32 s39, s35, 68608
  buffer_load_dwordx4 a[220:223], v240, s[16:19], s39 offen
  v_mfma_f32_16x16x32_bf16 v[44:47], v[232:235], a[156:159], v[44:47]
  s_waitcnt lgkmcnt(4)
  v_mfma_f32_16x16x32_bf16 v[48:51], v[236:239], a[144:147], v[48:51]
  ds_read_b64_tr_b16 v[232:233], v251 offset:96
  v_mfma_f32_16x16x32_bf16 v[52:55], v[236:239], a[148:151], v[52:55]
  ds_read_b64_tr_b16 v[234:235], v251 offset:3168
  v_mfma_f32_16x16x32_bf16 v[56:59], v[236:239], a[152:155], v[56:59]
  v_mfma_f32_16x16x32_bf16 v[60:63], v[236:239], a[156:159], v[60:63]
  s_waitcnt lgkmcnt(4)
  v_mfma_f32_16x16x32_bf16 v[64:67], v[224:227], a[144:147], v[64:67]
  ds_read_b64_tr_b16 v[236:237], v251 offset:6240
  v_mfma_f32_16x16x32_bf16 v[68:71], v[224:227], a[148:151], v[68:71]
  ds_read_b64_tr_b16 v[238:239], v251 offset:9312
  v_mfma_f32_16x16x32_bf16 v[72:75], v[224:227], a[152:155], v[72:75]
  s_add_u32 m0, s31, 12288
  s_add_u32 s38, s32, 4128768
  buffer_load_dwordx4 v241, s[12:15], s38 offen offset:0 lds
  v_mfma_f32_16x16x32_bf16 v[76:79], v[224:227], a[156:159], v[76:79]
  s_waitcnt lgkmcnt(4)
  v_mfma_f32_16x16x32_bf16 v[80:83], v[228:231], a[144:147], v[80:83]
  ds_read_b64_tr_b16 v[224:225], v250 offset:128
  v_mfma_f32_16x16x32_bf16 v[84:87], v[228:231], a[148:151], v[84:87]
  ds_read_b64_tr_b16 v[226:227], v250 offset:3200
  v_mfma_f32_16x16x32_bf16 v[88:91], v[228:231], a[152:155], v[88:91]
  buffer_load_dwordx4 v242, s[12:15], s38 offen offset:1024 lds
  v_mfma_f32_16x16x32_bf16 v[92:95], v[228:231], a[156:159], v[92:95]
  s_waitcnt lgkmcnt(4)
  v_mfma_f32_16x16x32_bf16 v[96:99], v[232:235], a[144:147], v[96:99]
  ds_read_b64_tr_b16 v[228:229], v250 offset:6272
  v_mfma_f32_16x16x32_bf16 v[100:103], v[232:235], a[148:151], v[100:103]
  ds_read_b64_tr_b16 v[230:231], v250 offset:9344
  v_mfma_f32_16x16x32_bf16 v[104:107], v[232:235], a[152:155], v[104:107]
  buffer_load_dwordx4 v243, s[12:15], s38 offen offset:2048 lds
  v_mfma_f32_16x16x32_bf16 v[108:111], v[232:235], a[156:159], v[108:111]
  s_waitcnt lgkmcnt(4)
  v_mfma_f32_16x16x32_bf16 v[112:115], v[236:239], a[144:147], v[112:115]
  ds_read_b64_tr_b16 v[232:233], v251 offset:160
  v_mfma_f32_16x16x32_bf16 v[116:119], v[236:239], a[148:151], v[116:119]
  ds_read_b64_tr_b16 v[234:235], v251 offset:3232
  v_mfma_f32_16x16x32_bf16 v[120:123], v[236:239], a[152:155], v[120:123]
  v_mfma_f32_16x16x32_bf16 v[124:127], v[236:239], a[156:159], v[124:127]
  s_waitcnt lgkmcnt(4)
  v_mfma_f32_16x16x32_bf16 v[128:131], v[224:227], a[144:147], v[128:131]
  ds_read_b64_tr_b16 v[236:237], v251 offset:6304
  v_mfma_f32_16x16x32_bf16 v[132:135], v[224:227], a[148:151], v[132:135]
  ds_read_b64_tr_b16 v[238:239], v251 offset:9376
  v_mfma_f32_16x16x32_bf16 v[136:139], v[224:227], a[152:155], v[136:139]
  s_add_u32 s39, s35, 14336
  buffer_load_dwordx4 a[224:227], v240, s[16:19], s39 offen
  v_mfma_f32_16x16x32_bf16 v[140:143], v[224:227], a[156:159], v[140:143]
  s_waitcnt vmcnt(22)
  s_barrier
  v_add_u32 v250, 122880, v247
  v_add_u32 v251, 122880, v248
  s_waitcnt lgkmcnt(4)
  v_mfma_f32_16x16x32_bf16 v[144:147], v[228:231], a[144:147], v[144:147]
  ds_read_b64_tr_b16 v[224:225], v250 offset:0
  v_mfma_f32_16x16x32_bf16 v[148:151], v[228:231], a[148:151], v[148:151]
  ds_read_b64_tr_b16 v[226:227], v250 offset:3072
  v_mfma_f32_16x16x32_bf16 v[152:155], v[228:231], a[152:155], v[152:155]
  s_add_u32 s39, s35, 32768
  buffer_load_dwordx4 a[228:231], v240, s[16:19], s39 offen
  v_mfma_f32_16x16x32_bf16 v[156:159], v[228:231], a[156:159], v[156:159]
  s_waitcnt lgkmcnt(4)
  v_mfma_f32_16x16x32_bf16 v[160:163], v[232:235], a[144:147], v[160:163]
  ds_read_b64_tr_b16 v[228:229], v250 offset:6144
  v_mfma_f32_16x16x32_bf16 v[164:167], v[232:235], a[148:151], v[164:167]
  ds_read_b64_tr_b16 v[230:231], v250 offset:9216
  v_mfma_f32_16x16x32_bf16 v[168:171], v[232:235], a[152:155], v[168:171]
  s_add_u32 s39, s35, 51200
  buffer_load_dwordx4 a[232:235], v240, s[16:19], s39 offen
  v_mfma_f32_16x16x32_bf16 v[172:175], v[232:235], a[156:159], v[172:175]
  s_waitcnt lgkmcnt(4)
  v_mfma_f32_16x16x32_bf16 v[176:179], v[236:239], a[144:147], v[176:179]
  ds_read_b64_tr_b16 v[232:233], v251 offset:32
  v_mfma_f32_16x16x32_bf16 v[180:183], v[236:239], a[148:151], v[180:183]
  ds_read_b64_tr_b16 v[234:235], v251 offset:3104
  v_mfma_f32_16x16x32_bf16 v[184:187], v[236:239], a[152:155], v[184:187]
  v_mfma_f32_16x16x32_bf16 v[188:191], v[236:239], a[156:159], v[188:191]
  s_waitcnt lgkmcnt(4)
  v_mfma_f32_16x16x32_bf16 v[0:3], v[224:227], a[160:163], v[0:3]
  ds_read_b64_tr_b16 v[236:237], v251 offset:6176
  v_mfma_f32_16x16x32_bf16 v[4:7], v[224:227], a[164:167], v[4:7]
  ds_read_b64_tr_b16 v[238:239], v251 offset:9248
  v_mfma_f32_16x16x32_bf16 v[8:11], v[224:227], a[168:171], v[8:11]
  s_add_u32 s39, s35, 69632
  buffer_load_dwordx4 a[236:239], v240, s[16:19], s39 offen
  v_mfma_f32_16x16x32_bf16 v[12:15], v[224:227], a[172:175], v[12:15]
  s_waitcnt lgkmcnt(4)
  v_mfma_f32_16x16x32_bf16 v[16:19], v[228:231], a[160:163], v[16:19]
  ds_read_b64_tr_b16 v[224:225], v250 offset:64
  v_mfma_f32_16x16x32_bf16 v[20:23], v[228:231], a[164:167], v[20:23]
  ds_read_b64_tr_b16 v[226:227], v250 offset:3136
  v_mfma_f32_16x16x32_bf16 v[24:27], v[228:231], a[168:171], v[24:27]
  s_add_u32 m0, s31, 24576
  s_add_u32 s38, s32, 4423680
  buffer_load_dwordx4 v241, s[12:15], s38 offen offset:0 lds
  v_mfma_f32_16x16x32_bf16 v[28:31], v[228:231], a[172:175], v[28:31]
  s_waitcnt lgkmcnt(4)
  v_mfma_f32_16x16x32_bf16 v[32:35], v[232:235], a[160:163], v[32:35]
  ds_read_b64_tr_b16 v[228:229], v250 offset:6208
  v_mfma_f32_16x16x32_bf16 v[36:39], v[232:235], a[164:167], v[36:39]
  ds_read_b64_tr_b16 v[230:231], v250 offset:9280
  v_mfma_f32_16x16x32_bf16 v[40:43], v[232:235], a[168:171], v[40:43]
  buffer_load_dwordx4 v242, s[12:15], s38 offen offset:1024 lds
  v_mfma_f32_16x16x32_bf16 v[44:47], v[232:235], a[172:175], v[44:47]
  s_waitcnt lgkmcnt(4)
  v_mfma_f32_16x16x32_bf16 v[48:51], v[236:239], a[160:163], v[48:51]
  ds_read_b64_tr_b16 v[232:233], v251 offset:96
  v_mfma_f32_16x16x32_bf16 v[52:55], v[236:239], a[164:167], v[52:55]
  ds_read_b64_tr_b16 v[234:235], v251 offset:3168
  v_mfma_f32_16x16x32_bf16 v[56:59], v[236:239], a[168:171], v[56:59]
  v_mfma_f32_16x16x32_bf16 v[60:63], v[236:239], a[172:175], v[60:63]
  s_waitcnt lgkmcnt(4)
  v_mfma_f32_16x16x32_bf16 v[64:67], v[224:227], a[160:163], v[64:67]
  ds_read_b64_tr_b16 v[236:237], v251 offset:6240
  v_mfma_f32_16x16x32_bf16 v[68:71], v[224:227], a[164:167], v[68:71]
  ds_read_b64_tr_b16 v[238:239], v251 offset:9312
  v_mfma_f32_16x16x32_bf16 v[72:75], v[224:227], a[168:171], v[72:75]
  buffer_load_dwordx4 v243, s[12:15], s38 offen offset:2048 lds
  v_mfma_f32_16x16x32_bf16 v[76:79], v[224:227], a[172:175], v[76:79]
  s_waitcnt lgkmcnt(4)
  v_mfma_f32_16x16x32_bf16 v[80:83], v[228:231], a[160:163], v[80:83]
  ds_read_b64_tr_b16 v[224:225], v250 offset:128
  v_mfma_f32_16x16x32_bf16 v[84:87], v[228:231], a[164:167], v[84:87]
  ds_read_b64_tr_b16 v[226:227], v250 offset:3200
  v_mfma_f32_16x16x32_bf16 v[88:91], v[228:231], a[168:171], v[88:91]
  s_add_u32 s39, s35, 15360
  buffer_load_dwordx4 a[240:243], v240, s[16:19], s39 offen
  v_mfma_f32_16x16x32_bf16 v[92:95], v[228:231], a[172:175], v[92:95]
  s_waitcnt lgkmcnt(4)
  v_mfma_f32_16x16x32_bf16 v[96:99], v[232:235], a[160:163], v[96:99]
  ds_read_b64_tr_b16 v[228:229], v250 offset:6272
  v_mfma_f32_16x16x32_bf16 v[100:103], v[232:235], a[164:167], v[100:103]
  ds_read_b64_tr_b16 v[230:231], v250 offset:9344
  v_mfma_f32_16x16x32_bf16 v[104:107], v[232:235], a[168:171], v[104:107]
  s_add_u32 s39, s35, 33792
  buffer_load_dwordx4 a[244:247], v240, s[16:19], s39 offen
  v_mfma_f32_16x16x32_bf16 v[108:111], v[232:235], a[172:175], v[108:111]
  s_waitcnt lgkmcnt(4)
  v_mfma_f32_16x16x32_bf16 v[112:115], v[236:239], a[160:163], v[112:115]
  ds_read_b64_tr_b16 v[232:233], v251 offset:160
  v_mfma_f32_16x16x32_bf16 v[116:119], v[236:239], a[164:167], v[116:119]
  ds_read_b64_tr_b16 v[234:235], v251 offset:3232
  v_mfma_f32_16x16x32_bf16 v[120:123], v[236:239], a[168:171], v[120:123]
  v_mfma_f32_16x16x32_bf16 v[124:127], v[236:239], a[172:175], v[124:127]
  s_waitcnt lgkmcnt(4)
  v_mfma_f32_16x16x32_bf16 v[128:131], v[224:227], a[160:163], v[128:131]
  ds_read_b64_tr_b16 v[236:237], v251 offset:6304
  v_mfma_f32_16x16x32_bf16 v[132:135], v[224:227], a[164:167], v[132:135]
  ds_read_b64_tr_b16 v[238:239], v251 offset:9376
  v_mfma_f32_16x16x32_bf16 v[136:139], v[224:227], a[168:171], v[136:139]
  s_add_u32 s39, s35, 52224
  buffer_load_dwordx4 a[248:251], v240, s[16:19], s39 offen
  v_mfma_f32_16x16x32_bf16 v[140:143], v[224:227], a[172:175], v[140:143]
  v_add_u32 v250, 135168, v247
  v_add_u32 v251, 135168, v248
  s_waitcnt lgkmcnt(4)
  v_mfma_f32_16x16x32_bf16 v[144:147], v[228:231], a[160:163], v[144:147]
  ds_read_b64_tr_b16 v[224:225], v250 offset:0
  v_mfma_f32_16x16x32_bf16 v[148:151], v[228:231], a[164:167], v[148:151]
  ds_read_b64_tr_b16 v[226:227], v250 offset:3072
  v_mfma_f32_16x16x32_bf16 v[152:155], v[228:231], a[168:171], v[152:155]
  s_add_u32 s39, s35, 70656
  buffer_load_dwordx4 a[252:255], v240, s[16:19], s39 offen
  v_mfma_f32_16x16x32_bf16 v[156:159], v[228:231], a[172:175], v[156:159]
  s_waitcnt lgkmcnt(4)
  v_mfma_f32_16x16x32_bf16 v[160:163], v[232:235], a[160:163], v[160:163]
  ds_read_b64_tr_b16 v[228:229], v250 offset:6144
  v_mfma_f32_16x16x32_bf16 v[164:167], v[232:235], a[164:167], v[164:167]
  ds_read_b64_tr_b16 v[230:231], v250 offset:9216
  v_mfma_f32_16x16x32_bf16 v[168:171], v[232:235], a[168:171], v[168:171]
  s_add_u32 m0, s31, 36864
  s_add_u32 s38, s32, 4718592
  buffer_load_dwordx4 v241, s[12:15], s38 offen offset:0 lds
  v_mfma_f32_16x16x32_bf16 v[172:175], v[232:235], a[172:175], v[172:175]
  s_waitcnt lgkmcnt(4)
  v_mfma_f32_16x16x32_bf16 v[176:179], v[236:239], a[160:163], v[176:179]
  ds_read_b64_tr_b16 v[232:233], v251 offset:32
  v_mfma_f32_16x16x32_bf16 v[180:183], v[236:239], a[164:167], v[180:183]
  ds_read_b64_tr_b16 v[234:235], v251 offset:3104
  v_mfma_f32_16x16x32_bf16 v[184:187], v[236:239], a[168:171], v[184:187]
  v_mfma_f32_16x16x32_bf16 v[188:191], v[236:239], a[172:175], v[188:191]
  s_waitcnt vmcnt(29)
  s_waitcnt lgkmcnt(4)
  v_mfma_f32_16x16x32_bf16 v[0:3], v[224:227], a[176:179], v[0:3]
  ds_read_b64_tr_b16 v[236:237], v251 offset:6176
  v_mfma_f32_16x16x32_bf16 v[4:7], v[224:227], a[180:183], v[4:7]
  ds_read_b64_tr_b16 v[238:239], v251 offset:9248
  v_mfma_f32_16x16x32_bf16 v[8:11], v[224:227], a[184:187], v[8:11]
  buffer_load_dwordx4 v242, s[12:15], s38 offen offset:1024 lds
  v_mfma_f32_16x16x32_bf16 v[12:15], v[224:227], a[188:191], v[12:15]
  s_waitcnt lgkmcnt(4)
  v_mfma_f32_16x16x32_bf16 v[16:19], v[228:231], a[176:179], v[16:19]
  ds_read_b64_tr_b16 v[224:225], v250 offset:64
  v_mfma_f32_16x16x32_bf16 v[20:23], v[228:231], a[180:183], v[20:23]
  ds_read_b64_tr_b16 v[226:227], v250 offset:3136
  v_mfma_f32_16x16x32_bf16 v[24:27], v[228:231], a[184:187], v[24:27]
  buffer_load_dwordx4 v243, s[12:15], s38 offen offset:2048 lds
  v_mfma_f32_16x16x32_bf16 v[28:31], v[228:231], a[188:191], v[28:31]
  s_waitcnt lgkmcnt(4)
  v_mfma_f32_16x16x32_bf16 v[32:35], v[232:235], a[176:179], v[32:35]
  ds_read_b64_tr_b16 v[228:229], v250 offset:6208
  v_mfma_f32_16x16x32_bf16 v[36:39], v[232:235], a[180:183], v[36:39]
  ds_read_b64_tr_b16 v[230:231], v250 offset:9280
  v_mfma_f32_16x16x32_bf16 v[40:43], v[232:235], a[184:187], v[40:43]
  s_add_u32 s39, s35, 16384
  buffer_load_dwordx4 v[192:195], v240, s[16:19], s39 offen
  v_mfma_f32_16x16x32_bf16 v[44:47], v[232:235], a[188:191], v[44:47]
  s_waitcnt lgkmcnt(4)
  v_mfma_f32_16x16x32_bf16 v[48:51], v[236:239], a[176:179], v[48:51]
  ds_read_b64_tr_b16 v[232:233], v251 offset:96
  v_mfma_f32_16x16x32_bf16 v[52:55], v[236:239], a[180:183], v[52:55]
  ds_read_b64_tr_b16 v[234:235], v251 offset:3168
  v_mfma_f32_16x16x32_bf16 v[56:59], v[236:239], a[184:187], v[56:59]
  v_mfma_f32_16x16x32_bf16 v[60:63], v[236:239], a[188:191], v[60:63]
  s_waitcnt lgkmcnt(4)
  v_mfma_f32_16x16x32_bf16 v[64:67], v[224:227], a[176:179], v[64:67]
  ds_read_b64_tr_b16 v[236:237], v251 offset:6240
  v_mfma_f32_16x16x32_bf16 v[68:71], v[224:227], a[180:183], v[68:71]
  ds_read_b64_tr_b16 v[238:239], v251 offset:9312
  v_mfma_f32_16x16x32_bf16 v[72:75], v[224:227], a[184:187], v[72:75]
  s_add_u32 s39, s35, 34816
  buffer_load_dwordx4 v[196:199], v240, s[16:19], s39 offen
  v_mfma_f32_16x16x32_bf16 v[76:79], v[224:227], a[188:191], v[76:79]
  s_waitcnt lgkmcnt(4)
  v_mfma_f32_16x16x32_bf16 v[80:83], v[228:231], a[176:179], v[80:83]
  ds_read_b64_tr_b16 v[224:225], v250 offset:128
  v_mfma_f32_16x16x32_bf16 v[84:87], v[228:231], a[180:183], v[84:87]
  ds_read_b64_tr_b16 v[226:227], v250 offset:3200
  v_mfma_f32_16x16x32_bf16 v[88:91], v[228:231], a[184:187], v[88:91]
  s_add_u32 s39, s35, 53248
  buffer_load_dwordx4 v[200:203], v240, s[16:19], s39 offen
  v_mfma_f32_16x16x32_bf16 v[92:95], v[228:231], a[188:191], v[92:95]
  s_waitcnt lgkmcnt(4)
  v_mfma_f32_16x16x32_bf16 v[96:99], v[232:235], a[176:179], v[96:99]
  ds_read_b64_tr_b16 v[228:229], v250 offset:6272
  v_mfma_f32_16x16x32_bf16 v[100:103], v[232:235], a[180:183], v[100:103]
  ds_read_b64_tr_b16 v[230:231], v250 offset:9344
  v_mfma_f32_16x16x32_bf16 v[104:107], v[232:235], a[184:187], v[104:107]
  s_add_u32 s39, s35, 71680
  buffer_load_dwordx4 v[204:207], v240, s[16:19], s39 offen
  v_mfma_f32_16x16x32_bf16 v[108:111], v[232:235], a[188:191], v[108:111]
  s_waitcnt lgkmcnt(4)
  v_mfma_f32_16x16x32_bf16 v[112:115], v[236:239], a[176:179], v[112:115]
  ds_read_b64_tr_b16 v[232:233], v251 offset:160
  v_mfma_f32_16x16x32_bf16 v[116:119], v[236:239], a[180:183], v[116:119]
  ds_read_b64_tr_b16 v[234:235], v251 offset:3232
  v_mfma_f32_16x16x32_bf16 v[120:123], v[236:239], a[184:187], v[120:123]
  v_mfma_f32_16x16x32_bf16 v[124:127], v[236:239], a[188:191], v[124:127]
  s_waitcnt lgkmcnt(4)
  v_mfma_f32_16x16x32_bf16 v[128:131], v[224:227], a[176:179], v[128:131]
  ds_read_b64_tr_b16 v[236:237], v251 offset:6304
  v_mfma_f32_16x16x32_bf16 v[132:135], v[224:227], a[180:183], v[132:135]
  ds_read_b64_tr_b16 v[238:239], v251 offset:9376
  v_mfma_f32_16x16x32_bf16 v[136:139], v[224:227], a[184:187], v[136:139]
  s_add_u32 m0, s31, 49152
  s_add_u32 s38, s32, 5013504
  buffer_load_dwordx4 v241, s[12:15], s38 offen offset:0 lds
  v_mfma_f32_16x16x32_bf16 v[140:143], v[224:227], a[188:191], v[140:143]
  s_waitcnt vmcnt(26)
  s_barrier
  v_add_u32 v250, 147456, v247
  v_add_u32 v251, 147456, v248
  s_waitcnt lgkmcnt(4)
  v_mfma_f32_16x16x32_bf16 v[144:147], v[228:231], a[176:179], v[144:147]
  ds_read_b64_tr_b16 v[224:225], v250 offset:0
  v_mfma_f32_16x16x32_bf16 v[148:151], v[228:231], a[180:183], v[148:151]
  ds_read_b64_tr_b16 v[226:227], v250 offset:3072
  v_mfma_f32_16x16x32_bf16 v[152:155], v[228:231], a[184:187], v[152:155]
  buffer_load_dwordx4 v242, s[12:15], s38 offen offset:1024 lds
  v_mfma_f32_16x16x32_bf16 v[156:159], v[228:231], a[188:191], v[156:159]
  s_waitcnt lgkmcnt(4)
  v_mfma_f32_16x16x32_bf16 v[160:163], v[232:235], a[176:179], v[160:163]
  ds_read_b64_tr_b16 v[228:229], v250 offset:6144
  v_mfma_f32_16x16x32_bf16 v[164:167], v[232:235], a[180:183], v[164:167]
  ds_read_b64_tr_b16 v[230:231], v250 offset:9216
  v_mfma_f32_16x16x32_bf16 v[168:171], v[232:235], a[184:187], v[168:171]
  buffer_load_dwordx4 v243, s[12:15], s38 offen offset:2048 lds
  v_mfma_f32_16x16x32_bf16 v[172:175], v[232:235], a[188:191], v[172:175]
  s_waitcnt lgkmcnt(4)
  v_mfma_f32_16x16x32_bf16 v[176:179], v[236:239], a[176:179], v[176:179]
  ds_read_b64_tr_b16 v[232:233], v251 offset:32
  v_mfma_f32_16x16x32_bf16 v[180:183], v[236:239], a[180:183], v[180:183]
  ds_read_b64_tr_b16 v[234:235], v251 offset:3104
  v_mfma_f32_16x16x32_bf16 v[184:187], v[236:239], a[184:187], v[184:187]
  v_mfma_f32_16x16x32_bf16 v[188:191], v[236:239], a[188:191], v[188:191]
  s_waitcnt lgkmcnt(4)
  v_mfma_f32_16x16x32_bf16 v[0:3], v[224:227], a[192:195], v[0:3]
  ds_read_b64_tr_b16 v[236:237], v251 offset:6176
  v_mfma_f32_16x16x32_bf16 v[4:7], v[224:227], a[196:199], v[4:7]
  ds_read_b64_tr_b16 v[238:239], v251 offset:9248
  v_mfma_f32_16x16x32_bf16 v[8:11], v[224:227], a[200:203], v[8:11]
  s_add_u32 s39, s35, 17408
  buffer_load_dwordx4 v[208:211], v240, s[16:19], s39 offen
  v_mfma_f32_16x16x32_bf16 v[12:15], v[224:227], a[204:207], v[12:15]
  s_waitcnt lgkmcnt(4)
  v_mfma_f32_16x16x32_bf16 v[16:19], v[228:231], a[192:195], v[16:19]
  ds_read_b64_tr_b16 v[224:225], v250 offset:64
  v_mfma_f32_16x16x32_bf16 v[20:23], v[228:231], a[196:199], v[20:23]
  ds_read_b64_tr_b16 v[226:227], v250 offset:3136
  v_mfma_f32_16x16x32_bf16 v[24:27], v[228:231], a[200:203], v[24:27]
  s_add_u32 s39, s35, 35840
  buffer_load_dwordx4 v[212:215], v240, s[16:19], s39 offen
  v_mfma_f32_16x16x32_bf16 v[28:31], v[228:231], a[204:207], v[28:31]
  s_waitcnt lgkmcnt(4)
  v_mfma_f32_16x16x32_bf16 v[32:35], v[232:235], a[192:195], v[32:35]
  ds_read_b64_tr_b16 v[228:229], v250 offset:6208
  v_mfma_f32_16x16x32_bf16 v[36:39], v[232:235], a[196:199], v[36:39]
  ds_read_b64_tr_b16 v[230:231], v250 offset:9280
  v_mfma_f32_16x16x32_bf16 v[40:43], v[232:235], a[200:203], v[40:43]
  s_add_u32 s39, s35, 54272
  buffer_load_dwordx4 v[216:219], v240, s[16:19], s39 offen
  v_mfma_f32_16x16x32_bf16 v[44:47], v[232:235], a[204:207], v[44:47]
  s_waitcnt lgkmcnt(4)
  v_mfma_f32_16x16x32_bf16 v[48:51], v[236:239], a[192:195], v[48:51]
  ds_read_b64_tr_b16 v[232:233], v251 offset:96
  v_mfma_f32_16x16x32_bf16 v[52:55], v[236:239], a[196:199], v[52:55]
  ds_read_b64_tr_b16 v[234:235], v251 offset:3168
  v_mfma_f32_16x16x32_bf16 v[56:59], v[236:239], a[200:203], v[56:59]
  v_mfma_f32_16x16x32_bf16 v[60:63], v[236:239], a[204:207], v[60:63]
  s_waitcnt lgkmcnt(4)
  v_mfma_f32_16x16x32_bf16 v[64:67], v[224:227], a[192:195], v[64:67]
  ds_read_b64_tr_b16 v[236:237], v251 offset:6240
  v_mfma_f32_16x16x32_bf16 v[68:71], v[224:227], a[196:199], v[68:71]
  ds_read_b64_tr_b16 v[238:239], v251 offset:9312
  v_mfma_f32_16x16x32_bf16 v[72:75], v[224:227], a[200:203], v[72:75]
  s_add_u32 s39, s35, 72704
  buffer_load_dwordx4 v[220:223], v240, s[16:19], s39 offen
  v_mfma_f32_16x16x32_bf16 v[76:79], v[224:227], a[204:207], v[76:79]
  s_waitcnt lgkmcnt(4)
  v_mfma_f32_16x16x32_bf16 v[80:83], v[228:231], a[192:195], v[80:83]
  ds_read_b64_tr_b16 v[224:225], v250 offset:128
  v_mfma_f32_16x16x32_bf16 v[84:87], v[228:231], a[196:199], v[84:87]
  ds_read_b64_tr_b16 v[226:227], v250 offset:3200
  v_mfma_f32_16x16x32_bf16 v[88:91], v[228:231], a[200:203], v[88:91]
  s_add_u32 m0, s31, 61440
  s_add_u32 s38, s43, 0
  buffer_load_dwordx4 v244, s[12:15], s38 offen offset:0 lds
  v_mfma_f32_16x16x32_bf16 v[92:95], v[228:231], a[204:207], v[92:95]
  s_waitcnt lgkmcnt(4)
  v_mfma_f32_16x16x32_bf16 v[96:99], v[232:235], a[192:195], v[96:99]
  ds_read_b64_tr_b16 v[228:229], v250 offset:6272
  v_mfma_f32_16x16x32_bf16 v[100:103], v[232:235], a[196:199], v[100:103]
  ds_read_b64_tr_b16 v[230:231], v250 offset:9344
  v_mfma_f32_16x16x32_bf16 v[104:107], v[232:235], a[200:203], v[104:107]
  buffer_load_dwordx4 v245, s[12:15], s38 offen offset:1024 lds
  v_mfma_f32_16x16x32_bf16 v[108:111], v[232:235], a[204:207], v[108:111]
  s_waitcnt lgkmcnt(4)
  v_mfma_f32_16x16x32_bf16 v[112:115], v[236:239], a[192:195], v[112:115]
  ds_read_b64_tr_b16 v[232:233], v251 offset:160
  v_mfma_f32_16x16x32_bf16 v[116:119], v[236:239], a[196:199], v[116:119]
  ds_read_b64_tr_b16 v[234:235], v251 offset:3232
  v_mfma_f32_16x16x32_bf16 v[120:123], v[236:239], a[200:203], v[120:123]
  v_mfma_f32_16x16x32_bf16 v[124:127], v[236:239], a[204:207], v[124:127]
  s_waitcnt lgkmcnt(4)
  v_mfma_f32_16x16x32_bf16 v[128:131], v[224:227], a[192:195], v[128:131]
  ds_read_b64_tr_b16 v[236:237], v251 offset:6304
  v_mfma_f32_16x16x32_bf16 v[132:135], v[224:227], a[196:199], v[132:135]
  ds_read_b64_tr_b16 v[238:239], v251 offset:9376
  v_mfma_f32_16x16x32_bf16 v[136:139], v[224:227], a[200:203], v[136:139]
  buffer_load_dwordx4 v246, s[12:15], s38 offen offset:2048 lds
  v_mfma_f32_16x16x32_bf16 v[140:143], v[224:227], a[204:207], v[140:143]
  v_add_u32 v250, 0, v247
  v_add_u32 v251, 0, v248
  s_waitcnt lgkmcnt(4)
  v_mfma_f32_16x16x32_bf16 v[144:147], v[228:231], a[192:195], v[144:147]
  ds_read_b64_tr_b16 v[224:225], v250 offset:0
  v_mfma_f32_16x16x32_bf16 v[148:151], v[228:231], a[196:199], v[148:151]
  ds_read_b64_tr_b16 v[226:227], v250 offset:3072
  v_mfma_f32_16x16x32_bf16 v[152:155], v[228:231], a[200:203], v[152:155]
  s_add_u32 m0, s31, 73728
  s_add_u32 s38, s43, 589824
  buffer_load_dwordx4 v244, s[12:15], s38 offen offset:0 lds
  v_mfma_f32_16x16x32_bf16 v[156:159], v[228:231], a[204:207], v[156:159]
  s_waitcnt lgkmcnt(4)
  v_mfma_f32_16x16x32_bf16 v[160:163], v[232:235], a[192:195], v[160:163]
  ds_read_b64_tr_b16 v[228:229], v250 offset:6144
  v_mfma_f32_16x16x32_bf16 v[164:167], v[232:235], a[196:199], v[164:167]
  ds_read_b64_tr_b16 v[230:231], v250 offset:9216
  v_mfma_f32_16x16x32_bf16 v[168:171], v[232:235], a[200:203], v[168:171]
  buffer_load_dwordx4 v245, s[12:15], s38 offen offset:1024 lds
  v_mfma_f32_16x16x32_bf16 v[172:175], v[232:235], a[204:207], v[172:175]
  s_waitcnt lgkmcnt(4)
  v_mfma_f32_16x16x32_bf16 v[176:179], v[236:239], a[192:195], v[176:179]
  ds_read_b64_tr_b16 v[232:233], v251 offset:32
  v_mfma_f32_16x16x32_bf16 v[180:183], v[236:239], a[196:199], v[180:183]
  ds_read_b64_tr_b16 v[234:235], v251 offset:3104
  v_mfma_f32_16x16x32_bf16 v[184:187], v[236:239], a[200:203], v[184:187]
  v_mfma_f32_16x16x32_bf16 v[188:191], v[236:239], a[204:207], v[188:191]
  s_waitcnt vmcnt(33)
  s_waitcnt lgkmcnt(4)
  v_mfma_f32_16x16x32_bf16 v[0:3], v[224:227], a[208:211], v[0:3]
  ds_read_b64_tr_b16 v[236:237], v251 offset:6176
  v_mfma_f32_16x16x32_bf16 v[4:7], v[224:227], a[212:215], v[4:7]
  ds_read_b64_tr_b16 v[238:239], v251 offset:9248
  v_mfma_f32_16x16x32_bf16 v[8:11], v[224:227], a[216:219], v[8:11]
  buffer_load_dwordx4 v246, s[12:15], s38 offen offset:2048 lds
  v_mfma_f32_16x16x32_bf16 v[12:15], v[224:227], a[220:223], v[12:15]
  s_waitcnt lgkmcnt(4)
  v_mfma_f32_16x16x32_bf16 v[16:19], v[228:231], a[208:211], v[16:19]
  ds_read_b64_tr_b16 v[224:225], v250 offset:64
  v_mfma_f32_16x16x32_bf16 v[20:23], v[228:231], a[212:215], v[20:23]
  ds_read_b64_tr_b16 v[226:227], v250 offset:3136
  v_mfma_f32_16x16x32_bf16 v[24:27], v[228:231], a[216:219], v[24:27]
  s_add_u32 m0, s31, 86016
  s_add_u32 s38, s43, 1179648
  buffer_load_dwordx4 v244, s[12:15], s38 offen offset:0 lds
  v_mfma_f32_16x16x32_bf16 v[28:31], v[228:231], a[220:223], v[28:31]
  s_waitcnt lgkmcnt(4)
  v_mfma_f32_16x16x32_bf16 v[32:35], v[232:235], a[208:211], v[32:35]
  ds_read_b64_tr_b16 v[228:229], v250 offset:6208
  v_mfma_f32_16x16x32_bf16 v[36:39], v[232:235], a[212:215], v[36:39]
  ds_read_b64_tr_b16 v[230:231], v250 offset:9280
  v_mfma_f32_16x16x32_bf16 v[40:43], v[232:235], a[216:219], v[40:43]
  buffer_load_dwordx4 v245, s[12:15], s38 offen offset:1024 lds
  v_mfma_f32_16x16x32_bf16 v[44:47], v[232:235], a[220:223], v[44:47]
  s_waitcnt lgkmcnt(4)
  v_mfma_f32_16x16x32_bf16 v[48:51], v[236:239], a[208:211], v[48:51]
  ds_read_b64_tr_b16 v[232:233], v251 offset:96
  v_mfma_f32_16x16x32_bf16 v[52:55], v[236:239], a[212:215], v[52:55]
  ds_read_b64_tr_b16 v[234:235], v251 offset:3168
  v_mfma_f32_16x16x32_bf16 v[56:59], v[236:239], a[216:219], v[56:59]
  v_mfma_f32_16x16x32_bf16 v[60:63], v[236:239], a[220:223], v[60:63]
  s_waitcnt lgkmcnt(4)
  v_mfma_f32_16x16x32_bf16 v[64:67], v[224:227], a[208:211], v[64:67]
  ds_read_b64_tr_b16 v[236:237], v251 offset:6240
  v_mfma_f32_16x16x32_bf16 v[68:71], v[224:227], a[212:215], v[68:71]
  ds_read_b64_tr_b16 v[238:239], v251 offset:9312
  v_mfma_f32_16x16x32_bf16 v[72:75], v[224:227], a[216:219], v[72:75]
  buffer_load_dwordx4 v246, s[12:15], s38 offen offset:2048 lds
  v_mfma_f32_16x16x32_bf16 v[76:79], v[224:227], a[220:223], v[76:79]
  s_waitcnt lgkmcnt(4)
  v_mfma_f32_16x16x32_bf16 v[80:83], v[228:231], a[208:211], v[80:83]
  ds_read_b64_tr_b16 v[224:225], v250 offset:128
  v_mfma_f32_16x16x32_bf16 v[84:87], v[228:231], a[212:215], v[84:87]
  ds_read_b64_tr_b16 v[226:227], v250 offset:3200
  v_mfma_f32_16x16x32_bf16 v[88:91], v[228:231], a[216:219], v[88:91]
  v_mfma_f32_16x16x32_bf16 v[92:95], v[228:231], a[220:223], v[92:95]
  s_waitcnt lgkmcnt(4)
  v_mfma_f32_16x16x32_bf16 v[96:99], v[232:235], a[208:211], v[96:99]
  ds_read_b64_tr_b16 v[228:229], v250 offset:6272
  v_mfma_f32_16x16x32_bf16 v[100:103], v[232:235], a[212:215], v[100:103]
  ds_read_b64_tr_b16 v[230:231], v250 offset:9344
  v_mfma_f32_16x16x32_bf16 v[104:107], v[232:235], a[216:219], v[104:107]
  s_add_u32 m0, s31, 98304
  s_add_u32 s38, s43, 1769472
  buffer_load_dwordx4 v244, s[12:15], s38 offen offset:0 lds
  v_mfma_f32_16x16x32_bf16 v[108:111], v[232:235], a[220:223], v[108:111]
  s_waitcnt lgkmcnt(4)
  v_mfma_f32_16x16x32_bf16 v[112:115], v[236:239], a[208:211], v[112:115]
  ds_read_b64_tr_b16 v[232:233], v251 offset:160
  v_mfma_f32_16x16x32_bf16 v[116:119], v[236:239], a[212:215], v[116:119]
  ds_read_b64_tr_b16 v[234:235], v251 offset:3232
  v_mfma_f32_16x16x32_bf16 v[120:123], v[236:239], a[216:219], v[120:123]
  v_mfma_f32_16x16x32_bf16 v[124:127], v[236:239], a[220:223], v[124:127]
  s_waitcnt lgkmcnt(4)
  v_mfma_f32_16x16x32_bf16 v[128:131], v[224:227], a[208:211], v[128:131]
  ds_read_b64_tr_b16 v[236:237], v251 offset:6304
  v_mfma_f32_16x16x32_bf16 v[132:135], v[224:227], a[212:215], v[132:135]
  ds_read_b64_tr_b16 v[238:239], v251 offset:9376
  v_mfma_f32_16x16x32_bf16 v[136:139], v[224:227], a[216:219], v[136:139]
  buffer_load_dwordx4 v245, s[12:15], s38 offen offset:1024 lds
  v_mfma_f32_16x16x32_bf16 v[140:143], v[224:227], a[220:223], v[140:143]
  s_waitcnt vmcnt(29)
  s_barrier
  v_add_u32 v250, 12288, v247
  v_add_u32 v251, 12288, v248
  s_waitcnt lgkmcnt(4)
  v_mfma_f32_16x16x32_bf16 v[144:147], v[228:231], a[208:211], v[144:147]
  ds_read_b64_tr_b16 v[224:225], v250 offset:0
  v_mfma_f32_16x16x32_bf16 v[148:151], v[228:231], a[212:215], v[148:151]
  ds_read_b64_tr_b16 v[226:227], v250 offset:3072
  v_mfma_f32_16x16x32_bf16 v[152:155], v[228:231], a[216:219], v[152:155]
  v_mfma_f32_16x16x32_bf16 v[156:159], v[228:231], a[220:223], v[156:159]
  s_waitcnt lgkmcnt(4)
  v_mfma_f32_16x16x32_bf16 v[160:163], v[232:235], a[208:211], v[160:163]
  ds_read_b64_tr_b16 v[228:229], v250 offset:6144
  v_mfma_f32_16x16x32_bf16 v[164:167], v[232:235], a[212:215], v[164:167]
  ds_read_b64_tr_b16 v[230:231], v250 offset:9216
  v_mfma_f32_16x16x32_bf16 v[168:171], v[232:235], a[216:219], v[168:171]
  buffer_load_dwordx4 v246, s[12:15], s38 offen offset:2048 lds
  v_mfma_f32_16x16x32_bf16 v[172:175], v[232:235], a[220:223], v[172:175]
  s_waitcnt lgkmcnt(4)
  v_mfma_f32_16x16x32_bf16 v[176:179], v[236:239], a[208:211], v[176:179]
  ds_read_b64_tr_b16 v[232:233], v251 offset:32
  v_mfma_f32_16x16x32_bf16 v[180:183], v[236:239], a[212:215], v[180:183]
  ds_read_b64_tr_b16 v[234:235], v251 offset:3104
  v_mfma_f32_16x16x32_bf16 v[184:187], v[236:239], a[216:219], v[184:187]
  v_mfma_f32_16x16x32_bf16 v[188:191], v[236:239], a[220:223], v[188:191]
  s_waitcnt lgkmcnt(4)
  v_mfma_f32_16x16x32_bf16 v[0:3], v[224:227], a[224:227], v[0:3]
  ds_read_b64_tr_b16 v[236:237], v251 offset:6176
  v_mfma_f32_16x16x32_bf16 v[4:7], v[224:227], a[228:231], v[4:7]
  ds_read_b64_tr_b16 v[238:239], v251 offset:9248
  v_mfma_f32_16x16x32_bf16 v[8:11], v[224:227], a[232:235], v[8:11]
  s_add_u32 m0, s31, 110592
  s_add_u32 s38, s43, 2359296
  buffer_load_dwordx4 v244, s[12:15], s38 offen offset:0 lds
  v_mfma_f32_16x16x32_bf16 v[12:15], v[224:227], a[236:239], v[12:15]
  s_waitcnt lgkmcnt(4)
  v_mfma_f32_16x16x32_bf16 v[16:19], v[228:231], a[224:227], v[16:19]
  ds_read_b64_tr_b16 v[224:225], v250 offset:64
  v_mfma_f32_16x16x32_bf16 v[20:23], v[228:231], a[228:231], v[20:23]
  ds_read_b64_tr_b16 v[226:227], v250 offset:3136
  v_mfma_f32_16x16x32_bf16 v[24:27], v[228:231], a[232:235], v[24:27]
  v_mfma_f32_16x16x32_bf16 v[28:31], v[228:231], a[236:239], v[28:31]
  s_waitcnt lgkmcnt(4)
  v_mfma_f32_16x16x32_bf16 v[32:35], v[232:235], a[224:227], v[32:35]
  ds_read_b64_tr_b16 v[228:229], v250 offset:6208
  v_mfma_f32_16x16x32_bf16 v[36:39], v[232:235], a[228:231], v[36:39]
  ds_read_b64_tr_b16 v[230:231], v250 offset:9280
  v_mfma_f32_16x16x32_bf16 v[40:43], v[232:235], a[232:235], v[40:43]
  buffer_load_dwordx4 v245, s[12:15], s38 offen offset:1024 lds
  v_mfma_f32_16x16x32_bf16 v[44:47], v[232:235], a[236:239], v[44:47]
  s_waitcnt lgkmcnt(4)
  v_mfma_f32_16x16x32_bf16 v[48:51], v[236:239], a[224:227], v[48:51]
  ds_read_b64_tr_b16 v[232:233], v251 offset:96
  v_mfma_f32_16x16x32_bf16 v[52:55], v[236:239], a[228:231], v[52:55]
  ds_read_b64_tr_b16 v[234:235], v251 offset:3168
  v_mfma_f32_16x16x32_bf16 v[56:59], v[236:239], a[232:235], v[56:59]
  v_mfma_f32_16x16x32_bf16 v[60:63], v[236:239], a[236:239], v[60:63]
  s_waitcnt lgkmcnt(4)
  v_mfma_f32_16x16x32_bf16 v[64:67], v[224:227], a[224:227], v[64:67]
  ds_read_b64_tr_b16 v[236:237], v251 offset:6240
  v_mfma_f32_16x16x32_bf16 v[68:71], v[224:227], a[228:231], v[68:71]
  ds_read_b64_tr_b16 v[238:239], v251 offset:9312
  v_mfma_f32_16x16x32_bf16 v[72:75], v[224:227], a[232:235], v[72:75]
  buffer_load_dwordx4 v246, s[12:15], s38 offen offset:2048 lds
  v_mfma_f32_16x16x32_bf16 v[76:79], v[224:227], a[236:239], v[76:79]
  s_waitcnt lgkmcnt(4)
  v_mfma_f32_16x16x32_bf16 v[80:83], v[228:231], a[224:227], v[80:83]
  ds_read_b64_tr_b16 v[224:225], v250 offset:128
  v_mfma_f32_16x16x32_bf16 v[84:87], v[228:231], a[228:231], v[84:87]
  ds_read_b64_tr_b16 v[226:227], v250 offset:3200
  v_mfma_f32_16x16x32_bf16 v[88:91], v[228:231], a[232:235], v[88:91]
  v_mfma_f32_16x16x32_bf16 v[92:95], v[228:231], a[236:239], v[92:95]
  s_waitcnt lgkmcnt(4)
  v_mfma_f32_16x16x32_bf16 v[96:99], v[232:235], a[224:227], v[96:99]
  ds_read_b64_tr_b16 v[228:229], v250 offset:6272
  v_mfma_f32_16x16x32_bf16 v[100:103], v[232:235], a[228:231], v[100:103]
  ds_read_b64_tr_b16 v[230:231], v250 offset:9344
  v_mfma_f32_16x16x32_bf16 v[104:107], v[232:235], a[232:235], v[104:107]
  s_add_u32 m0, s31, 122880
  s_add_u32 s38, s43, 2949120
  buffer_load_dwordx4 v244, s[12:15], s38 offen offset:0 lds
  v_mfma_f32_16x16x32_bf16 v[108:111], v[232:235], a[236:239], v[108:111]
  s_waitcnt lgkmcnt(4)
  v_mfma_f32_16x16x32_bf16 v[112:115], v[236:239], a[224:227], v[112:115]
  ds_read_b64_tr_b16 v[232:233], v251 offset:160
  v_mfma_f32_16x16x32_bf16 v[116:119], v[236:239], a[228:231], v[116:119]
  ds_read_b64_tr_b16 v[234:235], v251 offset:3232
  v_mfma_f32_16x16x32_bf16 v[120:123], v[236:239], a[232:235], v[120:123]
  v_mfma_f32_16x16x32_bf16 v[124:127], v[236:239], a[236:239], v[124:127]
  s_waitcnt lgkmcnt(4)
  v_mfma_f32_16x16x32_bf16 v[128:131], v[224:227], a[224:227], v[128:131]
  ds_read_b64_tr_b16 v[236:237], v251 offset:6304
  v_mfma_f32_16x16x32_bf16 v[132:135], v[224:227], a[228:231], v[132:135]
  ds_read_b64_tr_b16 v[238:239], v251 offset:9376
  v_mfma_f32_16x16x32_bf16 v[136:139], v[224:227], a[232:235], v[136:139]
  buffer_load_dwordx4 v245, s[12:15], s38 offen offset:1024 lds
  v_mfma_f32_16x16x32_bf16 v[140:143], v[224:227], a[236:239], v[140:143]
  v_add_u32 v250, 24576, v247
  v_add_u32 v251, 24576, v248
  s_waitcnt lgkmcnt(4)
  v_mfma_f32_16x16x32_bf16 v[144:147], v[228:231], a[224:227], v[144:147]
  ds_read_b64_tr_b16 v[224:225], v250 offset:0
  v_mfma_f32_16x16x32_bf16 v[148:151], v[228:231], a[228:231], v[148:151]
  ds_read_b64_tr_b16 v[226:227], v250 offset:3072
  v_mfma_f32_16x16x32_bf16 v[152:155], v[228:231], a[232:235], v[152:155]
  v_mfma_f32_16x16x32_bf16 v[156:159], v[228:231], a[236:239], v[156:159]
  s_waitcnt lgkmcnt(4)
  v_mfma_f32_16x16x32_bf16 v[160:163], v[232:235], a[224:227], v[160:163]
  ds_read_b64_tr_b16 v[228:229], v250 offset:6144
  v_mfma_f32_16x16x32_bf16 v[164:167], v[232:235], a[228:231], v[164:167]
  ds_read_b64_tr_b16 v[230:231], v250 offset:9216
  v_mfma_f32_16x16x32_bf16 v[168:171], v[232:235], a[232:235], v[168:171]
  buffer_load_dwordx4 v246, s[12:15], s38 offen offset:2048 lds
  v_mfma_f32_16x16x32_bf16 v[172:175], v[232:235], a[236:239], v[172:175]
  s_waitcnt lgkmcnt(4)
  v_mfma_f32_16x16x32_bf16 v[176:179], v[236:239], a[224:227], v[176:179]
  ds_read_b64_tr_b16 v[232:233], v251 offset:32
  v_mfma_f32_16x16x32_bf16 v[180:183], v[236:239], a[228:231], v[180:183]
  ds_read_b64_tr_b16 v[234:235], v251 offset:3104
  v_mfma_f32_16x16x32_bf16 v[184:187], v[236:239], a[232:235], v[184:187]
  v_mfma_f32_16x16x32_bf16 v[188:191], v[236:239], a[236:239], v[188:191]
  s_waitcnt vmcnt(32)
  s_waitcnt lgkmcnt(4)
  v_mfma_f32_16x16x32_bf16 v[0:3], v[224:227], a[240:243], v[0:3]
  ds_read_b64_tr_b16 v[236:237], v251 offset:6176
  v_mfma_f32_16x16x32_bf16 v[4:7], v[224:227], a[244:247], v[4:7]
  ds_read_b64_tr_b16 v[238:239], v251 offset:9248
  v_mfma_f32_16x16x32_bf16 v[8:11], v[224:227], a[248:251], v[8:11]
  s_add_u32 m0, s31, 135168
  s_add_u32 s38, s43, 3538944
  buffer_load_dwordx4 v244, s[12:15], s38 offen offset:0 lds
  v_mfma_f32_16x16x32_bf16 v[12:15], v[224:227], a[252:255], v[12:15]
  s_waitcnt lgkmcnt(4)
  v_mfma_f32_16x16x32_bf16 v[16:19], v[228:231], a[240:243], v[16:19]
  ds_read_b64_tr_b16 v[224:225], v250 offset:64
  v_mfma_f32_16x16x32_bf16 v[20:23], v[228:231], a[244:247], v[20:23]
  ds_read_b64_tr_b16 v[226:227], v250 offset:3136
  v_mfma_f32_16x16x32_bf16 v[24:27], v[228:231], a[248:251], v[24:27]
  v_mfma_f32_16x16x32_bf16 v[28:31], v[228:231], a[252:255], v[28:31]
  s_waitcnt lgkmcnt(4)
  v_mfma_f32_16x16x32_bf16 v[32:35], v[232:235], a[240:243], v[32:35]
  ds_read_b64_tr_b16 v[228:229], v250 offset:6208
  v_mfma_f32_16x16x32_bf16 v[36:39], v[232:235], a[244:247], v[36:39]
  ds_read_b64_tr_b16 v[230:231], v250 offset:9280
  v_mfma_f32_16x16x32_bf16 v[40:43], v[232:235], a[248:251], v[40:43]
  buffer_load_dwordx4 v245, s[12:15], s38 offen offset:1024 lds
  v_mfma_f32_16x16x32_bf16 v[44:47], v[232:235], a[252:255], v[44:47]
  s_waitcnt lgkmcnt(4)
  v_mfma_f32_16x16x32_bf16 v[48:51], v[236:239], a[240:243], v[48:51]
  ds_read_b64_tr_b16 v[232:233], v251 offset:96
  v_mfma_f32_16x16x32_bf16 v[52:55], v[236:239], a[244:247], v[52:55]
  ds_read_b64_tr_b16 v[234:235], v251 offset:3168
  v_mfma_f32_16x16x32_bf16 v[56:59], v[236:239], a[248:251], v[56:59]
  v_mfma_f32_16x16x32_bf16 v[60:63], v[236:239], a[252:255], v[60:63]
  s_waitcnt lgkmcnt(4)
  v_mfma_f32_16x16x32_bf16 v[64:67], v[224:227], a[240:243], v[64:67]
  ds_read_b64_tr_b16 v[236:237], v251 offset:6240
  v_mfma_f32_16x16x32_bf16 v[68:71], v[224:227], a[244:247], v[68:71]
  ds_read_b64_tr_b16 v[238:239], v251 offset:9312
  v_mfma_f32_16x16x32_bf16 v[72:75], v[224:227], a[248:251], v[72:75]
  buffer_load_dwordx4 v246, s[12:15], s38 offen offset:2048 lds
  v_mfma_f32_16x16x32_bf16 v[76:79], v[224:227], a[252:255], v[76:79]
  s_waitcnt lgkmcnt(4)
  v_mfma_f32_16x16x32_bf16 v[80:83], v[228:231], a[240:243], v[80:83]
  ds_read_b64_tr_b16 v[224:225], v250 offset:128
  v_mfma_f32_16x16x32_bf16 v[84:87], v[228:231], a[244:247], v[84:87]
  ds_read_b64_tr_b16 v[226:227], v250 offset:3200
  v_mfma_f32_16x16x32_bf16 v[88:91], v[228:231], a[248:251], v[88:91]
  v_mfma_f32_16x16x32_bf16 v[92:95], v[228:231], a[252:255], v[92:95]
  s_waitcnt lgkmcnt(4)
  v_mfma_f32_16x16x32_bf16 v[96:99], v[232:235], a[240:243], v[96:99]
  ds_read_b64_tr_b16 v[228:229], v250 offset:6272
  v_mfma_f32_16x16x32_bf16 v[100:103], v[232:235], a[244:247], v[100:103]
  ds_read_b64_tr_b16 v[230:231], v250 offset:9344
  v_mfma_f32_16x16x32_bf16 v[104:107], v[232:235], a[248:251], v[104:107]
  s_add_u32 m0, s31, 147456
  s_add_u32 s38, s43, 4128768
  buffer_load_dwordx4 v244, s[12:15], s38 offen offset:0 lds
  v_mfma_f32_16x16x32_bf16 v[108:111], v[232:235], a[252:255], v[108:111]
  s_waitcnt lgkmcnt(4)
  v_mfma_f32_16x16x32_bf16 v[112:115], v[236:239], a[240:243], v[112:115]
  ds_read_b64_tr_b16 v[232:233], v251 offset:160
  v_mfma_f32_16x16x32_bf16 v[116:119], v[236:239], a[244:247], v[116:119]
  ds_read_b64_tr_b16 v[234:235], v251 offset:3232
  v_mfma_f32_16x16x32_bf16 v[120:123], v[236:239], a[248:251], v[120:123]
  v_mfma_f32_16x16x32_bf16 v[124:127], v[236:239], a[252:255], v[124:127]
  s_waitcnt lgkmcnt(4)
  v_mfma_f32_16x16x32_bf16 v[128:131], v[224:227], a[240:243], v[128:131]
  ds_read_b64_tr_b16 v[236:237], v251 offset:6304
  v_mfma_f32_16x16x32_bf16 v[132:135], v[224:227], a[244:247], v[132:135]
  ds_read_b64_tr_b16 v[238:239], v251 offset:9376
  v_mfma_f32_16x16x32_bf16 v[136:139], v[224:227], a[248:251], v[136:139]
  buffer_load_dwordx4 v245, s[12:15], s38 offen offset:1024 lds
  v_mfma_f32_16x16x32_bf16 v[140:143], v[224:227], a[252:255], v[140:143]
  s_waitcnt vmcnt(27)
  s_barrier
  v_add_u32 v250, 36864, v247
  v_add_u32 v251, 36864, v248
  s_waitcnt lgkmcnt(4)
  v_mfma_f32_16x16x32_bf16 v[144:147], v[228:231], a[240:243], v[144:147]
  ds_read_b64_tr_b16 v[224:225], v250 offset:0
  v_mfma_f32_16x16x32_bf16 v[148:151], v[228:231], a[244:247], v[148:151]
  ds_read_b64_tr_b16 v[226:227], v250 offset:3072
  v_mfma_f32_16x16x32_bf16 v[152:155], v[228:231], a[248:251], v[152:155]
  v_mfma_f32_16x16x32_bf16 v[156:159], v[228:231], a[252:255], v[156:159]
  s_waitcnt lgkmcnt(4)
  v_mfma_f32_16x16x32_bf16 v[160:163], v[232:235], a[240:243], v[160:163]
  ds_read_b64_tr_b16 v[228:229], v250 offset:6144
  v_mfma_f32_16x16x32_bf16 v[164:167], v[232:235], a[244:247], v[164:167]
  ds_read_b64_tr_b16 v[230:231], v250 offset:9216
  v_mfma_f32_16x16x32_bf16 v[168:171], v[232:235], a[248:251], v[168:171]
  buffer_load_dwordx4 v246, s[12:15], s38 offen offset:2048 lds
  v_mfma_f32_16x16x32_bf16 v[172:175], v[232:235], a[252:255], v[172:175]
  s_waitcnt lgkmcnt(4)
  v_mfma_f32_16x16x32_bf16 v[176:179], v[236:239], a[240:243], v[176:179]
  ds_read_b64_tr_b16 v[232:233], v251 offset:32
  v_mfma_f32_16x16x32_bf16 v[180:183], v[236:239], a[244:247], v[180:183]
  ds_read_b64_tr_b16 v[234:235], v251 offset:3104
  v_mfma_f32_16x16x32_bf16 v[184:187], v[236:239], a[248:251], v[184:187]
  v_mfma_f32_16x16x32_bf16 v[188:191], v[236:239], a[252:255], v[188:191]
  s_waitcnt lgkmcnt(4)
  v_mfma_f32_16x16x32_bf16 v[0:3], v[224:227], v[192:195], v[0:3]
  ds_read_b64_tr_b16 v[236:237], v251 offset:6176
  v_mfma_f32_16x16x32_bf16 v[4:7], v[224:227], v[196:199], v[4:7]
  ds_read_b64_tr_b16 v[238:239], v251 offset:9248
  v_mfma_f32_16x16x32_bf16 v[8:11], v[224:227], v[200:203], v[8:11]
  s_add_u32 m0, s31, 0
  s_add_u32 s38, s43, 4718592
  buffer_load_dwordx4 v244, s[12:15], s38 offen offset:0 lds
  v_mfma_f32_16x16x32_bf16 v[12:15], v[224:227], v[204:207], v[12:15]
  s_waitcnt lgkmcnt(4)
  v_mfma_f32_16x16x32_bf16 v[16:19], v[228:231], v[192:195], v[16:19]
  ds_read_b64_tr_b16 v[224:225], v250 offset:64
  v_mfma_f32_16x16x32_bf16 v[20:23], v[228:231], v[196:199], v[20:23]
  ds_read_b64_tr_b16 v[226:227], v250 offset:3136
  v_mfma_f32_16x16x32_bf16 v[24:27], v[228:231], v[200:203], v[24:27]
  v_mfma_f32_16x16x32_bf16 v[28:31], v[228:231], v[204:207], v[28:31]
  s_waitcnt lgkmcnt(4)
  v_mfma_f32_16x16x32_bf16 v[32:35], v[232:235], v[192:195], v[32:35]
  ds_read_b64_tr_b16 v[228:229], v250 offset:6208
  v_mfma_f32_16x16x32_bf16 v[36:39], v[232:235], v[196:199], v[36:39]
  ds_read_b64_tr_b16 v[230:231], v250 offset:9280
  v_mfma_f32_16x16x32_bf16 v[40:43], v[232:235], v[200:203], v[40:43]
  buffer_load_dwordx4 v245, s[12:15], s38 offen offset:1024 lds
  v_mfma_f32_16x16x32_bf16 v[44:47], v[232:235], v[204:207], v[44:47]
  s_waitcnt lgkmcnt(4)
  v_mfma_f32_16x16x32_bf16 v[48:51], v[236:239], v[192:195], v[48:51]
  ds_read_b64_tr_b16 v[232:233], v251 offset:96
  v_mfma_f32_16x16x32_bf16 v[52:55], v[236:239], v[196:199], v[52:55]
  ds_read_b64_tr_b16 v[234:235], v251 offset:3168
  v_mfma_f32_16x16x32_bf16 v[56:59], v[236:239], v[200:203], v[56:59]
  v_mfma_f32_16x16x32_bf16 v[60:63], v[236:239], v[204:207], v[60:63]
  s_waitcnt lgkmcnt(4)
  v_mfma_f32_16x16x32_bf16 v[64:67], v[224:227], v[192:195], v[64:67]
  ds_read_b64_tr_b16 v[236:237], v251 offset:6240
  v_mfma_f32_16x16x32_bf16 v[68:71], v[224:227], v[196:199], v[68:71]
  ds_read_b64_tr_b16 v[238:239], v251 offset:9312
  v_mfma_f32_16x16x32_bf16 v[72:75], v[224:227], v[200:203], v[72:75]
  buffer_load_dwordx4 v246, s[12:15], s38 offen offset:2048 lds
  v_mfma_f32_16x16x32_bf16 v[76:79], v[224:227], v[204:207], v[76:79]
  s_waitcnt lgkmcnt(4)
  v_mfma_f32_16x16x32_bf16 v[80:83], v[228:231], v[192:195], v[80:83]
  ds_read_b64_tr_b16 v[224:225], v250 offset:128
  v_mfma_f32_16x16x32_bf16 v[84:87], v[228:231], v[196:199], v[84:87]
  ds_read_b64_tr_b16 v[226:227], v250 offset:3200
  v_mfma_f32_16x16x32_bf16 v[88:91], v[228:231], v[200:203], v[88:91]
  v_mfma_f32_16x16x32_bf16 v[92:95], v[228:231], v[204:207], v[92:95]
  s_waitcnt lgkmcnt(4)
  v_mfma_f32_16x16x32_bf16 v[96:99], v[232:235], v[192:195], v[96:99]
  ds_read_b64_tr_b16 v[228:229], v250 offset:6272
  v_mfma_f32_16x16x32_bf16 v[100:103], v[232:235], v[196:199], v[100:103]
  ds_read_b64_tr_b16 v[230:231], v250 offset:9344
  v_mfma_f32_16x16x32_bf16 v[104:107], v[232:235], v[200:203], v[104:107]
  v_mfma_f32_16x16x32_bf16 v[108:111], v[232:235], v[204:207], v[108:111]
  s_waitcnt lgkmcnt(4)
  v_mfma_f32_16x16x32_bf16 v[112:115], v[236:239], v[192:195], v[112:115]
  ds_read_b64_tr_b16 v[232:233], v251 offset:160
  v_mfma_f32_16x16x32_bf16 v[116:119], v[236:239], v[196:199], v[116:119]
  ds_read_b64_tr_b16 v[234:235], v251 offset:3232
  v_mfma_f32_16x16x32_bf16 v[120:123], v[236:239], v[200:203], v[120:123]
  v_mfma_f32_16x16x32_bf16 v[124:127], v[236:239], v[204:207], v[124:127]
  s_waitcnt lgkmcnt(4)
  v_mfma_f32_16x16x32_bf16 v[128:131], v[224:227], v[192:195], v[128:131]
  ds_read_b64_tr_b16 v[236:237], v251 offset:6304
  v_mfma_f32_16x16x32_bf16 v[132:135], v[224:227], v[196:199], v[132:135]
  ds_read_b64_tr_b16 v[238:239], v251 offset:9376
  v_mfma_f32_16x16x32_bf16 v[136:139], v[224:227], v[200:203], v[136:139]
  v_mfma_f32_16x16x32_bf16 v[140:143], v[224:227], v[204:207], v[140:143]
  v_add_u32 v250, 49152, v247
  v_add_u32 v251, 49152, v248
  s_waitcnt lgkmcnt(4)
  v_mfma_f32_16x16x32_bf16 v[144:147], v[228:231], v[192:195], v[144:147]
  ds_read_b64_tr_b16 v[224:225], v250 offset:0
  v_mfma_f32_16x16x32_bf16 v[148:151], v[228:231], v[196:199], v[148:151]
  ds_read_b64_tr_b16 v[226:227], v250 offset:3072
  v_mfma_f32_16x16x32_bf16 v[152:155], v[228:231], v[200:203], v[152:155]
  v_mfma_f32_16x16x32_bf16 v[156:159], v[228:231], v[204:207], v[156:159]
  s_waitcnt lgkmcnt(4)
  v_mfma_f32_16x16x32_bf16 v[160:163], v[232:235], v[192:195], v[160:163]
  ds_read_b64_tr_b16 v[228:229], v250 offset:6144
  v_mfma_f32_16x16x32_bf16 v[164:167], v[232:235], v[196:199], v[164:167]
  ds_read_b64_tr_b16 v[230:231], v250 offset:9216
  v_mfma_f32_16x16x32_bf16 v[168:171], v[232:235], v[200:203], v[168:171]
  v_mfma_f32_16x16x32_bf16 v[172:175], v[232:235], v[204:207], v[172:175]
  s_waitcnt lgkmcnt(4)
  v_mfma_f32_16x16x32_bf16 v[176:179], v[236:239], v[192:195], v[176:179]
  ds_read_b64_tr_b16 v[232:233], v251 offset:32
  v_mfma_f32_16x16x32_bf16 v[180:183], v[236:239], v[196:199], v[180:183]
  ds_read_b64_tr_b16 v[234:235], v251 offset:3104
  v_mfma_f32_16x16x32_bf16 v[184:187], v[236:239], v[200:203], v[184:187]
  v_mfma_f32_16x16x32_bf16 v[188:191], v[236:239], v[204:207], v[188:191]
  s_waitcnt vmcnt(27)
  s_waitcnt lgkmcnt(4)
  v_mfma_f32_16x16x32_bf16 v[0:3], v[224:227], v[208:211], v[0:3]
  ds_read_b64_tr_b16 v[236:237], v251 offset:6176
  v_mfma_f32_16x16x32_bf16 v[4:7], v[224:227], v[212:215], v[4:7]
  ds_read_b64_tr_b16 v[238:239], v251 offset:9248
  v_mfma_f32_16x16x32_bf16 v[8:11], v[224:227], v[216:219], v[8:11]
  v_mfma_f32_16x16x32_bf16 v[12:15], v[224:227], v[220:223], v[12:15]
  s_waitcnt lgkmcnt(4)
  v_mfma_f32_16x16x32_bf16 v[16:19], v[228:231], v[208:211], v[16:19]
  ds_read_b64_tr_b16 v[224:225], v250 offset:64
  v_mfma_f32_16x16x32_bf16 v[20:23], v[228:231], v[212:215], v[20:23]
  ds_read_b64_tr_b16 v[226:227], v250 offset:3136
  v_mfma_f32_16x16x32_bf16 v[24:27], v[228:231], v[216:219], v[24:27]
  v_mfma_f32_16x16x32_bf16 v[28:31], v[228:231], v[220:223], v[28:31]
  s_waitcnt lgkmcnt(4)
  v_mfma_f32_16x16x32_bf16 v[32:35], v[232:235], v[208:211], v[32:35]
  ds_read_b64_tr_b16 v[228:229], v250 offset:6208
  v_mfma_f32_16x16x32_bf16 v[36:39], v[232:235], v[212:215], v[36:39]
  ds_read_b64_tr_b16 v[230:231], v250 offset:9280
  v_mfma_f32_16x16x32_bf16 v[40:43], v[232:235], v[216:219], v[40:43]
  v_mfma_f32_16x16x32_bf16 v[44:47], v[232:235], v[220:223], v[44:47]
  s_waitcnt lgkmcnt(4)
  v_mfma_f32_16x16x32_bf16 v[48:51], v[236:239], v[208:211], v[48:51]
  ds_read_b64_tr_b16 v[232:233], v251 offset:96
  v_mfma_f32_16x16x32_bf16 v[52:55], v[236:239], v[212:215], v[52:55]
  ds_read_b64_tr_b16 v[234:235], v251 offset:3168
  v_mfma_f32_16x16x32_bf16 v[56:59], v[236:239], v[216:219], v[56:59]
  v_mfma_f32_16x16x32_bf16 v[60:63], v[236:239], v[220:223], v[60:63]
  s_waitcnt lgkmcnt(4)
  v_mfma_f32_16x16x32_bf16 v[64:67], v[224:227], v[208:211], v[64:67]
  ds_read_b64_tr_b16 v[236:237], v251 offset:6240
  v_mfma_f32_16x16x32_bf16 v[68:71], v[224:227], v[212:215], v[68:71]
  ds_read_b64_tr_b16 v[238:239], v251 offset:9312
  v_mfma_f32_16x16x32_bf16 v[72:75], v[224:227], v[216:219], v[72:75]
  v_mfma_f32_16x16x32_bf16 v[76:79], v[224:227], v[220:223], v[76:79]
  s_waitcnt lgkmcnt(4)
  v_mfma_f32_16x16x32_bf16 v[80:83], v[228:231], v[208:211], v[80:83]
  ds_read_b64_tr_b16 v[224:225], v250 offset:128
  v_mfma_f32_16x16x32_bf16 v[84:87], v[228:231], v[212:215], v[84:87]
  ds_read_b64_tr_b16 v[226:227], v250 offset:3200
  v_mfma_f32_16x16x32_bf16 v[88:91], v[228:231], v[216:219], v[88:91]
  v_mfma_f32_16x16x32_bf16 v[92:95], v[228:231], v[220:223], v[92:95]
  s_waitcnt lgkmcnt(4)
  v_mfma_f32_16x16x32_bf16 v[96:99], v[232:235], v[208:211], v[96:99]
  ds_read_b64_tr_b16 v[228:229], v250 offset:6272
  v_mfma_f32_16x16x32_bf16 v[100:103], v[232:235], v[212:215], v[100:103]
  ds_read_b64_tr_b16 v[230:231], v250 offset:9344
  v_mfma_f32_16x16x32_bf16 v[104:107], v[232:235], v[216:219], v[104:107]
  v_mfma_f32_16x16x32_bf16 v[108:111], v[232:235], v[220:223], v[108:111]
  s_waitcnt lgkmcnt(4)
  v_mfma_f32_16x16x32_bf16 v[112:115], v[236:239], v[208:211], v[112:115]
  ds_read_b64_tr_b16 v[232:233], v251 offset:160
  v_mfma_f32_16x16x32_bf16 v[116:119], v[236:239], v[212:215], v[116:119]
  ds_read_b64_tr_b16 v[234:235], v251 offset:3232
  v_mfma_f32_16x16x32_bf16 v[120:123], v[236:239], v[216:219], v[120:123]
  v_mfma_f32_16x16x32_bf16 v[124:127], v[236:239], v[220:223], v[124:127]
  s_waitcnt lgkmcnt(4)
  v_mfma_f32_16x16x32_bf16 v[128:131], v[224:227], v[208:211], v[128:131]
  ds_read_b64_tr_b16 v[236:237], v251 offset:6304
  v_mfma_f32_16x16x32_bf16 v[132:135], v[224:227], v[212:215], v[132:135]
  ds_read_b64_tr_b16 v[238:239], v251 offset:9376
  v_mfma_f32_16x16x32_bf16 v[136:139], v[224:227], v[216:219], v[136:139]
  v_mfma_f32_16x16x32_bf16 v[140:143], v[224:227], v[220:223], v[140:143]
  s_waitcnt vmcnt(18)
  s_barrier
  v_add_u32 v250, 61440, v249
  s_waitcnt lgkmcnt(4)
  v_mfma_f32_16x16x32_bf16 v[144:147], v[228:231], v[208:211], v[144:147]
  ds_read_b64_tr_b16 v[224:225], v250 offset:0
  v_mfma_f32_16x16x32_bf16 v[148:151], v[228:231], v[212:215], v[148:151]
  ds_read_b64_tr_b16 v[226:227], v250 offset:1536
  v_mfma_f32_16x16x32_bf16 v[152:155], v[228:231], v[216:219], v[152:155]
  v_mfma_f32_16x16x32_bf16 v[156:159], v[228:231], v[220:223], v[156:159]
  s_waitcnt lgkmcnt(4)
  v_mfma_f32_16x16x32_bf16 v[160:163], v[232:235], v[208:211], v[160:163]
  ds_read_b64_tr_b16 v[228:229], v250 offset:6144
  v_mfma_f32_16x16x32_bf16 v[164:167], v[232:235], v[212:215], v[164:167]
  ds_read_b64_tr_b16 v[230:231], v250 offset:7680
  v_mfma_f32_16x16x32_bf16 v[168:171], v[232:235], v[216:219], v[168:171]
  v_mfma_f32_16x16x32_bf16 v[172:175], v[232:235], v[220:223], v[172:175]
  s_waitcnt lgkmcnt(4)
  v_mfma_f32_16x16x32_bf16 v[176:179], v[236:239], v[208:211], v[176:179]
  ds_read_b64_tr_b16 v[232:233], v250 offset:32
  v_mfma_f32_16x16x32_bf16 v[180:183], v[236:239], v[212:215], v[180:183]
  ds_read_b64_tr_b16 v[234:235], v250 offset:1568
  v_mfma_f32_16x16x32_bf16 v[184:187], v[236:239], v[216:219], v[184:187]
  v_mfma_f32_16x16x32_bf16 v[188:191], v[236:239], v[220:223], v[188:191]
  v_mul_f32 v0, v0, v16
  v_mul_f32 v1, v1, v17
  v_mul_f32 v2, v2, v18
  v_mul_f32 v3, v3, v19
  v_mul_f32 v32, v32, v48
  v_mul_f32 v33, v33, v49
  v_mul_f32 v34, v34, v50
  v_mul_f32 v35, v35, v51
  v_cvt_pk_bf16_f32 v16, v0, v1
  v_cvt_pk_bf16_f32 v17, v2, v3
  v_cvt_pk_bf16_f32 v18, v32, v33
  v_cvt_pk_bf16_f32 v19, v34, v35
  s_add_u32 s44, s37, 0
  buffer_store_dwordx4 v[16:19], v240, s[20:23], s44 offen sc0 sc1
  v_mul_f32 v4, v4, v20
  v_mul_f32 v5, v5, v21
  v_mul_f32 v6, v6, v22
  v_mul_f32 v7, v7, v23
  v_mul_f32 v36, v36, v52
  v_mul_f32 v37, v37, v53
  v_mul_f32 v38, v38, v54
  v_mul_f32 v39, v39, v55
  v_cvt_pk_bf16_f32 v20, v4, v5
  v_cvt_pk_bf16_f32 v21, v6, v7
  v_cvt_pk_bf16_f32 v22, v36, v37
  v_cvt_pk_bf16_f32 v23, v38, v39
  s_add_u32 s44, s37, 147456
  buffer_store_dwordx4 v[20:23], v240, s[20:23], s44 offen sc0 sc1
  v_mul_f32 v8, v8, v24
  v_mul_f32 v9, v9, v25
  v_mul_f32 v10, v10, v26
  v_mul_f32 v11, v11, v27
  v_mul_f32 v40, v40, v56
  v_mul_f32 v41, v41, v57
  v_mul_f32 v42, v42, v58
  v_mul_f32 v43, v43, v59
  v_cvt_pk_bf16_f32 v24, v8, v9
  v_cvt_pk_bf16_f32 v25, v10, v11
  v_cvt_pk_bf16_f32 v26, v40, v41
  v_cvt_pk_bf16_f32 v27, v42, v43
  s_add_u32 s44, s37, 294912
  buffer_store_dwordx4 v[24:27], v240, s[20:23], s44 offen sc0 sc1
  v_mul_f32 v12, v12, v28
  v_mul_f32 v13, v13, v29
  v_mul_f32 v14, v14, v30
  v_mul_f32 v15, v15, v31
  v_mul_f32 v44, v44, v60
  v_mul_f32 v45, v45, v61
  v_mul_f32 v46, v46, v62
  v_mul_f32 v47, v47, v63
  v_cvt_pk_bf16_f32 v28, v12, v13
  v_cvt_pk_bf16_f32 v29, v14, v15
  v_cvt_pk_bf16_f32 v30, v44, v45
  v_cvt_pk_bf16_f32 v31, v46, v47
  s_add_u32 s44, s37, 442368
  buffer_store_dwordx4 v[28:31], v240, s[20:23], s44 offen sc0 sc1
  v_mul_f32 v64, v64, v80
  v_mul_f32 v65, v65, v81
  v_mul_f32 v66, v66, v82
  v_mul_f32 v67, v67, v83
  v_mul_f32 v96, v96, v112
  v_mul_f32 v97, v97, v113
  v_mul_f32 v98, v98, v114
  v_mul_f32 v99, v99, v115
  v_cvt_pk_bf16_f32 v80, v64, v65
  v_cvt_pk_bf16_f32 v81, v66, v67
  v_cvt_pk_bf16_f32 v82, v96, v97
  v_cvt_pk_bf16_f32 v83, v98, v99
  s_add_u32 s44, s37, 1024
  buffer_store_dwordx4 v[80:83], v240, s[20:23], s44 offen sc0 sc1
  v_mul_f32 v68, v68, v84
  v_mul_f32 v69, v69, v85
  v_mul_f32 v70, v70, v86
  v_mul_f32 v71, v71, v87
  v_mul_f32 v100, v100, v116
  v_mul_f32 v101, v101, v117
  v_mul_f32 v102, v102, v118
  v_mul_f32 v103, v103, v119
  v_cvt_pk_bf16_f32 v84, v68, v69
  v_cvt_pk_bf16_f32 v85, v70, v71
  v_cvt_pk_bf16_f32 v86, v100, v101
  v_cvt_pk_bf16_f32 v87, v102, v103
  s_add_u32 s44, s37, 148480
  buffer_store_dwordx4 v[84:87], v240, s[20:23], s44 offen sc0 sc1
  v_mul_f32 v72, v72, v88
  v_mul_f32 v73, v73, v89
  v_mul_f32 v74, v74, v90
  v_mul_f32 v75, v75, v91
  v_mul_f32 v104, v104, v120
  v_mul_f32 v105, v105, v121
  v_mul_f32 v106, v106, v122
  v_mul_f32 v107, v107, v123
  v_cvt_pk_bf16_f32 v88, v72, v73
  v_cvt_pk_bf16_f32 v89, v74, v75
  v_cvt_pk_bf16_f32 v90, v104, v105
  v_cvt_pk_bf16_f32 v91, v106, v107
  s_add_u32 s44, s37, 295936
  buffer_store_dwordx4 v[88:91], v240, s[20:23], s44 offen sc0 sc1
  v_mul_f32 v76, v76, v92
  v_mul_f32 v77, v77, v93
  v_mul_f32 v78, v78, v94
  v_mul_f32 v79, v79, v95
  v_mul_f32 v108, v108, v124
  v_mul_f32 v109, v109, v125
  v_mul_f32 v110, v110, v126
  v_mul_f32 v111, v111, v127
  v_cvt_pk_bf16_f32 v92, v76, v77
  v_cvt_pk_bf16_f32 v93, v78, v79
  v_cvt_pk_bf16_f32 v94, v108, v109
  v_cvt_pk_bf16_f32 v95, v110, v111
  s_add_u32 s44, s37, 443392
  buffer_store_dwordx4 v[92:95], v240, s[20:23], s44 offen sc0 sc1
  s_waitcnt lgkmcnt(4)
  v_mfma_f32_16x16x32_bf16 v[0:3], v[224:227], a[0:3], 0
  ds_read_b64_tr_b16 v[236:237], v250 offset:6176
  v_mfma_f32_16x16x32_bf16 v[4:7], v[224:227], a[4:7], 0
  ds_read_b64_tr_b16 v[238:239], v250 offset:7712
  v_mfma_f32_16x16x32_bf16 v[8:11], v[224:227], a[8:11], 0
  v_mul_f32 v128, v128, v144
  v_mfma_f32_16x16x32_bf16 v[12:15], v[224:227], a[12:15], 0
  v_mul_f32 v129, v129, v145
  v_mul_f32 v130, v130, v146
  s_waitcnt lgkmcnt(4)
  v_mfma_f32_16x16x32_bf16 v[16:19], v[228:231], a[0:3], 0
  ds_read_b64_tr_b16 v[224:225], v250 offset:64
  v_mfma_f32_16x16x32_bf16 v[20:23], v[228:231], a[4:7], 0
  ds_read_b64_tr_b16 v[226:227], v250 offset:1600
  v_mfma_f32_16x16x32_bf16 v[24:27], v[228:231], a[8:11], 0
  v_mul_f32 v131, v131, v147
  v_mfma_f32_16x16x32_bf16 v[28:31], v[228:231], a[12:15], 0
  v_mul_f32 v160, v160, v176
  v_mul_f32 v161, v161, v177
  s_waitcnt lgkmcnt(4)
  v_mfma_f32_16x16x32_bf16 v[32:35], v[232:235], a[0:3], 0
  ds_read_b64_tr_b16 v[228:229], v250 offset:6208
  v_mfma_f32_16x16x32_bf16 v[36:39], v[232:235], a[4:7], 0
  ds_read_b64_tr_b16 v[230:231], v250 offset:7744
  v_mfma_f32_16x16x32_bf16 v[40:43], v[232:235], a[8:11], 0
  v_mul_f32 v162, v162, v178
  v_mfma_f32_16x16x32_bf16 v[44:47], v[232:235], a[12:15], 0
  v_mul_f32 v163, v163, v179
  v_cvt_pk_bf16_f32 v144, v128, v129
  s_waitcnt lgkmcnt(4)
  v_mfma_f32_16x16x32_bf16 v[48:51], v[236:239], a[0:3], 0
  ds_read_b64_tr_b16 v[232:233], v250 offset:3072
  v_mfma_f32_16x16x32_bf16 v[52:55], v[236:239], a[4:7], 0
  ds_read_b64_tr_b16 v[234:235], v250 offset:4608
  v_mfma_f32_16x16x32_bf16 v[56:59], v[236:239], a[8:11], 0
  v_cvt_pk_bf16_f32 v145, v130, v131
  v_mfma_f32_16x16x32_bf16 v[60:63], v[236:239], a[12:15], 0
  v_cvt_pk_bf16_f32 v146, v160, v161
  v_cvt_pk_bf16_f32 v147, v162, v163
  s_waitcnt lgkmcnt(4)
  v_mfma_f32_16x16x32_bf16 v[64:67], v[224:227], a[0:3], 0
  ds_read_b64_tr_b16 v[236:237], v250 offset:9216
  v_mfma_f32_16x16x32_bf16 v[68:71], v[224:227], a[4:7], 0
  ds_read_b64_tr_b16 v[238:239], v250 offset:10752
  v_mfma_f32_16x16x32_bf16 v[72:75], v[224:227], a[8:11], 0
  s_add_u32 s44, s37, 2048
  buffer_store_dwordx4 v[144:147], v240, s[20:23], s44 offen sc0 sc1
  v_mfma_f32_16x16x32_bf16 v[76:79], v[224:227], a[12:15], 0
  v_mul_f32 v132, v132, v148
  v_mul_f32 v133, v133, v149
  s_waitcnt lgkmcnt(4)
  v_mfma_f32_16x16x32_bf16 v[80:83], v[228:231], a[0:3], 0
  ds_read_b64_tr_b16 v[224:225], v250 offset:3104
  v_mfma_f32_16x16x32_bf16 v[84:87], v[228:231], a[4:7], 0
  ds_read_b64_tr_b16 v[226:227], v250 offset:4640
  v_mfma_f32_16x16x32_bf16 v[88:91], v[228:231], a[8:11], 0
  v_mul_f32 v134, v134, v150
  v_mfma_f32_16x16x32_bf16 v[92:95], v[228:231], a[12:15], 0
  v_mul_f32 v135, v135, v151
  v_mul_f32 v164, v164, v180
  s_waitcnt lgkmcnt(4)
  v_mfma_f32_16x16x32_bf16 v[0:3], v[232:235], a[16:19], v[0:3]
  ds_read_b64_tr_b16 v[228:229], v250 offset:9248
  v_mfma_f32_16x16x32_bf16 v[4:7], v[232:235], a[20:23], v[4:7]
  ds_read_b64_tr_b16 v[230:231], v250 offset:10784
  v_mfma_f32_16x16x32_bf16 v[8:11], v[232:235], a[24:27], v[8:11]
  v_mul_f32 v165, v165, v181
  v_mfma_f32_16x16x32_bf16 v[12:15], v[232:235], a[28:31], v[12:15]
  v_mul_f32 v166, v166, v182
  v_mul_f32 v167, v167, v183
  s_waitcnt lgkmcnt(4)
  v_mfma_f32_16x16x32_bf16 v[16:19], v[236:239], a[16:19], v[16:19]
  ds_read_b64_tr_b16 v[232:233], v250 offset:3136
  v_mfma_f32_16x16x32_bf16 v[20:23], v[236:239], a[20:23], v[20:23]
  ds_read_b64_tr_b16 v[234:235], v250 offset:4672
  v_mfma_f32_16x16x32_bf16 v[24:27], v[236:239], a[24:27], v[24:27]
  v_cvt_pk_bf16_f32 v148, v132, v133
  v_mfma_f32_16x16x32_bf16 v[28:31], v[236:239], a[28:31], v[28:31]
  v_cvt_pk_bf16_f32 v149, v134, v135
  v_cvt_pk_bf16_f32 v150, v164, v165
  s_waitcnt lgkmcnt(4)
  v_mfma_f32_16x16x32_bf16 v[32:35], v[224:227], a[16:19], v[32:35]
  ds_read_b64_tr_b16 v[236:237], v250 offset:9280
  v_mfma_f32_16x16x32_bf16 v[36:39], v[224:227], a[20:23], v[36:39]
  ds_read_b64_tr_b16 v[238:239], v250 offset:10816
  v_mfma_f32_16x16x32_bf16 v[40:43], v[224:227], a[24:27], v[40:43]
  v_cvt_pk_bf16_f32 v151, v166, v167
  v_mfma_f32_16x16x32_bf16 v[44:47], v[224:227], a[28:31], v[44:47]
  s_add_u32 s44, s37, 149504
  buffer_store_dwordx4 v[148:151], v240, s[20:23], s44 offen sc0 sc1
  v_mul_f32 v136, v136, v152
  v_add_u32 v250, 73728, v249
  s_waitcnt lgkmcnt(4)
  v_mfma_f32_16x16x32_bf16 v[48:51], v[228:231], a[16:19], v[48:51]
  ds_read_b64_tr_b16 v[224:225], v250 offset:0
  v_mfma_f32_16x16x32_bf16 v[52:55], v[228:231], a[20:23], v[52:55]
  ds_read_b64_tr_b16 v[226:227], v250 offset:1536
  v_mfma_f32_16x16x32_bf16 v[56:59], v[228:231], a[24:27], v[56:59]
  v_mul_f32 v137, v137, v153
  v_mfma_f32_16x16x32_bf16 v[60:63], v[228:231], a[28:31], v[60:63]
  v_mul_f32 v138, v138, v154
  v_mul_f32 v139, v139, v155
  s_waitcnt lgkmcnt(4)
  v_mfma_f32_16x16x32_bf16 v[64:67], v[232:235], a[16:19], v[64:67]
  ds_read_b64_tr_b16 v[228:229], v250 offset:6144
  v_mfma_f32_16x16x32_bf16 v[68:71], v[232:235], a[20:23], v[68:71]
  ds_read_b64_tr_b16 v[230:231], v250 offset:7680
  v_mfma_f32_16x16x32_bf16 v[72:75], v[232:235], a[24:27], v[72:75]
  v_mul_f32 v168, v168, v184
  v_mfma_f32_16x16x32_bf16 v[76:79], v[232:235], a[28:31], v[76:79]
  v_mul_f32 v169, v169, v185
  v_mul_f32 v170, v170, v186
  s_waitcnt lgkmcnt(4)
  v_mfma_f32_16x16x32_bf16 v[80:83], v[236:239], a[16:19], v[80:83]
  ds_read_b64_tr_b16 v[232:233], v250 offset:32
  v_mfma_f32_16x16x32_bf16 v[84:87], v[236:239], a[20:23], v[84:87]
  ds_read_b64_tr_b16 v[234:235], v250 offset:1568
  v_mfma_f32_16x16x32_bf16 v[88:91], v[236:239], a[24:27], v[88:91]
  v_mul_f32 v171, v171, v187
  v_mfma_f32_16x16x32_bf16 v[92:95], v[236:239], a[28:31], v[92:95]
  v_cvt_pk_bf16_f32 v152, v136, v137
  v_cvt_pk_bf16_f32 v153, v138, v139
  s_waitcnt lgkmcnt(4)
  v_mfma_f32_16x16x32_bf16 v[0:3], v[224:227], a[32:35], v[0:3]
  ds_read_b64_tr_b16 v[236:237], v250 offset:6176
  v_mfma_f32_16x16x32_bf16 v[4:7], v[224:227], a[36:39], v[4:7]
  ds_read_b64_tr_b16 v[238:239], v250 offset:7712
  v_mfma_f32_16x16x32_bf16 v[8:11], v[224:227], a[40:43], v[8:11]
  v_cvt_pk_bf16_f32 v154, v168, v169
  v_mfma_f32_16x16x32_bf16 v[12:15], v[224:227], a[44:47], v[12:15]
  v_cvt_pk_bf16_f32 v155, v170, v171
  s_add_u32 s44, s37, 296960
  buffer_store_dwordx4 v[152:155], v240, s[20:23], s44 offen sc0 sc1
  s_waitcnt lgkmcnt(4)
  v_mfma_f32_16x16x32_bf16 v[16:19], v[228:231], a[32:35], v[16:19]
  ds_read_b64_tr_b16 v[224:225], v250 offset:64
  v_mfma_f32_16x16x32_bf16 v[20:23], v[228:231], a[36:39], v[20:23]
  ds_read_b64_tr_b16 v[226:227], v250 offset:1600
  v_mfma_f32_16x16x32_bf16 v[24:27], v[228:231], a[40:43], v[24:27]
  v_mul_f32 v140, v140, v156
  v_mfma_f32_16x16x32_bf16 v[28:31], v[228:231], a[44:47], v[28:31]
  v_mul_f32 v141, v141, v157
  v_mul_f32 v142, v142, v158
  s_waitcnt lgkmcnt(4)
  v_mfma_f32_16x16x32_bf16 v[32:35], v[232:235], a[32:35], v[32:35]
  ds_read_b64_tr_b16 v[228:229], v250 offset:6208
  v_mfma_f32_16x16x32_bf16 v[36:39], v[232:235], a[36:39], v[36:39]
  ds_read_b64_tr_b16 v[230:231], v250 offset:7744
  v_mfma_f32_16x16x32_bf16 v[40:43], v[232:235], a[40:43], v[40:43]
  v_mul_f32 v143, v143, v159
  v_mfma_f32_16x16x32_bf16 v[44:47], v[232:235], a[44:47], v[44:47]
  v_mul_f32 v172, v172, v188
  v_mul_f32 v173, v173, v189
  s_waitcnt lgkmcnt(4)
  v_mfma_f32_16x16x32_bf16 v[48:51], v[236:239], a[32:35], v[48:51]
  ds_read_b64_tr_b16 v[232:233], v250 offset:3072
  v_mfma_f32_16x16x32_bf16 v[52:55], v[236:239], a[36:39], v[52:55]
  ds_read_b64_tr_b16 v[234:235], v250 offset:4608
  v_mfma_f32_16x16x32_bf16 v[56:59], v[236:239], a[40:43], v[56:59]
  v_mul_f32 v174, v174, v190
  v_mfma_f32_16x16x32_bf16 v[60:63], v[236:239], a[44:47], v[60:63]
  v_mul_f32 v175, v175, v191
  v_cvt_pk_bf16_f32 v156, v140, v141
  s_waitcnt lgkmcnt(4)
  v_mfma_f32_16x16x32_bf16 v[64:67], v[224:227], a[32:35], v[64:67]
  ds_read_b64_tr_b16 v[236:237], v250 offset:9216
  v_mfma_f32_16x16x32_bf16 v[68:71], v[224:227], a[36:39], v[68:71]
  ds_read_b64_tr_b16 v[238:239], v250 offset:10752
  v_mfma_f32_16x16x32_bf16 v[72:75], v[224:227], a[40:43], v[72:75]
  v_cvt_pk_bf16_f32 v157, v142, v143
  v_mfma_f32_16x16x32_bf16 v[76:79], v[224:227], a[44:47], v[76:79]
  v_cvt_pk_bf16_f32 v158, v172, v173
  v_cvt_pk_bf16_f32 v159, v174, v175
  s_waitcnt lgkmcnt(4)
  v_mfma_f32_16x16x32_bf16 v[80:83], v[228:231], a[32:35], v[80:83]
  ds_read_b64_tr_b16 v[224:225], v250 offset:3104
  v_mfma_f32_16x16x32_bf16 v[84:87], v[228:231], a[36:39], v[84:87]
  ds_read_b64_tr_b16 v[226:227], v250 offset:4640
  v_mfma_f32_16x16x32_bf16 v[88:91], v[228:231], a[40:43], v[88:91]
  s_add_u32 s44, s37, 444416
  buffer_store_dwordx4 v[156:159], v240, s[20:23], s44 offen sc0 sc1
  v_mfma_f32_16x16x32_bf16 v[92:95], v[228:231], a[44:47], v[92:95]
  s_waitcnt lgkmcnt(4)
  v_mfma_f32_16x16x32_bf16 v[0:3], v[232:235], a[48:51], v[0:3]
  ds_read_b64_tr_b16 v[228:229], v250 offset:9248
  v_mfma_f32_16x16x32_bf16 v[4:7], v[232:235], a[52:55], v[4:7]
  ds_read_b64_tr_b16 v[230:231], v250 offset:10784
  v_mfma_f32_16x16x32_bf16 v[8:11], v[232:235], a[56:59], v[8:11]
  v_mfma_f32_16x16x32_bf16 v[12:15], v[232:235], a[60:63], v[12:15]
  s_waitcnt lgkmcnt(4)
  v_mfma_f32_16x16x32_bf16 v[16:19], v[236:239], a[48:51], v[16:19]
  ds_read_b64_tr_b16 v[232:233], v250 offset:3136
  v_mfma_f32_16x16x32_bf16 v[20:23], v[236:239], a[52:55], v[20:23]
  ds_read_b64_tr_b16 v[234:235], v250 offset:4672
  v_mfma_f32_16x16x32_bf16 v[24:27], v[236:239], a[56:59], v[24:27]
  v_mfma_f32_16x16x32_bf16 v[28:31], v[236:239], a[60:63], v[28:31]
  s_waitcnt lgkmcnt(4)
  v_mfma_f32_16x16x32_bf16 v[32:35], v[224:227], a[48:51], v[32:35]
  ds_read_b64_tr_b16 v[236:237], v250 offset:9280
  v_mfma_f32_16x16x32_bf16 v[36:39], v[224:227], a[52:55], v[36:39]
  ds_read_b64_tr_b16 v[238:239], v250 offset:10816
  v_mfma_f32_16x16x32_bf16 v[40:43], v[224:227], a[56:59], v[40:43]
  v_mfma_f32_16x16x32_bf16 v[44:47], v[224:227], a[60:63], v[44:47]
  v_add_u32 v250, 86016, v249
  s_waitcnt lgkmcnt(4)
  v_mfma_f32_16x16x32_bf16 v[48:51], v[228:231], a[48:51], v[48:51]
  ds_read_b64_tr_b16 v[224:225], v250 offset:0
  v_mfma_f32_16x16x32_bf16 v[52:55], v[228:231], a[52:55], v[52:55]
  ds_read_b64_tr_b16 v[226:227], v250 offset:1536
  v_mfma_f32_16x16x32_bf16 v[56:59], v[228:231], a[56:59], v[56:59]
  v_mfma_f32_16x16x32_bf16 v[60:63], v[228:231], a[60:63], v[60:63]
  s_waitcnt lgkmcnt(4)
  v_mfma_f32_16x16x32_bf16 v[64:67], v[232:235], a[48:51], v[64:67]
  ds_read_b64_tr_b16 v[228:229], v250 offset:6144
  v_mfma_f32_16x16x32_bf16 v[68:71], v[232:235], a[52:55], v[68:71]
  ds_read_b64_tr_b16 v[230:231], v250 offset:7680
  v_mfma_f32_16x16x32_bf16 v[72:75], v[232:235], a[56:59], v[72:75]
  v_mfma_f32_16x16x32_bf16 v[76:79], v[232:235], a[60:63], v[76:79]
  s_waitcnt lgkmcnt(4)
  v_mfma_f32_16x16x32_bf16 v[80:83], v[236:239], a[48:51], v[80:83]
  ds_read_b64_tr_b16 v[232:233], v250 offset:32
  v_mfma_f32_16x16x32_bf16 v[84:87], v[236:239], a[52:55], v[84:87]
  ds_read_b64_tr_b16 v[234:235], v250 offset:1568
  v_mfma_f32_16x16x32_bf16 v[88:91], v[236:239], a[56:59], v[88:91]
  v_mfma_f32_16x16x32_bf16 v[92:95], v[236:239], a[60:63], v[92:95]
  s_waitcnt lgkmcnt(4)
  v_mfma_f32_16x16x32_bf16 v[0:3], v[224:227], a[64:67], v[0:3]
  ds_read_b64_tr_b16 v[236:237], v250 offset:6176
  v_mfma_f32_16x16x32_bf16 v[4:7], v[224:227], a[68:71], v[4:7]
  ds_read_b64_tr_b16 v[238:239], v250 offset:7712
  v_mfma_f32_16x16x32_bf16 v[8:11], v[224:227], a[72:75], v[8:11]
  v_mfma_f32_16x16x32_bf16 v[12:15], v[224:227], a[76:79], v[12:15]
  s_waitcnt lgkmcnt(4)
  v_mfma_f32_16x16x32_bf16 v[16:19], v[228:231], a[64:67], v[16:19]
  ds_read_b64_tr_b16 v[224:225], v250 offset:64
  v_mfma_f32_16x16x32_bf16 v[20:23], v[228:231], a[68:71], v[20:23]
  ds_read_b64_tr_b16 v[226:227], v250 offset:1600
  v_mfma_f32_16x16x32_bf16 v[24:27], v[228:231], a[72:75], v[24:27]
  v_mfma_f32_16x16x32_bf16 v[28:31], v[228:231], a[76:79], v[28:31]
  s_waitcnt lgkmcnt(4)
  v_mfma_f32_16x16x32_bf16 v[32:35], v[232:235], a[64:67], v[32:35]
  ds_read_b64_tr_b16 v[228:229], v250 offset:6208
  v_mfma_f32_16x16x32_bf16 v[36:39], v[232:235], a[68:71], v[36:39]
  ds_read_b64_tr_b16 v[230:231], v250 offset:7744
  v_mfma_f32_16x16x32_bf16 v[40:43], v[232:235], a[72:75], v[40:43]
  v_mfma_f32_16x16x32_bf16 v[44:47], v[232:235], a[76:79], v[44:47]
  s_waitcnt lgkmcnt(4)
  v_mfma_f32_16x16x32_bf16 v[48:51], v[236:239], a[64:67], v[48:51]
  ds_read_b64_tr_b16 v[232:233], v250 offset:3072
  v_mfma_f32_16x16x32_bf16 v[52:55], v[236:239], a[68:71], v[52:55]
  ds_read_b64_tr_b16 v[234:235], v250 offset:4608
  v_mfma_f32_16x16x32_bf16 v[56:59], v[236:239], a[72:75], v[56:59]
  v_mfma_f32_16x16x32_bf16 v[60:63], v[236:239], a[76:79], v[60:63]
  s_waitcnt lgkmcnt(4)
  v_mfma_f32_16x16x32_bf16 v[64:67], v[224:227], a[64:67], v[64:67]
  ds_read_b64_tr_b16 v[236:237], v250 offset:9216
  v_mfma_f32_16x16x32_bf16 v[68:71], v[224:227], a[68:71], v[68:71]
  ds_read_b64_tr_b16 v[238:239], v250 offset:10752
  v_mfma_f32_16x16x32_bf16 v[72:75], v[224:227], a[72:75], v[72:75]
  v_mfma_f32_16x16x32_bf16 v[76:79], v[224:227], a[76:79], v[76:79]
  s_waitcnt lgkmcnt(4)
  v_mfma_f32_16x16x32_bf16 v[80:83], v[228:231], a[64:67], v[80:83]
  ds_read_b64_tr_b16 v[224:225], v250 offset:3104
  v_mfma_f32_16x16x32_bf16 v[84:87], v[228:231], a[68:71], v[84:87]
  ds_read_b64_tr_b16 v[226:227], v250 offset:4640
  v_mfma_f32_16x16x32_bf16 v[88:91], v[228:231], a[72:75], v[88:91]
  v_mfma_f32_16x16x32_bf16 v[92:95], v[228:231], a[76:79], v[92:95]
  s_waitcnt lgkmcnt(4)
  v_mfma_f32_16x16x32_bf16 v[0:3], v[232:235], a[80:83], v[0:3]
  ds_read_b64_tr_b16 v[228:229], v250 offset:9248
  v_mfma_f32_16x16x32_bf16 v[4:7], v[232:235], a[84:87], v[4:7]
  ds_read_b64_tr_b16 v[230:231], v250 offset:10784
  v_mfma_f32_16x16x32_bf16 v[8:11], v[232:235], a[88:91], v[8:11]
  v_mfma_f32_16x16x32_bf16 v[12:15], v[232:235], a[92:95], v[12:15]
  s_waitcnt lgkmcnt(4)
  v_mfma_f32_16x16x32_bf16 v[16:19], v[236:239], a[80:83], v[16:19]
  ds_read_b64_tr_b16 v[232:233], v250 offset:3136
  v_mfma_f32_16x16x32_bf16 v[20:23], v[236:239], a[84:87], v[20:23]
  ds_read_b64_tr_b16 v[234:235], v250 offset:4672
  v_mfma_f32_16x16x32_bf16 v[24:27], v[236:239], a[88:91], v[24:27]
  v_mfma_f32_16x16x32_bf16 v[28:31], v[236:239], a[92:95], v[28:31]
  s_waitcnt lgkmcnt(4)
  v_mfma_f32_16x16x32_bf16 v[32:35], v[224:227], a[80:83], v[32:35]
  ds_read_b64_tr_b16 v[236:237], v250 offset:9280
  v_mfma_f32_16x16x32_bf16 v[36:39], v[224:227], a[84:87], v[36:39]
  ds_read_b64_tr_b16 v[238:239], v250 offset:10816
  v_mfma_f32_16x16x32_bf16 v[40:43], v[224:227], a[88:91], v[40:43]
  v_mfma_f32_16x16x32_bf16 v[44:47], v[224:227], a[92:95], v[44:47]
  s_waitcnt vmcnt(21)
  s_barrier
  v_add_u32 v250, 98304, v249
  s_waitcnt lgkmcnt(4)
  v_mfma_f32_16x16x32_bf16 v[48:51], v[228:231], a[80:83], v[48:51]
  ds_read_b64_tr_b16 v[224:225], v250 offset:0
  v_mfma_f32_16x16x32_bf16 v[52:55], v[228:231], a[84:87], v[52:55]
  ds_read_b64_tr_b16 v[226:227], v250 offset:1536
  v_mfma_f32_16x16x32_bf16 v[56:59], v[228:231], a[88:91], v[56:59]
  v_mfma_f32_16x16x32_bf16 v[60:63], v[228:231], a[92:95], v[60:63]
  s_waitcnt lgkmcnt(4)
  v_mfma_f32_16x16x32_bf16 v[64:67], v[232:235], a[80:83], v[64:67]
  ds_read_b64_tr_b16 v[228:229], v250 offset:6144
  v_mfma_f32_16x16x32_bf16 v[68:71], v[232:235], a[84:87], v[68:71]
  ds_read_b64_tr_b16 v[230:231], v250 offset:7680
  v_mfma_f32_16x16x32_bf16 v[72:75], v[232:235], a[88:91], v[72:75]
  v_mfma_f32_16x16x32_bf16 v[76:79], v[232:235], a[92:95], v[76:79]
  s_waitcnt lgkmcnt(4)
  v_mfma_f32_16x16x32_bf16 v[80:83], v[236:239], a[80:83], v[80:83]
  ds_read_b64_tr_b16 v[232:233], v250 offset:32
  v_mfma_f32_16x16x32_bf16 v[84:87], v[236:239], a[84:87], v[84:87]
  ds_read_b64_tr_b16 v[234:235], v250 offset:1568
  v_mfma_f32_16x16x32_bf16 v[88:91], v[236:239], a[88:91], v[88:91]
  v_mfma_f32_16x16x32_bf16 v[92:95], v[236:239], a[92:95], v[92:95]
  s_waitcnt lgkmcnt(4)
  v_mfma_f32_16x16x32_bf16 v[0:3], v[224:227], a[96:99], v[0:3]
  ds_read_b64_tr_b16 v[236:237], v250 offset:6176
  v_mfma_f32_16x16x32_bf16 v[4:7], v[224:227], a[100:103], v[4:7]
  ds_read_b64_tr_b16 v[238:239], v250 offset:7712
  v_mfma_f32_16x16x32_bf16 v[8:11], v[224:227], a[104:107], v[8:11]
  v_mfma_f32_16x16x32_bf16 v[12:15], v[224:227], a[108:111], v[12:15]
  s_waitcnt lgkmcnt(4)
  v_mfma_f32_16x16x32_bf16 v[16:19], v[228:231], a[96:99], v[16:19]
  ds_read_b64_tr_b16 v[224:225], v250 offset:64
  v_mfma_f32_16x16x32_bf16 v[20:23], v[228:231], a[100:103], v[20:23]
  ds_read_b64_tr_b16 v[226:227], v250 offset:1600
  v_mfma_f32_16x16x32_bf16 v[24:27], v[228:231], a[104:107], v[24:27]
  v_mfma_f32_16x16x32_bf16 v[28:31], v[228:231], a[108:111], v[28:31]
  s_waitcnt lgkmcnt(4)
  v_mfma_f32_16x16x32_bf16 v[32:35], v[232:235], a[96:99], v[32:35]
  ds_read_b64_tr_b16 v[228:229], v250 offset:6208
  v_mfma_f32_16x16x32_bf16 v[36:39], v[232:235], a[100:103], v[36:39]
  ds_read_b64_tr_b16 v[230:231], v250 offset:7744
  v_mfma_f32_16x16x32_bf16 v[40:43], v[232:235], a[104:107], v[40:43]
  v_mfma_f32_16x16x32_bf16 v[44:47], v[232:235], a[108:111], v[44:47]
  s_waitcnt lgkmcnt(4)
  v_mfma_f32_16x16x32_bf16 v[48:51], v[236:239], a[96:99], v[48:51]
  ds_read_b64_tr_b16 v[232:233], v250 offset:3072
  v_mfma_f32_16x16x32_bf16 v[52:55], v[236:239], a[100:103], v[52:55]
  ds_read_b64_tr_b16 v[234:235], v250 offset:4608
  v_mfma_f32_16x16x32_bf16 v[56:59], v[236:239], a[104:107], v[56:59]
  v_mfma_f32_16x16x32_bf16 v[60:63], v[236:239], a[108:111], v[60:63]
  s_waitcnt lgkmcnt(4)
  v_mfma_f32_16x16x32_bf16 v[64:67], v[224:227], a[96:99], v[64:67]
  ds_read_b64_tr_b16 v[236:237], v250 offset:9216
  v_mfma_f32_16x16x32_bf16 v[68:71], v[224:227], a[100:103], v[68:71]
  ds_read_b64_tr_b16 v[238:239], v250 offset:10752
  v_mfma_f32_16x16x32_bf16 v[72:75], v[224:227], a[104:107], v[72:75]
  v_mfma_f32_16x16x32_bf16 v[76:79], v[224:227], a[108:111], v[76:79]
  s_waitcnt lgkmcnt(4)
  v_mfma_f32_16x16x32_bf16 v[80:83], v[228:231], a[96:99], v[80:83]
  ds_read_b64_tr_b16 v[224:225], v250 offset:3104
  v_mfma_f32_16x16x32_bf16 v[84:87], v[228:231], a[100:103], v[84:87]
  ds_read_b64_tr_b16 v[226:227], v250 offset:4640
  v_mfma_f32_16x16x32_bf16 v[88:91], v[228:231], a[104:107], v[88:91]
  v_mfma_f32_16x16x32_bf16 v[92:95], v[228:231], a[108:111], v[92:95]
  s_waitcnt lgkmcnt(4)
  v_mfma_f32_16x16x32_bf16 v[0:3], v[232:235], a[112:115], v[0:3]
  ds_read_b64_tr_b16 v[228:229], v250 offset:9248
  v_mfma_f32_16x16x32_bf16 v[4:7], v[232:235], a[116:119], v[4:7]
  ds_read_b64_tr_b16 v[230:231], v250 offset:10784
  v_mfma_f32_16x16x32_bf16 v[8:11], v[232:235], a[120:123], v[8:11]
  v_mfma_f32_16x16x32_bf16 v[12:15], v[232:235], a[124:127], v[12:15]
  s_waitcnt lgkmcnt(4)
  v_mfma_f32_16x16x32_bf16 v[16:19], v[236:239], a[112:115], v[16:19]
  ds_read_b64_tr_b16 v[232:233], v250 offset:3136
  v_mfma_f32_16x16x32_bf16 v[20:23], v[236:239], a[116:119], v[20:23]
  ds_read_b64_tr_b16 v[234:235], v250 offset:4672
  v_mfma_f32_16x16x32_bf16 v[24:27], v[236:239], a[120:123], v[24:27]
  v_mfma_f32_16x16x32_bf16 v[28:31], v[236:239], a[124:127], v[28:31]
  s_mov_b32 s24, s6
  s_mov_b32 s25, s7
  s_mov_b32 s26, 0x510000
  s_mov_b32 s27, 0x20000
  s_getpc_b64 s[84:85]
k4_up_kernel_here4:
  s_add_u32 s84, s84, k5_down_kernel-k4_up_kernel_here4
  s_addc_u32 s85, s85, 0
  s_cmp_lt_u32 s2, 16
  s_cselect_b32 s86, k6_fin_kernel_eoc-k5_down_kernel, 0
  s_mov_b32 s87, 0x20000
  s_lshl_b32 s7, s3, 13
  v_lshl_add_u32 v255, v240, 3, s7
  buffer_load_dword v255, v255, s[84:87], 0 offen
  s_lshr_b32 s6, s2, 3
  s_lshl_b32 s6, s6, 2
  s_add_u32 s6, s6, s3
  s_and_b32 s7, s2, 3
  s_lshl_b32 s7, s7, 7
  s_add_u32 s6, s6, s7
  s_mul_i32 s6, s6, 10368
  v_lshl_add_u32 v253, v240, 3, s6
  v_add_u32 v254, 8192, v253
  buffer_load_dword v253, v253, s[24:27], 0 offen
  s_mov_b64 exec, 0x1ffff
  buffer_load_dword v254, v254, s[24:27], 0 offen
  s_mov_b64 exec, -1
  s_waitcnt lgkmcnt(4)
  v_mfma_f32_16x16x32_bf16 v[32:35], v[224:227], a[112:115], v[32:35]
  ds_read_b64_tr_b16 v[236:237], v250 offset:9280
  v_mfma_f32_16x16x32_bf16 v[36:39], v[224:227], a[116:119], v[36:39]
  ds_read_b64_tr_b16 v[238:239], v250 offset:10816
  v_mfma_f32_16x16x32_bf16 v[40:43], v[224:227], a[120:123], v[40:43]
  v_mfma_f32_16x16x32_bf16 v[44:47], v[224:227], a[124:127], v[44:47]
  v_add_u32 v250, 110592, v249
  s_waitcnt lgkmcnt(4)
  v_mfma_f32_16x16x32_bf16 v[48:51], v[228:231], a[112:115], v[48:51]
  ds_read_b64_tr_b16 v[224:225], v250 offset:0
  v_mfma_f32_16x16x32_bf16 v[52:55], v[228:231], a[116:119], v[52:55]
  ds_read_b64_tr_b16 v[226:227], v250 offset:1536
  v_mfma_f32_16x16x32_bf16 v[56:59], v[228:231], a[120:123], v[56:59]
  v_mfma_f32_16x16x32_bf16 v[60:63], v[228:231], a[124:127], v[60:63]
  s_waitcnt lgkmcnt(4)
  v_mfma_f32_16x16x32_bf16 v[64:67], v[232:235], a[112:115], v[64:67]
  ds_read_b64_tr_b16 v[228:229], v250 offset:6144
  v_mfma_f32_16x16x32_bf16 v[68:71], v[232:235], a[116:119], v[68:71]
  ds_read_b64_tr_b16 v[230:231], v250 offset:7680
  v_mfma_f32_16x16x32_bf16 v[72:75], v[232:235], a[120:123], v[72:75]
  v_mfma_f32_16x16x32_bf16 v[76:79], v[232:235], a[124:127], v[76:79]
  s_waitcnt lgkmcnt(4)
  v_mfma_f32_16x16x32_bf16 v[80:83], v[236:239], a[112:115], v[80:83]
  ds_read_b64_tr_b16 v[232:233], v250 offset:32
  v_mfma_f32_16x16x32_bf16 v[84:87], v[236:239], a[116:119], v[84:87]
  ds_read_b64_tr_b16 v[234:235], v250 offset:1568
  v_mfma_f32_16x16x32_bf16 v[88:91], v[236:239], a[120:123], v[88:91]
  v_mfma_f32_16x16x32_bf16 v[92:95], v[236:239], a[124:127], v[92:95]
  s_waitcnt lgkmcnt(4)
  v_mfma_f32_16x16x32_bf16 v[0:3], v[224:227], a[128:131], v[0:3]
  ds_read_b64_tr_b16 v[236:237], v250 offset:6176
  v_mfma_f32_16x16x32_bf16 v[4:7], v[224:227], a[132:135], v[4:7]
  ds_read_b64_tr_b16 v[238:239], v250 offset:7712
  v_mfma_f32_16x16x32_bf16 v[8:11], v[224:227], a[136:139], v[8:11]
  v_mfma_f32_16x16x32_bf16 v[12:15], v[224:227], a[140:143], v[12:15]
  s_waitcnt lgkmcnt(4)
  v_mfma_f32_16x16x32_bf16 v[16:19], v[228:231], a[128:131], v[16:19]
  ds_read_b64_tr_b16 v[224:225], v250 offset:64
  v_mfma_f32_16x16x32_bf16 v[20:23], v[228:231], a[132:135], v[20:23]
  ds_read_b64_tr_b16 v[226:227], v250 offset:1600
  v_mfma_f32_16x16x32_bf16 v[24:27], v[228:231], a[136:139], v[24:27]
  v_mfma_f32_16x16x32_bf16 v[28:31], v[228:231], a[140:143], v[28:31]
  s_waitcnt lgkmcnt(4)
  v_mfma_f32_16x16x32_bf16 v[32:35], v[232:235], a[128:131], v[32:35]
  ds_read_b64_tr_b16 v[228:229], v250 offset:6208
  v_mfma_f32_16x16x32_bf16 v[36:39], v[232:235], a[132:135], v[36:39]
  ds_read_b64_tr_b16 v[230:231], v250 offset:7744
  v_mfma_f32_16x16x32_bf16 v[40:43], v[232:235], a[136:139], v[40:43]
  v_mfma_f32_16x16x32_bf16 v[44:47], v[232:235], a[140:143], v[44:47]
  s_waitcnt lgkmcnt(4)
  v_mfma_f32_16x16x32_bf16 v[48:51], v[236:239], a[128:131], v[48:51]
  ds_read_b64_tr_b16 v[232:233], v250 offset:3072
  v_mfma_f32_16x16x32_bf16 v[52:55], v[236:239], a[132:135], v[52:55]
  ds_read_b64_tr_b16 v[234:235], v250 offset:4608
  v_mfma_f32_16x16x32_bf16 v[56:59], v[236:239], a[136:139], v[56:59]
  v_mfma_f32_16x16x32_bf16 v[60:63], v[236:239], a[140:143], v[60:63]
  s_waitcnt lgkmcnt(4)
  v_mfma_f32_16x16x32_bf16 v[64:67], v[224:227], a[128:131], v[64:67]
  ds_read_b64_tr_b16 v[236:237], v250 offset:9216
  v_mfma_f32_16x16x32_bf16 v[68:71], v[224:227], a[132:135], v[68:71]
  ds_read_b64_tr_b16 v[238:239], v250 offset:10752
  v_mfma_f32_16x16x32_bf16 v[72:75], v[224:227], a[136:139], v[72:75]
  v_mfma_f32_16x16x32_bf16 v[76:79], v[224:227], a[140:143], v[76:79]
  s_waitcnt lgkmcnt(4)
  v_mfma_f32_16x16x32_bf16 v[80:83], v[228:231], a[128:131], v[80:83]
  ds_read_b64_tr_b16 v[224:225], v250 offset:3104
  v_mfma_f32_16x16x32_bf16 v[84:87], v[228:231], a[132:135], v[84:87]
  ds_read_b64_tr_b16 v[226:227], v250 offset:4640
  v_mfma_f32_16x16x32_bf16 v[88:91], v[228:231], a[136:139], v[88:91]
  v_mfma_f32_16x16x32_bf16 v[92:95], v[228:231], a[140:143], v[92:95]
  s_waitcnt lgkmcnt(4)
  v_mfma_f32_16x16x32_bf16 v[0:3], v[232:235], a[144:147], v[0:3]
  ds_read_b64_tr_b16 v[228:229], v250 offset:9248
  v_mfma_f32_16x16x32_bf16 v[4:7], v[232:235], a[148:151], v[4:7]
  ds_read_b64_tr_b16 v[230:231], v250 offset:10784
  v_mfma_f32_16x16x32_bf16 v[8:11], v[232:235], a[152:155], v[8:11]
  v_mfma_f32_16x16x32_bf16 v[12:15], v[232:235], a[156:159], v[12:15]
  s_waitcnt lgkmcnt(4)
  v_mfma_f32_16x16x32_bf16 v[16:19], v[236:239], a[144:147], v[16:19]
  ds_read_b64_tr_b16 v[232:233], v250 offset:3136
  v_mfma_f32_16x16x32_bf16 v[20:23], v[236:239], a[148:151], v[20:23]
  ds_read_b64_tr_b16 v[234:235], v250 offset:4672
  v_mfma_f32_16x16x32_bf16 v[24:27], v[236:239], a[152:155], v[24:27]
  v_mfma_f32_16x16x32_bf16 v[28:31], v[236:239], a[156:159], v[28:31]
  s_waitcnt lgkmcnt(4)
  v_mfma_f32_16x16x32_bf16 v[32:35], v[224:227], a[144:147], v[32:35]
  ds_read_b64_tr_b16 v[236:237], v250 offset:9280
  v_mfma_f32_16x16x32_bf16 v[36:39], v[224:227], a[148:151], v[36:39]
  ds_read_b64_tr_b16 v[238:239], v250 offset:10816
  v_mfma_f32_16x16x32_bf16 v[40:43], v[224:227], a[152:155], v[40:43]
  v_mfma_f32_16x16x32_bf16 v[44:47], v[224:227], a[156:159], v[44:47]
  v_add_u32 v250, 122880, v249
  s_waitcnt lgkmcnt(4)
  v_mfma_f32_16x16x32_bf16 v[48:51], v[228:231], a[144:147], v[48:51]
  ds_read_b64_tr_b16 v[224:225], v250 offset:0
  v_mfma_f32_16x16x32_bf16 v[52:55], v[228:231], a[148:151], v[52:55]
  ds_read_b64_tr_b16 v[226:227], v250 offset:1536
  v_mfma_f32_16x16x32_bf16 v[56:59], v[228:231], a[152:155], v[56:59]
  v_mfma_f32_16x16x32_bf16 v[60:63], v[228:231], a[156:159], v[60:63]
  s_waitcnt lgkmcnt(4)
  v_mfma_f32_16x16x32_bf16 v[64:67], v[232:235], a[144:147], v[64:67]
  ds_read_b64_tr_b16 v[228:229], v250 offset:6144
  v_mfma_f32_16x16x32_bf16 v[68:71], v[232:235], a[148:151], v[68:71]
  ds_read_b64_tr_b16 v[230:231], v250 offset:7680
  v_mfma_f32_16x16x32_bf16 v[72:75], v[232:235], a[152:155], v[72:75]
  v_mfma_f32_16x16x32_bf16 v[76:79], v[232:235], a[156:159], v[76:79]
  s_waitcnt lgkmcnt(4)
  v_mfma_f32_16x16x32_bf16 v[80:83], v[236:239], a[144:147], v[80:83]
  ds_read_b64_tr_b16 v[232:233], v250 offset:32
  v_mfma_f32_16x16x32_bf16 v[84:87], v[236:239], a[148:151], v[84:87]
  ds_read_b64_tr_b16 v[234:235], v250 offset:1568
  v_mfma_f32_16x16x32_bf16 v[88:91], v[236:239], a[152:155], v[88:91]
  v_mfma_f32_16x16x32_bf16 v[92:95], v[236:239], a[156:159], v[92:95]
  s_waitcnt lgkmcnt(4)
  v_mfma_f32_16x16x32_bf16 v[0:3], v[224:227], a[160:163], v[0:3]
  ds_read_b64_tr_b16 v[236:237], v250 offset:6176
  v_mfma_f32_16x16x32_bf16 v[4:7], v[224:227], a[164:167], v[4:7]
  ds_read_b64_tr_b16 v[238:239], v250 offset:7712
  v_mfma_f32_16x16x32_bf16 v[8:11], v[224:227], a[168:171], v[8:11]
  v_mfma_f32_16x16x32_bf16 v[12:15], v[224:227], a[172:175], v[12:15]
  s_waitcnt lgkmcnt(4)
  v_mfma_f32_16x16x32_bf16 v[16:19], v[228:231], a[160:163], v[16:19]
  ds_read_b64_tr_b16 v[224:225], v250 offset:64
  v_mfma_f32_16x16x32_bf16 v[20:23], v[228:231], a[164:167], v[20:23]
  ds_read_b64_tr_b16 v[226:227], v250 offset:1600
  v_mfma_f32_16x16x32_bf16 v[24:27], v[228:231], a[168:171], v[24:27]
  v_mfma_f32_16x16x32_bf16 v[28:31], v[228:231], a[172:175], v[28:31]
  s_waitcnt lgkmcnt(4)
  v_mfma_f32_16x16x32_bf16 v[32:35], v[232:235], a[160:163], v[32:35]
  ds_read_b64_tr_b16 v[228:229], v250 offset:6208
  v_mfma_f32_16x16x32_bf16 v[36:39], v[232:235], a[164:167], v[36:39]
  ds_read_b64_tr_b16 v[230:231], v250 offset:7744
  v_mfma_f32_16x16x32_bf16 v[40:43], v[232:235], a[168:171], v[40:43]
  v_mfma_f32_16x16x32_bf16 v[44:47], v[232:235], a[172:175], v[44:47]
  s_waitcnt lgkmcnt(4)
  v_mfma_f32_16x16x32_bf16 v[48:51], v[236:239], a[160:163], v[48:51]
  ds_read_b64_tr_b16 v[232:233], v250 offset:3072
  v_mfma_f32_16x16x32_bf16 v[52:55], v[236:239], a[164:167], v[52:55]
  ds_read_b64_tr_b16 v[234:235], v250 offset:4608
  v_mfma_f32_16x16x32_bf16 v[56:59], v[236:239], a[168:171], v[56:59]
  v_mfma_f32_16x16x32_bf16 v[60:63], v[236:239], a[172:175], v[60:63]
  s_waitcnt lgkmcnt(4)
  v_mfma_f32_16x16x32_bf16 v[64:67], v[224:227], a[160:163], v[64:67]
  ds_read_b64_tr_b16 v[236:237], v250 offset:9216
  v_mfma_f32_16x16x32_bf16 v[68:71], v[224:227], a[164:167], v[68:71]
  ds_read_b64_tr_b16 v[238:239], v250 offset:10752
  v_mfma_f32_16x16x32_bf16 v[72:75], v[224:227], a[168:171], v[72:75]
  v_mfma_f32_16x16x32_bf16 v[76:79], v[224:227], a[172:175], v[76:79]
  s_waitcnt lgkmcnt(4)
  v_mfma_f32_16x16x32_bf16 v[80:83], v[228:231], a[160:163], v[80:83]
  ds_read_b64_tr_b16 v[224:225], v250 offset:3104
  v_mfma_f32_16x16x32_bf16 v[84:87], v[228:231], a[164:167], v[84:87]
  ds_read_b64_tr_b16 v[226:227], v250 offset:4640
  v_mfma_f32_16x16x32_bf16 v[88:91], v[228:231], a[168:171], v[88:91]
  v_mfma_f32_16x16x32_bf16 v[92:95], v[228:231], a[172:175], v[92:95]
  s_waitcnt lgkmcnt(4)
  v_mfma_f32_16x16x32_bf16 v[0:3], v[232:235], a[176:179], v[0:3]
  ds_read_b64_tr_b16 v[228:229], v250 offset:9248
  v_mfma_f32_16x16x32_bf16 v[4:7], v[232:235], a[180:183], v[4:7]
  ds_read_b64_tr_b16 v[230:231], v250 offset:10784
  v_mfma_f32_16x16x32_bf16 v[8:11], v[232:235], a[184:187], v[8:11]
  v_mfma_f32_16x16x32_bf16 v[12:15], v[232:235], a[188:191], v[12:15]
  s_waitcnt lgkmcnt(4)
  v_mfma_f32_16x16x32_bf16 v[16:19], v[236:239], a[176:179], v[16:19]
  ds_read_b64_tr_b16 v[232:233], v250 offset:3136
  v_mfma_f32_16x16x32_bf16 v[20:23], v[236:239], a[180:183], v[20:23]
  ds_read_b64_tr_b16 v[234:235], v250 offset:4672
  v_mfma_f32_16x16x32_bf16 v[24:27], v[236:239], a[184:187], v[24:27]
  v_mfma_f32_16x16x32_bf16 v[28:31], v[236:239], a[188:191], v[28:31]
  s_waitcnt lgkmcnt(4)
  v_mfma_f32_16x16x32_bf16 v[32:35], v[224:227], a[176:179], v[32:35]
  ds_read_b64_tr_b16 v[236:237], v250 offset:9280
  v_mfma_f32_16x16x32_bf16 v[36:39], v[224:227], a[180:183], v[36:39]
  ds_read_b64_tr_b16 v[238:239], v250 offset:10816
  v_mfma_f32_16x16x32_bf16 v[40:43], v[224:227], a[184:187], v[40:43]
  v_mfma_f32_16x16x32_bf16 v[44:47], v[224:227], a[188:191], v[44:47]
  s_waitcnt vmcnt(15)
  s_barrier
  v_add_u32 v250, 135168, v249
  s_waitcnt lgkmcnt(4)
  v_mfma_f32_16x16x32_bf16 v[48:51], v[228:231], a[176:179], v[48:51]
  ds_read_b64_tr_b16 v[224:225], v250 offset:0
  v_mfma_f32_16x16x32_bf16 v[52:55], v[228:231], a[180:183], v[52:55]
  ds_read_b64_tr_b16 v[226:227], v250 offset:1536
  v_mfma_f32_16x16x32_bf16 v[56:59], v[228:231], a[184:187], v[56:59]
  v_mfma_f32_16x16x32_bf16 v[60:63], v[228:231], a[188:191], v[60:63]
  s_waitcnt lgkmcnt(4)
  v_mfma_f32_16x16x32_bf16 v[64:67], v[232:235], a[176:179], v[64:67]
  ds_read_b64_tr_b16 v[228:229], v250 offset:6144
  v_mfma_f32_16x16x32_bf16 v[68:71], v[232:235], a[180:183], v[68:71]
  ds_read_b64_tr_b16 v[230:231], v250 offset:7680
  v_mfma_f32_16x16x32_bf16 v[72:75], v[232:235], a[184:187], v[72:75]
  v_mfma_f32_16x16x32_bf16 v[76:79], v[232:235], a[188:191], v[76:79]
  s_waitcnt lgkmcnt(4)
  v_mfma_f32_16x16x32_bf16 v[80:83], v[236:239], a[176:179], v[80:83]
  ds_read_b64_tr_b16 v[232:233], v250 offset:32
  v_mfma_f32_16x16x32_bf16 v[84:87], v[236:239], a[180:183], v[84:87]
  ds_read_b64_tr_b16 v[234:235], v250 offset:1568
  v_mfma_f32_16x16x32_bf16 v[88:91], v[236:239], a[184:187], v[88:91]
  v_mfma_f32_16x16x32_bf16 v[92:95], v[236:239], a[188:191], v[92:95]
  s_waitcnt lgkmcnt(4)
  v_mfma_f32_16x16x32_bf16 v[0:3], v[224:227], a[192:195], v[0:3]
  ds_read_b64_tr_b16 v[236:237], v250 offset:6176
  v_mfma_f32_16x16x32_bf16 v[4:7], v[224:227], a[196:199], v[4:7]
  ds_read_b64_tr_b16 v[238:239], v250 offset:7712
  v_mfma_f32_16x16x32_bf16 v[8:11], v[224:227], a[200:203], v[8:11]
  v_mfma_f32_16x16x32_bf16 v[12:15], v[224:227], a[204:207], v[12:15]
  s_waitcnt lgkmcnt(4)
  v_mfma_f32_16x16x32_bf16 v[16:19], v[228:231], a[192:195], v[16:19]
  ds_read_b64_tr_b16 v[224:225], v250 offset:64
  v_mfma_f32_16x16x32_bf16 v[20:23], v[228:231], a[196:199], v[20:23]
  ds_read_b64_tr_b16 v[226:227], v250 offset:1600
  v_mfma_f32_16x16x32_bf16 v[24:27], v[228:231], a[200:203], v[24:27]
  v_mfma_f32_16x16x32_bf16 v[28:31], v[228:231], a[204:207], v[28:31]
  s_waitcnt lgkmcnt(4)
  v_mfma_f32_16x16x32_bf16 v[32:35], v[232:235], a[192:195], v[32:35]
  ds_read_b64_tr_b16 v[228:229], v250 offset:6208
  v_mfma_f32_16x16x32_bf16 v[36:39], v[232:235], a[196:199], v[36:39]
  ds_read_b64_tr_b16 v[230:231], v250 offset:7744
  v_mfma_f32_16x16x32_bf16 v[40:43], v[232:235], a[200:203], v[40:43]
  v_mfma_f32_16x16x32_bf16 v[44:47], v[232:235], a[204:207], v[44:47]
  s_waitcnt lgkmcnt(4)
  v_mfma_f32_16x16x32_bf16 v[48:51], v[236:239], a[192:195], v[48:51]
  ds_read_b64_tr_b16 v[232:233], v250 offset:3072
  v_mfma_f32_16x16x32_bf16 v[52:55], v[236:239], a[196:199], v[52:55]
  ds_read_b64_tr_b16 v[234:235], v250 offset:4608
  v_mfma_f32_16x16x32_bf16 v[56:59], v[236:239], a[200:203], v[56:59]
  v_mfma_f32_16x16x32_bf16 v[60:63], v[236:239], a[204:207], v[60:63]
  s_waitcnt lgkmcnt(4)
  v_mfma_f32_16x16x32_bf16 v[64:67], v[224:227], a[192:195], v[64:67]
  ds_read_b64_tr_b16 v[236:237], v250 offset:9216
  v_mfma_f32_16x16x32_bf16 v[68:71], v[224:227], a[196:199], v[68:71]
  ds_read_b64_tr_b16 v[238:239], v250 offset:10752
  v_mfma_f32_16x16x32_bf16 v[72:75], v[224:227], a[200:203], v[72:75]
  v_mfma_f32_16x16x32_bf16 v[76:79], v[224:227], a[204:207], v[76:79]
  s_waitcnt lgkmcnt(4)
  v_mfma_f32_16x16x32_bf16 v[80:83], v[228:231], a[192:195], v[80:83]
  ds_read_b64_tr_b16 v[224:225], v250 offset:3104
  v_mfma_f32_16x16x32_bf16 v[84:87], v[228:231], a[196:199], v[84:87]
  ds_read_b64_tr_b16 v[226:227], v250 offset:4640
  v_mfma_f32_16x16x32_bf16 v[88:91], v[228:231], a[200:203], v[88:91]
  v_mfma_f32_16x16x32_bf16 v[92:95], v[228:231], a[204:207], v[92:95]
  s_waitcnt lgkmcnt(4)
  v_mfma_f32_16x16x32_bf16 v[0:3], v[232:235], a[208:211], v[0:3]
  ds_read_b64_tr_b16 v[228:229], v250 offset:9248
  v_mfma_f32_16x16x32_bf16 v[4:7], v[232:235], a[212:215], v[4:7]
  ds_read_b64_tr_b16 v[230:231], v250 offset:10784
  v_mfma_f32_16x16x32_bf16 v[8:11], v[232:235], a[216:219], v[8:11]
  v_mfma_f32_16x16x32_bf16 v[12:15], v[232:235], a[220:223], v[12:15]
  s_waitcnt lgkmcnt(4)
  v_mfma_f32_16x16x32_bf16 v[16:19], v[236:239], a[208:211], v[16:19]
  ds_read_b64_tr_b16 v[232:233], v250 offset:3136
  v_mfma_f32_16x16x32_bf16 v[20:23], v[236:239], a[212:215], v[20:23]
  ds_read_b64_tr_b16 v[234:235], v250 offset:4672
  v_mfma_f32_16x16x32_bf16 v[24:27], v[236:239], a[216:219], v[24:27]
  v_mfma_f32_16x16x32_bf16 v[28:31], v[236:239], a[220:223], v[28:31]
  s_waitcnt lgkmcnt(4)
  v_mfma_f32_16x16x32_bf16 v[32:35], v[224:227], a[208:211], v[32:35]
  ds_read_b64_tr_b16 v[236:237], v250 offset:9280
  v_mfma_f32_16x16x32_bf16 v[36:39], v[224:227], a[212:215], v[36:39]
  ds_read_b64_tr_b16 v[238:239], v250 offset:10816
  v_mfma_f32_16x16x32_bf16 v[40:43], v[224:227], a[216:219], v[40:43]
  v_mfma_f32_16x16x32_bf16 v[44:47], v[224:227], a[220:223], v[44:47]
  v_add_u32 v250, 147456, v249
  s_waitcnt lgkmcnt(4)
  v_mfma_f32_16x16x32_bf16 v[48:51], v[228:231], a[208:211], v[48:51]
  ds_read_b64_tr_b16 v[224:225], v250 offset:0
  v_mfma_f32_16x16x32_bf16 v[52:55], v[228:231], a[212:215], v[52:55]
  ds_read_b64_tr_b16 v[226:227], v250 offset:1536
  v_mfma_f32_16x16x32_bf16 v[56:59], v[228:231], a[216:219], v[56:59]
  v_mfma_f32_16x16x32_bf16 v[60:63], v[228:231], a[220:223], v[60:63]
  s_waitcnt lgkmcnt(4)
  v_mfma_f32_16x16x32_bf16 v[64:67], v[232:235], a[208:211], v[64:67]
  ds_read_b64_tr_b16 v[228:229], v250 offset:6144
  v_mfma_f32_16x16x32_bf16 v[68:71], v[232:235], a[212:215], v[68:71]
  ds_read_b64_tr_b16 v[230:231], v250 offset:7680
  v_mfma_f32_16x16x32_bf16 v[72:75], v[232:235], a[216:219], v[72:75]
  v_mfma_f32_16x16x32_bf16 v[76:79], v[232:235], a[220:223], v[76:79]
  s_waitcnt lgkmcnt(4)
  v_mfma_f32_16x16x32_bf16 v[80:83], v[236:239], a[208:211], v[80:83]
  ds_read_b64_tr_b16 v[232:233], v250 offset:32
  v_mfma_f32_16x16x32_bf16 v[84:87], v[236:239], a[212:215], v[84:87]
  ds_read_b64_tr_b16 v[234:235], v250 offset:1568
  v_mfma_f32_16x16x32_bf16 v[88:91], v[236:239], a[216:219], v[88:91]
  v_mfma_f32_16x16x32_bf16 v[92:95], v[236:239], a[220:223], v[92:95]
  s_waitcnt lgkmcnt(4)
  v_mfma_f32_16x16x32_bf16 v[0:3], v[224:227], a[224:227], v[0:3]
  ds_read_b64_tr_b16 v[236:237], v250 offset:6176
  v_mfma_f32_16x16x32_bf16 v[4:7], v[224:227], a[228:231], v[4:7]
  ds_read_b64_tr_b16 v[238:239], v250 offset:7712
  v_mfma_f32_16x16x32_bf16 v[8:11], v[224:227], a[232:235], v[8:11]
  v_mfma_f32_16x16x32_bf16 v[12:15], v[224:227], a[236:239], v[12:15]
  s_waitcnt lgkmcnt(4)
  v_mfma_f32_16x16x32_bf16 v[16:19], v[228:231], a[224:227], v[16:19]
  ds_read_b64_tr_b16 v[224:225], v250 offset:64
  v_mfma_f32_16x16x32_bf16 v[20:23], v[228:231], a[228:231], v[20:23]
  ds_read_b64_tr_b16 v[226:227], v250 offset:1600
  v_mfma_f32_16x16x32_bf16 v[24:27], v[228:231], a[232:235], v[24:27]
  v_mfma_f32_16x16x32_bf16 v[28:31], v[228:231], a[236:239], v[28:31]
  s_waitcnt lgkmcnt(4)
  v_mfma_f32_16x16x32_bf16 v[32:35], v[232:235], a[224:227], v[32:35]
  ds_read_b64_tr_b16 v[228:229], v250 offset:6208
  v_mfma_f32_16x16x32_bf16 v[36:39], v[232:235], a[228:231], v[36:39]
  ds_read_b64_tr_b16 v[230:231], v250 offset:7744
  v_mfma_f32_16x16x32_bf16 v[40:43], v[232:235], a[232:235], v[40:43]
  v_mfma_f32_16x16x32_bf16 v[44:47], v[232:235], a[236:239], v[44:47]
  s_waitcnt lgkmcnt(4)
  v_mfma_f32_16x16x32_bf16 v[48:51], v[236:239], a[224:227], v[48:51]
  ds_read_b64_tr_b16 v[232:233], v250 offset:3072
  v_mfma_f32_16x16x32_bf16 v[52:55], v[236:239], a[228:231], v[52:55]
  ds_read_b64_tr_b16 v[234:235], v250 offset:4608
  v_mfma_f32_16x16x32_bf16 v[56:59], v[236:239], a[232:235], v[56:59]
  v_mfma_f32_16x16x32_bf16 v[60:63], v[236:239], a[236:239], v[60:63]
  s_waitcnt lgkmcnt(4)
  v_mfma_f32_16x16x32_bf16 v[64:67], v[224:227], a[224:227], v[64:67]
  ds_read_b64_tr_b16 v[236:237], v250 offset:9216
  v_mfma_f32_16x16x32_bf16 v[68:71], v[224:227], a[228:231], v[68:71]
  ds_read_b64_tr_b16 v[238:239], v250 offset:10752
  v_mfma_f32_16x16x32_bf16 v[72:75], v[224:227], a[232:235], v[72:75]
  v_mfma_f32_16x16x32_bf16 v[76:79], v[224:227], a[236:239], v[76:79]
  s_waitcnt lgkmcnt(4)
  v_mfma_f32_16x16x32_bf16 v[80:83], v[228:231], a[224:227], v[80:83]
  ds_read_b64_tr_b16 v[224:225], v250 offset:3104
  v_mfma_f32_16x16x32_bf16 v[84:87], v[228:231], a[228:231], v[84:87]
  ds_read_b64_tr_b16 v[226:227], v250 offset:4640
  v_mfma_f32_16x16x32_bf16 v[88:91], v[228:231], a[232:235], v[88:91]
  v_mfma_f32_16x16x32_bf16 v[92:95], v[228:231], a[236:239], v[92:95]
  s_waitcnt lgkmcnt(4)
  v_mfma_f32_16x16x32_bf16 v[0:3], v[232:235], a[240:243], v[0:3]
  ds_read_b64_tr_b16 v[228:229], v250 offset:9248
  v_mfma_f32_16x16x32_bf16 v[4:7], v[232:235], a[244:247], v[4:7]
  ds_read_b64_tr_b16 v[230:231], v250 offset:10784
  v_mfma_f32_16x16x32_bf16 v[8:11], v[232:235], a[248:251], v[8:11]
  v_mfma_f32_16x16x32_bf16 v[12:15], v[232:235], a[252:255], v[12:15]
  s_waitcnt lgkmcnt(4)
  v_mfma_f32_16x16x32_bf16 v[16:19], v[236:239], a[240:243], v[16:19]
  ds_read_b64_tr_b16 v[232:233], v250 offset:3136
  v_mfma_f32_16x16x32_bf16 v[20:23], v[236:239], a[244:247], v[20:23]
  ds_read_b64_tr_b16 v[234:235], v250 offset:4672
  v_mfma_f32_16x16x32_bf16 v[24:27], v[236:239], a[248:251], v[24:27]
  v_mfma_f32_16x16x32_bf16 v[28:31], v[236:239], a[252:255], v[28:31]
  s_waitcnt lgkmcnt(4)
  v_mfma_f32_16x16x32_bf16 v[32:35], v[224:227], a[240:243], v[32:35]
  ds_read_b64_tr_b16 v[236:237], v250 offset:9280
  v_mfma_f32_16x16x32_bf16 v[36:39], v[224:227], a[244:247], v[36:39]
  ds_read_b64_tr_b16 v[238:239], v250 offset:10816
  v_mfma_f32_16x16x32_bf16 v[40:43], v[224:227], a[248:251], v[40:43]
  v_mfma_f32_16x16x32_bf16 v[44:47], v[224:227], a[252:255], v[44:47]
  v_add_u32 v250, 0, v249
  s_waitcnt lgkmcnt(4)
  v_mfma_f32_16x16x32_bf16 v[48:51], v[228:231], a[240:243], v[48:51]
  ds_read_b64_tr_b16 v[224:225], v250 offset:0
  v_mfma_f32_16x16x32_bf16 v[52:55], v[228:231], a[244:247], v[52:55]
  ds_read_b64_tr_b16 v[226:227], v250 offset:1536
  v_mfma_f32_16x16x32_bf16 v[56:59], v[228:231], a[248:251], v[56:59]
  v_mfma_f32_16x16x32_bf16 v[60:63], v[228:231], a[252:255], v[60:63]
  s_waitcnt lgkmcnt(4)
  v_mfma_f32_16x16x32_bf16 v[64:67], v[232:235], a[240:243], v[64:67]
  ds_read_b64_tr_b16 v[228:229], v250 offset:6144
  v_mfma_f32_16x16x32_bf16 v[68:71], v[232:235], a[244:247], v[68:71]
  ds_read_b64_tr_b16 v[230:231], v250 offset:7680
  v_mfma_f32_16x16x32_bf16 v[72:75], v[232:235], a[248:251], v[72:75]
  v_mfma_f32_16x16x32_bf16 v[76:79], v[232:235], a[252:255], v[76:79]
  s_waitcnt lgkmcnt(4)
  v_mfma_f32_16x16x32_bf16 v[80:83], v[236:239], a[240:243], v[80:83]
  ds_read_b64_tr_b16 v[232:233], v250 offset:32
  v_mfma_f32_16x16x32_bf16 v[84:87], v[236:239], a[244:247], v[84:87]
  ds_read_b64_tr_b16 v[234:235], v250 offset:1568
  v_mfma_f32_16x16x32_bf16 v[88:91], v[236:239], a[248:251], v[88:91]
  v_mfma_f32_16x16x32_bf16 v[92:95], v[236:239], a[252:255], v[92:95]
  s_waitcnt lgkmcnt(4)
  v_mfma_f32_16x16x32_bf16 v[0:3], v[224:227], v[192:195], v[0:3]
  ds_read_b64_tr_b16 v[236:237], v250 offset:6176
  v_mfma_f32_16x16x32_bf16 v[4:7], v[224:227], v[196:199], v[4:7]
  ds_read_b64_tr_b16 v[238:239], v250 offset:7712
  v_mfma_f32_16x16x32_bf16 v[8:11], v[224:227], v[200:203], v[8:11]
  v_mfma_f32_16x16x32_bf16 v[12:15], v[224:227], v[204:207], v[12:15]
  s_waitcnt lgkmcnt(4)
  v_mfma_f32_16x16x32_bf16 v[16:19], v[228:231], v[192:195], v[16:19]
  ds_read_b64_tr_b16 v[224:225], v250 offset:64
  v_mfma_f32_16x16x32_bf16 v[20:23], v[228:231], v[196:199], v[20:23]
  ds_read_b64_tr_b16 v[226:227], v250 offset:1600
  v_mfma_f32_16x16x32_bf16 v[24:27], v[228:231], v[200:203], v[24:27]
  v_mfma_f32_16x16x32_bf16 v[28:31], v[228:231], v[204:207], v[28:31]
  s_waitcnt lgkmcnt(4)
  v_mfma_f32_16x16x32_bf16 v[32:35], v[232:235], v[192:195], v[32:35]
  ds_read_b64_tr_b16 v[228:229], v250 offset:6208
  v_mfma_f32_16x16x32_bf16 v[36:39], v[232:235], v[196:199], v[36:39]
  ds_read_b64_tr_b16 v[230:231], v250 offset:7744
  v_mfma_f32_16x16x32_bf16 v[40:43], v[232:235], v[200:203], v[40:43]
  v_mfma_f32_16x16x32_bf16 v[44:47], v[232:235], v[204:207], v[44:47]
  s_waitcnt lgkmcnt(4)
  v_mfma_f32_16x16x32_bf16 v[48:51], v[236:239], v[192:195], v[48:51]
  ds_read_b64_tr_b16 v[232:233], v250 offset:3072
  v_mfma_f32_16x16x32_bf16 v[52:55], v[236:239], v[196:199], v[52:55]
  ds_read_b64_tr_b16 v[234:235], v250 offset:4608
  v_mfma_f32_16x16x32_bf16 v[56:59], v[236:239], v[200:203], v[56:59]
  v_mfma_f32_16x16x32_bf16 v[60:63], v[236:239], v[204:207], v[60:63]
  s_waitcnt lgkmcnt(4)
  v_mfma_f32_16x16x32_bf16 v[64:67], v[224:227], v[192:195], v[64:67]
  ds_read_b64_tr_b16 v[236:237], v250 offset:9216
  v_mfma_f32_16x16x32_bf16 v[68:71], v[224:227], v[196:199], v[68:71]
  ds_read_b64_tr_b16 v[238:239], v250 offset:10752
  v_mfma_f32_16x16x32_bf16 v[72:75], v[224:227], v[200:203], v[72:75]
  v_mfma_f32_16x16x32_bf16 v[76:79], v[224:227], v[204:207], v[76:79]
  s_waitcnt lgkmcnt(4)
  v_mfma_f32_16x16x32_bf16 v[80:83], v[228:231], v[192:195], v[80:83]
  ds_read_b64_tr_b16 v[224:225], v250 offset:3104
  v_mfma_f32_16x16x32_bf16 v[84:87], v[228:231], v[196:199], v[84:87]
  ds_read_b64_tr_b16 v[226:227], v250 offset:4640
  v_mfma_f32_16x16x32_bf16 v[88:91], v[228:231], v[200:203], v[88:91]
  v_mfma_f32_16x16x32_bf16 v[92:95], v[228:231], v[204:207], v[92:95]
  s_waitcnt lgkmcnt(4)
  v_mfma_f32_16x16x32_bf16 v[0:3], v[232:235], v[208:211], v[0:3]
  ds_read_b64_tr_b16 v[228:229], v250 offset:9248
  v_mfma_f32_16x16x32_bf16 v[4:7], v[232:235], v[212:215], v[4:7]
  ds_read_b64_tr_b16 v[230:231], v250 offset:10784
  v_mfma_f32_16x16x32_bf16 v[8:11], v[232:235], v[216:219], v[8:11]
  v_mfma_f32_16x16x32_bf16 v[12:15], v[232:235], v[220:223], v[12:15]
  s_waitcnt lgkmcnt(4)
  v_mfma_f32_16x16x32_bf16 v[16:19], v[236:239], v[208:211], v[16:19]
  ds_read_b64_tr_b16 v[232:233], v250 offset:3136
  v_mfma_f32_16x16x32_bf16 v[20:23], v[236:239], v[212:215], v[20:23]
  ds_read_b64_tr_b16 v[234:235], v250 offset:4672
  v_mfma_f32_16x16x32_bf16 v[24:27], v[236:239], v[216:219], v[24:27]
  v_mfma_f32_16x16x32_bf16 v[28:31], v[236:239], v[220:223], v[28:31]
  s_waitcnt lgkmcnt(4)
  v_mfma_f32_16x16x32_bf16 v[32:35], v[224:227], v[208:211], v[32:35]
  ds_read_b64_tr_b16 v[236:237], v250 offset:9280
  v_mfma_f32_16x16x32_bf16 v[36:39], v[224:227], v[212:215], v[36:39]
  ds_read_b64_tr_b16 v[238:239], v250 offset:10816
  v_mfma_f32_16x16x32_bf16 v[40:43], v[224:227], v[216:219], v[40:43]
  v_mfma_f32_16x16x32_bf16 v[44:47], v[224:227], v[220:223], v[44:47]
  s_waitcnt lgkmcnt(4)
  v_mfma_f32_16x16x32_bf16 v[48:51], v[228:231], v[208:211], v[48:51]
  v_mfma_f32_16x16x32_bf16 v[52:55], v[228:231], v[212:215], v[52:55]
  v_mfma_f32_16x16x32_bf16 v[56:59], v[228:231], v[216:219], v[56:59]
  v_mfma_f32_16x16x32_bf16 v[60:63], v[228:231], v[220:223], v[60:63]
  s_waitcnt lgkmcnt(2)
  v_mfma_f32_16x16x32_bf16 v[64:67], v[232:235], v[208:211], v[64:67]
  v_mfma_f32_16x16x32_bf16 v[68:71], v[232:235], v[212:215], v[68:71]
  v_mfma_f32_16x16x32_bf16 v[72:75], v[232:235], v[216:219], v[72:75]
  v_mfma_f32_16x16x32_bf16 v[76:79], v[232:235], v[220:223], v[76:79]
  s_waitcnt lgkmcnt(0)
  v_mfma_f32_16x16x32_bf16 v[80:83], v[236:239], v[208:211], v[80:83]
  v_mfma_f32_16x16x32_bf16 v[84:87], v[236:239], v[212:215], v[84:87]
  v_mfma_f32_16x16x32_bf16 v[88:91], v[236:239], v[216:219], v[88:91]
  v_mfma_f32_16x16x32_bf16 v[92:95], v[236:239], v[220:223], v[92:95]
  v_mul_f32 v0, v0, v16
  v_mul_f32 v1, v1, v17
  v_mul_f32 v2, v2, v18
  v_mul_f32 v3, v3, v19
  v_mul_f32 v32, v32, v48
  v_mul_f32 v33, v33, v49
  v_mul_f32 v34, v34, v50
  v_mul_f32 v35, v35, v51
  v_cvt_pk_bf16_f32 v16, v0, v1
  v_cvt_pk_bf16_f32 v17, v2, v3
  v_cvt_pk_bf16_f32 v18, v32, v33
  v_cvt_pk_bf16_f32 v19, v34, v35
  s_add_u32 s44, s40, 0
  buffer_store_dwordx4 v[16:19], v240, s[20:23], s44 offen sc0 sc1
  v_mul_f32 v4, v4, v20
  v_mul_f32 v5, v5, v21
  v_mul_f32 v6, v6, v22
  v_mul_f32 v7, v7, v23
  v_mul_f32 v36, v36, v52
  v_mul_f32 v37, v37, v53
  v_mul_f32 v38, v38, v54
  v_mul_f32 v39, v39, v55
  v_cvt_pk_bf16_f32 v20, v4, v5
  v_cvt_pk_bf16_f32 v21, v6, v7
  v_cvt_pk_bf16_f32 v22, v36, v37
  v_cvt_pk_bf16_f32 v23, v38, v39
  s_add_u32 s44, s40, 147456
  buffer_store_dwordx4 v[20:23], v240, s[20:23], s44 offen sc0 sc1
  v_mul_f32 v8, v8, v24
  v_mul_f32 v9, v9, v25
  v_mul_f32 v10, v10, v26
  v_mul_f32 v11, v11, v27
  v_mul_f32 v40, v40, v56
  v_mul_f32 v41, v41, v57
  v_mul_f32 v42, v42, v58
  v_mul_f32 v43, v43, v59
  v_cvt_pk_bf16_f32 v24, v8, v9
  v_cvt_pk_bf16_f32 v25, v10, v11
  v_cvt_pk_bf16_f32 v26, v40, v41
  v_cvt_pk_bf16_f32 v27, v42, v43
  s_add_u32 s44, s40, 294912
  buffer_store_dwordx4 v[24:27], v240, s[20:23], s44 offen sc0 sc1
  v_mul_f32 v12, v12, v28
  v_mul_f32 v13, v13, v29
  v_mul_f32 v14, v14, v30
  v_mul_f32 v15, v15, v31
  v_mul_f32 v44, v44, v60
  v_mul_f32 v45, v45, v61
  v_mul_f32 v46, v46, v62
  v_mul_f32 v47, v47, v63
  v_cvt_pk_bf16_f32 v28, v12, v13
  v_cvt_pk_bf16_f32 v29, v14, v15
  v_cvt_pk_bf16_f32 v30, v44, v45
  v_cvt_pk_bf16_f32 v31, v46, v47
  s_add_u32 s44, s40, 442368
  buffer_store_dwordx4 v[28:31], v240, s[20:23], s44 offen sc0 sc1
  v_mul_f32 v64, v64, v80
  v_mul_f32 v65, v65, v81
  v_mul_f32 v66, v66, v82
  v_mul_f32 v67, v67, v83
  v_cvt_pk_bf16_f32 v80, v64, v65
  v_cvt_pk_bf16_f32 v81, v66, v67
  s_add_u32 s33, s36, 0
  buffer_store_dwordx2 v[80:81], v252, s[20:23], s33 offen sc0 sc1
  v_mul_f32 v68, v68, v84
  v_mul_f32 v69, v69, v85
  v_mul_f32 v70, v70, v86
  v_mul_f32 v71, v71, v87
  v_cvt_pk_bf16_f32 v84, v68, v69
  v_cvt_pk_bf16_f32 v85, v70, v71
  s_add_u32 s33, s36, 147456
  buffer_store_dwordx2 v[84:85], v252, s[20:23], s33 offen sc0 sc1
  v_mul_f32 v72, v72, v88
  v_mul_f32 v73, v73, v89
  v_mul_f32 v74, v74, v90
  v_mul_f32 v75, v75, v91
  v_cvt_pk_bf16_f32 v88, v72, v73
  v_cvt_pk_bf16_f32 v89, v74, v75
  s_add_u32 s33, s36, 294912
  buffer_store_dwordx2 v[88:89], v252, s[20:23], s33 offen sc0 sc1
  v_mul_f32 v76, v76, v92
  v_mul_f32 v77, v77, v93
  v_mul_f32 v78, v78, v94
  v_mul_f32 v79, v79, v95
  v_cvt_pk_bf16_f32 v92, v76, v77
  v_cvt_pk_bf16_f32 v93, v78, v79
  s_add_u32 s33, s36, 442368
  buffer_store_dwordx2 v[92:93], v252, s[20:23], s33 offen sc0 sc1
k4_up_kernel_end1:
  s_endpgm
k4_up_kernel_eoc:
.globl k5_down_kernel
.p2align 8
.type k5_down_kernel,@function
k5_down_kernel:
  s_load_dwordx2 s[4:5], s[0:1], 88
  s_load_dwordx2 s[6:7], s[0:1], 48
  s_cmp_ge_u32 s2, 16
  s_cbranch_scc1 k5_down_kernel_cpf3
  s_getpc_b64 s[84:85]
k5_down_kernel_here4:
  s_add_u32 s84, s84, k5_down_kernel-k5_down_kernel_here4
  s_addc_u32 s85, s85, -1
  s_mov_b32 s86, k5_down_kernel_eoc-k5_down_kernel
  s_mov_b32 s87, 0x20000
  v_lshlrev_b32 v127, 6, v0
  buffer_load_dword v128, v127, s[84:87], 0 offen
k5_down_kernel_cpf3:
  v_lshrrev_b32 v1, 6, v0
  s_nop 0
  v_readfirstlane_b32 s3, v1
  s_cmp_ge_u32 s2, 256
  s_cbranch_scc1 k5_down_kernel_end1
  s_and_b32 s31, s3, 3
  s_and_b32 s28, s2, 3
  s_bfe_u32 s29, s2, 0x10002
  s_lshl_b32 s29, s29, 3
  s_bfe_u32 s33, s2, 0x30003
  s_add_u32 s29, s29, s33
  s_lshr_b32 s41, s2, 6
  s_lshl_b32 s34, s29, 2
  s_add_u32 s34, s34, s31
  v_and_b32 v1, 63, v0
  v_lshlrev_b32 v120, 4, v1
  s_cmp_ge_u32 s3, 4
  s_cbranch_scc0 k5_down_kernel_ld2
  v_bfe_u32 v4, v0, 2, 4
  v_mul_u32_u24 v4, 288, v4
  v_and_b32 v5, 3, v0
  v_lshl_add_u32 v121, v5, 3, v4
  v_add_u32 v122, 36864, v121
  s_lshl_b32 s39, s31, 11
  s_add_u32 s39, s39, 73728
  v_add_u32 v123, s39, v120
  v_lshl_add_u32 v125, v1, 3, s39
  s_mul_i32 s38, s28, 2304
  s_mul_i32 s39, s34, 36
  s_add_u32 s38, s38, s39
  s_mul_i32 s39, s41, 9
  s_add_u32 s38, s38, s39
  s_lshl_b32 s38, s38, 10
  s_waitcnt lgkmcnt(0)
  s_add_u32 s20, s4, 0x2400000
  s_addc_u32 s21, s5, 0
  s_mov_b32 s22, 0x900000
  s_mov_b32 s23, 0x20000
  s_setprio 1
  s_barrier
  ds_read_b128 v[72:75], v123 offset:0
  ds_read_b128 v[76:79], v123 offset:1024
  ds_read_b64_tr_b16 v[96:97], v121 offset:0
  ds_read_b64_tr_b16 v[98:99], v121 offset:4608
  ds_read_b64_tr_b16 v[100:101], v121 offset:32
  ds_read_b64_tr_b16 v[102:103], v121 offset:4640
  ds_read_b64_tr_b16 v[104:105], v121 offset:64
  ds_read_b64_tr_b16 v[106:107], v121 offset:4672
  ds_read_b64_tr_b16 v[108:109], v121 offset:96
  ds_read_b64_tr_b16 v[110:111], v121 offset:4704
  s_waitcnt lgkmcnt(6)
  v_mfma_f32_16x16x32_bf16 v[0:3], v[96:99], v[72:75], 0
  ds_read_b64_tr_b16 v[112:113], v121 offset:128
  v_mfma_f32_16x16x32_bf16 v[4:7], v[96:99], v[76:79], 0
  ds_read_b64_tr_b16 v[114:115], v121 offset:4736
  s_waitcnt lgkmcnt(6)
  v_mfma_f32_16x16x32_bf16 v[8:11], v[100:103], v[72:75], 0
  ds_read_b64_tr_b16 v[116:117], v121 offset:160
  v_mfma_f32_16x16x32_bf16 v[12:15], v[100:103], v[76:79], 0
  ds_read_b64_tr_b16 v[118:119], v121 offset:4768
  s_waitcnt lgkmcnt(6)
  v_mfma_f32_16x16x32_bf16 v[16:19], v[104:107], v[72:75], 0
  ds_read_b64_tr_b16 v[96:97], v121 offset:192
  v_mfma_f32_16x16x32_bf16 v[20:23], v[104:107], v[76:79], 0
  ds_read_b64_tr_b16 v[98:99], v121 offset:4800
  s_waitcnt lgkmcnt(6)
  v_mfma_f32_16x16x32_bf16 v[24:27], v[108:111], v[72:75], 0
  ds_read_b64_tr_b16 v[100:101], v121 offset:224
  v_mfma_f32_16x16x32_bf16 v[28:31], v[108:111], v[76:79], 0
  ds_read_b64_tr_b16 v[102:103], v121 offset:4832
  s_waitcnt lgkmcnt(6)
  v_mfma_f32_16x16x32_bf16 v[32:35], v[112:115], v[72:75], 0
  ds_read_b64_tr_b16 v[104:105], v121 offset:256
  v_mfma_f32_16x16x32_bf16 v[36:39], v[112:115], v[76:79], 0
  ds_read_b64_tr_b16 v[106:107], v121 offset:4864
  s_barrier
  ds_read_b128 v[80:83], v123 offset:8192
  ds_read_b128 v[84:87], v123 offset:9216
  s_waitcnt lgkmcnt(8)
  v_mfma_f32_16x16x32_bf16 v[40:43], v[116:119], v[72:75], 0
  ds_read_b64_tr_b16 v[108:109], v121 offset:9216
  v_mfma_f32_16x16x32_bf16 v[44:47], v[116:119], v[76:79], 0
  ds_read_b64_tr_b16 v[110:111], v121 offset:13824
  s_waitcnt lgkmcnt(8)
  v_mfma_f32_16x16x32_bf16 v[48:51], v[96:99], v[72:75], 0
  ds_read_b64_tr_b16 v[112:113], v121 offset:9248
  v_mfma_f32_16x16x32_bf16 v[52:55], v[96:99], v[76:79], 0
  ds_read_b64_tr_b16 v[114:115], v121 offset:13856
  s_waitcnt lgkmcnt(8)
  v_mfma_f32_16x16x32_bf16 v[56:59], v[100:103], v[72:75], 0
  ds_read_b64_tr_b16 v[116:117], v121 offset:9280
  v_mfma_f32_16x16x32_bf16 v[60:63], v[100:103], v[76:79], 0
  ds_read_b64_tr_b16 v[118:119], v121 offset:13888
  s_waitcnt lgkmcnt(8)
  v_mfma_f32_16x16x32_bf16 v[64:67], v[104:107], v[72:75], 0
  ds_read_b64_tr_b16 v[96:97], v121 offset:9312
  v_mfma_f32_16x16x32_bf16 v[68:71], v[104:107], v[76:79], 0
  ds_read_b64_tr_b16 v[98:99], v121 offset:13920
  s_waitcnt lgkmcnt(6)
  v_mfma_f32_16x16x32_bf16 v[0:3], v[108:111], v[80:83], v[0:3]
  ds_read_b64_tr_b16 v[100:101], v121 offset:9344
  v_mfma_f32_16x16x32_bf16 v[4:7], v[108:111], v[84:87], v[4:7]
  ds_read_b64_tr_b16 v[102:103], v121 offset:13952
  s_waitcnt lgkmcnt(6)
  v_mfma_f32_16x16x32_bf16 v[8:11], v[112:115], v[80:83], v[8:11]
  ds_read_b64_tr_b16 v[104:105], v121 offset:9376
  v_mfma_f32_16x16x32_bf16 v[12:15], v[112:115], v[84:87], v[12:15]
  ds_read_b64_tr_b16 v[106:107], v121 offset:13984
  s_waitcnt lgkmcnt(6)
  v_mfma_f32_16x16x32_bf16 v[16:19], v[116:119], v[80:83], v[16:19]
  ds_read_b64_tr_b16 v[108:109], v121 offset:9408
  v_mfma_f32_16x16x32_bf16 v[20:23], v[116:119], v[84:87], v[20:23]
  ds_read_b64_tr_b16 v[110:111], v121 offset:14016
  s_waitcnt lgkmcnt(6)
  v_mfma_f32_16x16x32_bf16 v[24:27], v[96:99], v[80:83], v[24:27]
  ds_read_b64_tr_b16 v[112:113], v121 offset:9440
  v_mfma_f32_16x16x32_bf16 v[28:31], v[96:99], v[84:87], v[28:31]
  ds_read_b64_tr_b16 v[114:115], v121 offset:14048
  s_waitcnt lgkmcnt(6)
  v_mfma_f32_16x16x32_bf16 v[32:35], v[100:103], v[80:83], v[32:35]
  ds_read_b64_tr_b16 v[116:117], v121 offset:9472
  v_mfma_f32_16x16x32_bf16 v[36:39], v[100:103], v[84:87], v[36:39]
  ds_read_b64_tr_b16 v[118:119], v121 offset:14080
  s_barrier
  ds_read_b128 v[88:91], v123 offset:16384
  ds_read_b128 v[92:95], v123 offset:17408
  s_waitcnt lgkmcnt(8)
  v_mfma_f32_16x16x32_bf16 v[40:43], v[104:107], v[80:83], v[40:43]
  ds_read_b64_tr_b16 v[96:97], v121 offset:18432
  v_mfma_f32_16x16x32_bf16 v[44:47], v[104:107], v[84:87], v[44:47]
  ds_read_b64_tr_b16 v[98:99], v121 offset:23040
  s_waitcnt lgkmcnt(8)
  v_mfma_f32_16x16x32_bf16 v[48:51], v[108:111], v[80:83], v[48:51]
  ds_read_b64_tr_b16 v[100:101], v121 offset:18464
  v_mfma_f32_16x16x32_bf16 v[52:55], v[108:111], v[84:87], v[52:55]
  ds_read_b64_tr_b16 v[102:103], v121 offset:23072
  s_waitcnt lgkmcnt(8)
  v_mfma_f32_16x16x32_bf16 v[56:59], v[112:115], v[80:83], v[56:59]
  ds_read_b64_tr_b16 v[104:105], v121 offset:18496
  v_mfma_f32_16x16x32_bf16 v[60:63], v[112:115], v[84:87], v[60:63]
  ds_read_b64_tr_b16 v[106:107], v121 offset:23104
  s_waitcnt lgkmcnt(8)
  v_mfma_f32_16x16x32_bf16 v[64:67], v[116:119], v[80:83], v[64:67]
  ds_read_b64_tr_b16 v[108:109], v121 offset:18528
  v_mfma_f32_16x16x32_bf16 v[68:71], v[116:119], v[84:87], v[68:71]
  ds_read_b64_tr_b16 v[110:111], v121 offset:23136
  s_waitcnt lgkmcnt(6)
  v_mfma_f32_16x16x32_bf16 v[0:3], v[96:99], v[88:91], v[0:3]
  ds_read_b64_tr_b16 v[112:113], v121 offset:18560
  v_mfma_f32_16x16x32_bf16 v[4:7], v[96:99], v[92:95], v[4:7]
  ds_read_b64_tr_b16 v[114:115], v121 offset:23168
  s_waitcnt lgkmcnt(6)
  v_mfma_f32_16x16x32_bf16 v[8:11], v[100:103], v[88:91], v[8:11]
  ds_read_b64_tr_b16 v[116:117], v121 offset:18592
  v_mfma_f32_16x16x32_bf16 v[12:15], v[100:103], v[92:95], v[12:15]
  ds_read_b64_tr_b16 v[118:119], v121 offset:23200
  s_waitcnt lgkmcnt(6)
  v_mfma_f32_16x16x32_bf16 v[16:19], v[104:107], v[88:91], v[16:19]
  ds_read_b64_tr_b16 v[96:97], v121 offset:18624
  v_mfma_f32_16x16x32_bf16 v[20:23], v[104:107], v[92:95], v[20:23]
  ds_read_b64_tr_b16 v[98:99], v121 offset:23232
  s_waitcnt lgkmcnt(6)
  v_mfma_f32_16x16x32_bf16 v[24:27], v[108:111], v[88:91], v[24:27]
  ds_read_b64_tr_b16 v[100:101], v121 offset:18656
  v_mfma_f32_16x16x32_bf16 v[28:31], v[108:111], v[92:95], v[28:31]
  ds_read_b64_tr_b16 v[102:103], v121 offset:23264
  s_waitcnt lgkmcnt(6)
  v_mfma_f32_16x16x32_bf16 v[32:35], v[112:115], v[88:91], v[32:35]
  ds_read_b64_tr_b16 v[104:105], v121 offset:18688
  v_mfma_f32_16x16x32_bf16 v[36:39], v[112:115], v[92:95], v[36:39]
  ds_read_b64_tr_b16 v[106:107], v121 offset:23296
  s_barrier
  ds_read_b128 v[72:75], v123 offset:24576
  ds_read_b128 v[76:79], v123 offset:25600
  s_waitcnt lgkmcnt(8)
  v_mfma_f32_16x16x32_bf16 v[40:43], v[116:119], v[88:91], v[40:43]
  ds_read_b64_tr_b16 v[108:109], v121 offset:27648
  v_mfma_f32_16x16x32_bf16 v[44:47], v[116:119], v[92:95], v[44:47]
  ds_read_b64_tr_b16 v[110:111], v121 offset:32256
  s_waitcnt lgkmcnt(8)
  v_mfma_f32_16x16x32_bf16 v[48:51], v[96:99], v[88:91], v[48:51]
  ds_read_b64_tr_b16 v[112:113], v121 offset:27680
  v_mfma_f32_16x16x32_bf16 v[52:55], v[96:99], v[92:95], v[52:55]
  ds_read_b64_tr_b16 v[114:115], v121 offset:32288
  s_waitcnt lgkmcnt(8)
  v_mfma_f32_16x16x32_bf16 v[56:59], v[100:103], v[88:91], v[56:59]
  ds_read_b64_tr_b16 v[116:117], v121 offset:27712
  v_mfma_f32_16x16x32_bf16 v[60:63], v[100:103], v[92:95], v[60:63]
  ds_read_b64_tr_b16 v[118:119], v121 offset:32320
  s_waitcnt lgkmcnt(8)
  v_mfma_f32_16x16x32_bf16 v[64:67], v[104:107], v[88:91], v[64:67]
  ds_read_b64_tr_b16 v[96:97], v121 offset:27744
  v_mfma_f32_16x16x32_bf16 v[68:71], v[104:107], v[92:95], v[68:71]
  ds_read_b64_tr_b16 v[98:99], v121 offset:32352
  s_waitcnt lgkmcnt(6)
  v_mfma_f32_16x16x32_bf16 v[0:3], v[108:111], v[72:75], v[0:3]
  ds_read_b64_tr_b16 v[100:101], v121 offset:27776
  v_mfma_f32_16x16x32_bf16 v[4:7], v[108:111], v[76:79], v[4:7]
  ds_read_b64_tr_b16 v[102:103], v121 offset:32384
  s_waitcnt lgkmcnt(6)
  v_mfma_f32_16x16x32_bf16 v[8:11], v[112:115], v[72:75], v[8:11]
  ds_read_b64_tr_b16 v[104:105], v121 offset:27808
  v_mfma_f32_16x16x32_bf16 v[12:15], v[112:115], v[76:79], v[12:15]
  ds_read_b64_tr_b16 v[106:107], v121 offset:32416
  s_waitcnt lgkmcnt(6)
  v_mfma_f32_16x16x32_bf16 v[16:19], v[116:119], v[72:75], v[16:19]
  ds_read_b64_tr_b16 v[108:109], v121 offset:27840
  v_mfma_f32_16x16x32_bf16 v[20:23], v[116:119], v[76:79], v[20:23]
  ds_read_b64_tr_b16 v[110:111], v121 offset:32448
  s_waitcnt lgkmcnt(6)
  v_mfma_f32_16x16x32_bf16 v[24:27], v[96:99], v[72:75], v[24:27]
  ds_read_b64_tr_b16 v[112:113], v121 offset:27872
  v_mfma_f32_16x16x32_bf16 v[28:31], v[96:99], v[76:79], v[28:31]
  ds_read_b64_tr_b16 v[114:115], v121 offset:32480
  s_waitcnt lgkmcnt(6)
  v_mfma_f32_16x16x32_bf16 v[32:35], v[100:103], v[72:75], v[32:35]
  ds_read_b64_tr_b16 v[116:117], v121 offset:27904
  v_mfma_f32_16x16x32_bf16 v[36:39], v[100:103], v[76:79], v[36:39]
  ds_read_b64_tr_b16 v[118:119], v121 offset:32512
  s_barrier
  ds_read2st64_b64 v[80:83], v125 offset0:64 offset1:65
  ds_read2st64_b64 v[84:87], v125 offset0:66 offset1:67
  s_waitcnt lgkmcnt(8)
  v_mfma_f32_16x16x32_bf16 v[40:43], v[104:107], v[72:75], v[40:43]
  ds_read_b64_tr_b16 v[96:97], v122 offset:0
  v_mfma_f32_16x16x32_bf16 v[44:47], v[104:107], v[76:79], v[44:47]
  ds_read_b64_tr_b16 v[98:99], v122 offset:4608
  s_waitcnt lgkmcnt(8)
  v_mfma_f32_16x16x32_bf16 v[48:51], v[108:111], v[72:75], v[48:51]
  ds_read_b64_tr_b16 v[100:101], v122 offset:32
  v_mfma_f32_16x16x32_bf16 v[52:55], v[108:111], v[76:79], v[52:55]
  ds_read_b64_tr_b16 v[102:103], v122 offset:4640
  s_waitcnt lgkmcnt(8)
  v_mfma_f32_16x16x32_bf16 v[56:59], v[112:115], v[72:75], v[56:59]
  ds_read_b64_tr_b16 v[104:105], v122 offset:64
  v_mfma_f32_16x16x32_bf16 v[60:63], v[112:115], v[76:79], v[60:63]
  ds_read_b64_tr_b16 v[106:107], v122 offset:4672
  s_waitcnt lgkmcnt(8)
  v_mfma_f32_16x16x32_bf16 v[64:67], v[116:119], v[72:75], v[64:67]
  ds_read_b64_tr_b16 v[108:109], v122 offset:96
  v_mfma_f32_16x16x32_bf16 v[68:71], v[116:119], v[76:79], v[68:71]
  ds_read_b64_tr_b16 v[110:111], v122 offset:4704
  s_waitcnt lgkmcnt(6)
  v_mfma_f32_16x16x32_bf16 v[0:3], v[96:99], v[80:83], v[0:3]
  ds_read_b64_tr_b16 v[112:113], v122 offset:128
  v_mfma_f32_16x16x32_bf16 v[4:7], v[96:99], v[84:87], v[4:7]
  ds_read_b64_tr_b16 v[114:115], v122 offset:4736
  s_waitcnt lgkmcnt(6)
  v_mfma_f32_16x16x32_bf16 v[8:11], v[100:103], v[80:83], v[8:11]
  ds_read_b64_tr_b16 v[116:117], v122 offset:160
  v_mfma_f32_16x16x32_bf16 v[12:15], v[100:103], v[84:87], v[12:15]
  ds_read_b64_tr_b16 v[118:119], v122 offset:4768
  s_waitcnt lgkmcnt(6)
  v_mfma_f32_16x16x32_bf16 v[16:19], v[104:107], v[80:83], v[16:19]
  ds_read_b64_tr_b16 v[96:97], v122 offset:192
  v_mfma_f32_16x16x32_bf16 v[20:23], v[104:107], v[84:87], v[20:23]
  ds_read_b64_tr_b16 v[98:99], v122 offset:4800
  s_waitcnt lgkmcnt(6)
  v_mfma_f32_16x16x32_bf16 v[24:27], v[108:111], v[80:83], v[24:27]
  ds_read_b64_tr_b16 v[100:101], v122 offset:224
  v_mfma_f32_16x16x32_bf16 v[28:31], v[108:111], v[84:87], v[28:31]
  ds_read_b64_tr_b16 v[102:103], v122 offset:4832
  s_waitcnt lgkmcnt(6)
  v_mfma_f32_16x16x32_bf16 v[32:35], v[112:115], v[80:83], v[32:35]
  ds_read_b64_tr_b16 v[104:105], v122 offset:256
  v_mfma_f32_16x16x32_bf16 v[36:39], v[112:115], v[84:87], v[36:39]
  ds_read_b64_tr_b16 v[106:107], v122 offset:4864
  s_barrier
  ds_read_b128 v[88:91], v123 offset:40960
  ds_read_b128 v[92:95], v123 offset:41984
  s_waitcnt lgkmcnt(8)
  v_mfma_f32_16x16x32_bf16 v[40:43], v[116:119], v[80:83], v[40:43]
  ds_read_b64_tr_b16 v[108:109], v122 offset:9216
  v_mfma_f32_16x16x32_bf16 v[44:47], v[116:119], v[84:87], v[44:47]
  ds_read_b64_tr_b16 v[110:111], v122 offset:13824
  s_waitcnt lgkmcnt(8)
  v_mfma_f32_16x16x32_bf16 v[48:51], v[96:99], v[80:83], v[48:51]
  ds_read_b64_tr_b16 v[112:113], v122 offset:9248
  v_mfma_f32_16x16x32_bf16 v[52:55], v[96:99], v[84:87], v[52:55]
  ds_read_b64_tr_b16 v[114:115], v122 offset:13856
  s_waitcnt lgkmcnt(8)
  v_mfma_f32_16x16x32_bf16 v[56:59], v[100:103], v[80:83], v[56:59]
  ds_read_b64_tr_b16 v[116:117], v122 offset:9280
  v_mfma_f32_16x16x32_bf16 v[60:63], v[100:103], v[84:87], v[60:63]
  ds_read_b64_tr_b16 v[118:119], v122 offset:13888
  s_waitcnt lgkmcnt(8)
  v_mfma_f32_16x16x32_bf16 v[64:67], v[104:107], v[80:83], v[64:67]
  ds_read_b64_tr_b16 v[96:97], v122 offset:9312
  v_mfma_f32_16x16x32_bf16 v[68:71], v[104:107], v[84:87], v[68:71]
  ds_read_b64_tr_b16 v[98:99], v122 offset:13920
  s_waitcnt lgkmcnt(6)
  v_mfma_f32_16x16x32_bf16 v[0:3], v[108:111], v[88:91], v[0:3]
  ds_read_b64_tr_b16 v[100:101], v122 offset:9344
  v_mfma_f32_16x16x32_bf16 v[4:7], v[108:111], v[92:95], v[4:7]
  ds_read_b64_tr_b16 v[102:103], v122 offset:13952
  s_waitcnt lgkmcnt(6)
  v_mfma_f32_16x16x32_bf16 v[8:11], v[112:115], v[88:91], v[8:11]
  ds_read_b64_tr_b16 v[104:105], v122 offset:9376
  v_mfma_f32_16x16x32_bf16 v[12:15], v[112:115], v[92:95], v[12:15]
  ds_read_b64_tr_b16 v[106:107], v122 offset:13984
  s_waitcnt lgkmcnt(6)
  v_mfma_f32_16x16x32_bf16 v[16:19], v[116:119], v[88:91], v[16:19]
  ds_read_b64_tr_b16 v[108:109], v122 offset:9408
  v_mfma_f32_16x16x32_bf16 v[20:23], v[116:119], v[92:95], v[20:23]
  ds_read_b64_tr_b16 v[110:111], v122 offset:14016
  s_waitcnt lgkmcnt(6)
  v_mfma_f32_16x16x32_bf16 v[24:27], v[96:99], v[88:91], v[24:27]
  ds_read_b64_tr_b16 v[112:113], v122 offset:9440
  v_mfma_f32_16x16x32_bf16 v[28:31], v[96:99], v[92:95], v[28:31]
  ds_read_b64_tr_b16 v[114:115], v122 offset:14048
  s_waitcnt lgkmcnt(6)
  v_mfma_f32_16x16x32_bf16 v[32:35], v[100:103], v[88:91], v[32:35]
  ds_read_b64_tr_b16 v[116:117], v122 offset:9472
  v_mfma_f32_16x16x32_bf16 v[36:39], v[100:103], v[92:95], v[36:39]
  ds_read_b64_tr_b16 v[118:119], v122 offset:14080
  s_barrier
  ds_read_b128 v[72:75], v123 offset:49152
  ds_read_b128 v[76:79], v123 offset:50176
  s_waitcnt lgkmcnt(8)
  v_mfma_f32_16x16x32_bf16 v[40:43], v[104:107], v[88:91], v[40:43]
  ds_read_b64_tr_b16 v[96:97], v122 offset:18432
  v_mfma_f32_16x16x32_bf16 v[44:47], v[104:107], v[92:95], v[44:47]
  ds_read_b64_tr_b16 v[98:99], v122 offset:23040
  s_waitcnt lgkmcnt(8)
  v_mfma_f32_16x16x32_bf16 v[48:51], v[108:111], v[88:91], v[48:51]
  ds_read_b64_tr_b16 v[100:101], v122 offset:18464
  v_mfma_f32_16x16x32_bf16 v[52:55], v[108:111], v[92:95], v[52:55]
  ds_read_b64_tr_b16 v[102:103], v122 offset:23072
  s_waitcnt lgkmcnt(8)
  v_mfma_f32_16x16x32_bf16 v[56:59], v[112:115], v[88:91], v[56:59]
  ds_read_b64_tr_b16 v[104:105], v122 offset:18496
  v_mfma_f32_16x16x32_bf16 v[60:63], v[112:115], v[92:95], v[60:63]
  ds_read_b64_tr_b16 v[106:107], v122 offset:23104
  s_waitcnt lgkmcnt(8)
  v_mfma_f32_16x16x32_bf16 v[64:67], v[116:119], v[88:91], v[64:67]
  ds_read_b64_tr_b16 v[108:109], v122 offset:18528
  v_mfma_f32_16x16x32_bf16 v[68:71], v[116:119], v[92:95], v[68:71]
  ds_read_b64_tr_b16 v[110:111], v122 offset:23136
  s_waitcnt lgkmcnt(6)
  v_mfma_f32_16x16x32_bf16 v[0:3], v[96:99], v[72:75], v[0:3]
  ds_read_b64_tr_b16 v[112:113], v122 offset:18560
  v_mfma_f32_16x16x32_bf16 v[4:7], v[96:99], v[76:79], v[4:7]
  ds_read_b64_tr_b16 v[114:115], v122 offset:23168
  s_waitcnt lgkmcnt(6)
  v_mfma_f32_16x16x32_bf16 v[8:11], v[100:103], v[72:75], v[8:11]
  ds_read_b64_tr_b16 v[116:117], v122 offset:18592
  v_mfma_f32_16x16x32_bf16 v[12:15], v[100:103], v[76:79], v[12:15]
  ds_read_b64_tr_b16 v[118:119], v122 offset:23200
  s_waitcnt lgkmcnt(6)
  v_mfma_f32_16x16x32_bf16 v[16:19], v[104:107], v[72:75], v[16:19]
  ds_read_b64_tr_b16 v[96:97], v122 offset:18624
  v_mfma_f32_16x16x32_bf16 v[20:23], v[104:107], v[76:79], v[20:23]
  ds_read_b64_tr_b16 v[98:99], v122 offset:23232
  s_waitcnt lgkmcnt(6)
  v_mfma_f32_16x16x32_bf16 v[24:27], v[108:111], v[72:75], v[24:27]
  ds_read_b64_tr_b16 v[100:101], v122 offset:18656
  v_mfma_f32_16x16x32_bf16 v[28:31], v[108:111], v[76:79], v[28:31]
  ds_read_b64_tr_b16 v[102:103], v122 offset:23264
  s_waitcnt lgkmcnt(6)
  v_mfma_f32_16x16x32_bf16 v[32:35], v[112:115], v[72:75], v[32:35]
  ds_read_b64_tr_b16 v[104:105], v122 offset:18688
  v_mfma_f32_16x16x32_bf16 v[36:39], v[112:115], v[76:79], v[36:39]
  ds_read_b64_tr_b16 v[106:107], v122 offset:23296
  s_barrier
  ds_read_b128 v[80:83], v123 offset:57344
  ds_read_b128 v[84:87], v123 offset:58368
  s_waitcnt lgkmcnt(8)
  v_mfma_f32_16x16x32_bf16 v[40:43], v[116:119], v[72:75], v[40:43]
  ds_read_b64_tr_b16 v[108:109], v122 offset:27648
  v_mfma_f32_16x16x32_bf16 v[44:47], v[116:119], v[76:79], v[44:47]
  ds_read_b64_tr_b16 v[110:111], v122 offset:32256
  s_waitcnt lgkmcnt(8)
  v_mfma_f32_16x16x32_bf16 v[48:51], v[96:99], v[72:75], v[48:51]
  ds_read_b64_tr_b16 v[112:113], v122 offset:27680
  v_mfma_f32_16x16x32_bf16 v[52:55], v[96:99], v[76:79], v[52:55]
  ds_read_b64_tr_b16 v[114:115], v122 offset:32288
  s_waitcnt lgkmcnt(8)
  v_mfma_f32_16x16x32_bf16 v[56:59], v[100:103], v[72:75], v[56:59]
  ds_read_b64_tr_b16 v[116:117], v122 offset:27712
  v_mfma_f32_16x16x32_bf16 v[60:63], v[100:103], v[76:79], v[60:63]
  ds_read_b64_tr_b16 v[118:119], v122 offset:32320
  s_waitcnt lgkmcnt(8)
  v_mfma_f32_16x16x32_bf16 v[64:67], v[104:107], v[72:75], v[64:67]
  ds_read_b64_tr_b16 v[96:97], v122 offset:27744
  v_mfma_f32_16x16x32_bf16 v[68:71], v[104:107], v[76:79], v[68:71]
  ds_read_b64_tr_b16 v[98:99], v122 offset:32352
  s_waitcnt lgkmcnt(6)
  v_mfma_f32_16x16x32_bf16 v[0:3], v[108:111], v[80:83], v[0:3]
  ds_read_b64_tr_b16 v[100:101], v122 offset:27776
  v_mfma_f32_16x16x32_bf16 v[4:7], v[108:111], v[84:87], v[4:7]
  ds_read_b64_tr_b16 v[102:103], v122 offset:32384
  s_waitcnt lgkmcnt(6)
  v_mfma_f32_16x16x32_bf16 v[8:11], v[112:115], v[80:83], v[8:11]
  ds_read_b64_tr_b16 v[104:105], v122 offset:27808
  v_mfma_f32_16x16x32_bf16 v[12:15], v[112:115], v[84:87], v[12:15]
  ds_read_b64_tr_b16 v[106:107], v122 offset:32416
  s_waitcnt lgkmcnt(6)
  v_mfma_f32_16x16x32_bf16 v[16:19], v[116:119], v[80:83], v[16:19]
  ds_read_b64_tr_b16 v[108:109], v122 offset:27840
  v_mfma_f32_16x16x32_bf16 v[20:23], v[116:119], v[84:87], v[20:23]
  ds_read_b64_tr_b16 v[110:111], v122 offset:32448
  s_waitcnt lgkmcnt(6)
  v_mfma_f32_16x16x32_bf16 v[24:27], v[96:99], v[80:83], v[24:27]
  ds_read_b64_tr_b16 v[112:113], v122 offset:27872
  v_mfma_f32_16x16x32_bf16 v[28:31], v[96:99], v[84:87], v[28:31]
  ds_read_b64_tr_b16 v[114:115], v122 offset:32480
  s_waitcnt lgkmcnt(6)
  v_mfma_f32_16x16x32_bf16 v[32:35], v[100:103], v[80:83], v[32:35]
  ds_read_b64_tr_b16 v[116:117], v122 offset:27904
  v_mfma_f32_16x16x32_bf16 v[36:39], v[100:103], v[84:87], v[36:39]
  ds_read_b64_tr_b16 v[118:119], v122 offset:32512
  s_barrier
  ds_read_b128 v[88:91], v123 offset:0
  ds_read_b128 v[92:95], v123 offset:1024
  s_waitcnt lgkmcnt(8)
  v_mfma_f32_16x16x32_bf16 v[40:43], v[104:107], v[80:83], v[40:43]
  ds_read_b64_tr_b16 v[96:97], v121 offset:0
  v_mfma_f32_16x16x32_bf16 v[44:47], v[104:107], v[84:87], v[44:47]
  ds_read_b64_tr_b16 v[98:99], v121 offset:4608
  s_waitcnt lgkmcnt(8)
  v_mfma_f32_16x16x32_bf16 v[48:51], v[108:111], v[80:83], v[48:51]
  ds_read_b64_tr_b16 v[100:101], v121 offset:32
  v_mfma_f32_16x16x32_bf16 v[52:55], v[108:111], v[84:87], v[52:55]
  ds_read_b64_tr_b16 v[102:103], v121 offset:4640
  s_waitcnt lgkmcnt(8)
  v_mfma_f32_16x16x32_bf16 v[56:59], v[112:115], v[80:83], v[56:59]
  ds_read_b64_tr_b16 v[104:105], v121 offset:64
  v_mfma_f32_16x16x32_bf16 v[60:63], v[112:115], v[84:87], v[60:63]
  ds_read_b64_tr_b16 v[106:107], v121 offset:4672
  s_waitcnt lgkmcnt(8)
  v_mfma_f32_16x16x32_bf16 v[64:67], v[116:119], v[80:83], v[64:67]
  ds_read_b64_tr_b16 v[108:109], v121 offset:96
  v_mfma_f32_16x16x32_bf16 v[68:71], v[116:119], v[84:87], v[68:71]
  ds_read_b64_tr_b16 v[110:111], v121 offset:4704
  s_waitcnt lgkmcnt(6)
  v_mfma_f32_16x16x32_bf16 v[0:3], v[96:99], v[88:91], v[0:3]
  ds_read_b64_tr_b16 v[112:113], v121 offset:128
  v_mfma_f32_16x16x32_bf16 v[4:7], v[96:99], v[92:95], v[4:7]
  ds_read_b64_tr_b16 v[114:115], v121 offset:4736
  s_waitcnt lgkmcnt(6)
  v_mfma_f32_16x16x32_bf16 v[8:11], v[100:103], v[88:91], v[8:11]
  ds_read_b64_tr_b16 v[116:117], v121 offset:160
  v_mfma_f32_16x16x32_bf16 v[12:15], v[100:103], v[92:95], v[12:15]
  ds_read_b64_tr_b16 v[118:119], v121 offset:4768
  s_waitcnt lgkmcnt(6)
  v_mfma_f32_16x16x32_bf16 v[16:19], v[104:107], v[88:91], v[16:19]
  ds_read_b64_tr_b16 v[96:97], v121 offset:192
  v_mfma_f32_16x16x32_bf16 v[20:23], v[104:107], v[92:95], v[20:23]
  ds_read_b64_tr_b16 v[98:99], v121 offset:4800
  s_waitcnt lgkmcnt(6)
  v_mfma_f32_16x16x32_bf16 v[24:27], v[108:111], v[88:91], v[24:27]
  ds_read_b64_tr_b16 v[100:101], v121 offset:224
  v_mfma_f32_16x16x32_bf16 v[28:31], v[108:111], v[92:95], v[28:31]
  ds_read_b64_tr_b16 v[102:103], v121 offset:4832
  s_waitcnt lgkmcnt(6)
  v_mfma_f32_16x16x32_bf16 v[32:35], v[112:115], v[88:91], v[32:35]
  ds_read_b64_tr_b16 v[104:105], v121 offset:256
  v_mfma_f32_16x16x32_bf16 v[36:39], v[112:115], v[92:95], v[36:39]
  ds_read_b64_tr_b16 v[106:107], v121 offset:4864
  s_barrier
  ds_read_b128 v[72:75], v123 offset:8192
  ds_read_b128 v[76:79], v123 offset:9216
  s_waitcnt lgkmcnt(8)
  v_mfma_f32_16x16x32_bf16 v[40:43], v[116:119], v[88:91], v[40:43]
  ds_read_b64_tr_b16 v[108:109], v121 offset:9216
  v_mfma_f32_16x16x32_bf16 v[44:47], v[116:119], v[92:95], v[44:47]
  ds_read_b64_tr_b16 v[110:111], v121 offset:13824
  s_waitcnt lgkmcnt(8)
  v_mfma_f32_16x16x32_bf16 v[48:51], v[96:99], v[88:91], v[48:51]
  ds_read_b64_tr_b16 v[112:113], v121 offset:9248
  v_mfma_f32_16x16x32_bf16 v[52:55], v[96:99], v[92:95], v[52:55]
  ds_read_b64_tr_b16 v[114:115], v121 offset:13856
  s_waitcnt lgkmcnt(8)
  v_mfma_f32_16x16x32_bf16 v[56:59], v[100:103], v[88:91], v[56:59]
  ds_read_b64_tr_b16 v[116:117], v121 offset:9280
  v_mfma_f32_16x16x32_bf16 v[60:63], v[100:103], v[92:95], v[60:63]
  ds_read_b64_tr_b16 v[118:119], v121 offset:13888
  s_waitcnt lgkmcnt(8)
  v_mfma_f32_16x16x32_bf16 v[64:67], v[104:107], v[88:91], v[64:67]
  ds_read_b64_tr_b16 v[96:97], v121 offset:9312
  v_mfma_f32_16x16x32_bf16 v[68:71], v[104:107], v[92:95], v[68:71]
  ds_read_b64_tr_b16 v[98:99], v121 offset:13920
  s_waitcnt lgkmcnt(6)
  v_mfma_f32_16x16x32_bf16 v[0:3], v[108:111], v[72:75], v[0:3]
  ds_read_b64_tr_b16 v[100:101], v121 offset:9344
  v_mfma_f32_16x16x32_bf16 v[4:7], v[108:111], v[76:79], v[4:7]
  ds_read_b64_tr_b16 v[102:103], v121 offset:13952
  s_waitcnt lgkmcnt(6)
  v_mfma_f32_16x16x32_bf16 v[8:11], v[112:115], v[72:75], v[8:11]
  ds_read_b64_tr_b16 v[104:105], v121 offset:9376
  v_mfma_f32_16x16x32_bf16 v[12:15], v[112:115], v[76:79], v[12:15]
  ds_read_b64_tr_b16 v[106:107], v121 offset:13984
  s_waitcnt lgkmcnt(6)
  v_mfma_f32_16x16x32_bf16 v[16:19], v[116:119], v[72:75], v[16:19]
  ds_read_b64_tr_b16 v[108:109], v121 offset:9408
  v_mfma_f32_16x16x32_bf16 v[20:23], v[116:119], v[76:79], v[20:23]
  ds_read_b64_tr_b16 v[110:111], v121 offset:14016
  s_waitcnt lgkmcnt(6)
  v_mfma_f32_16x16x32_bf16 v[24:27], v[96:99], v[72:75], v[24:27]
  ds_read_b64_tr_b16 v[112:113], v121 offset:9440
  v_mfma_f32_16x16x32_bf16 v[28:31], v[96:99], v[76:79], v[28:31]
  ds_read_b64_tr_b16 v[114:115], v121 offset:14048
  s_waitcnt lgkmcnt(6)
  v_mfma_f32_16x16x32_bf16 v[32:35], v[100:103], v[72:75], v[32:35]
  ds_read_b64_tr_b16 v[116:117], v121 offset:9472
  v_mfma_f32_16x16x32_bf16 v[36:39], v[100:103], v[76:79], v[36:39]
  ds_read_b64_tr_b16 v[118:119], v121 offset:14080
  s_barrier
  ds_read_b128 v[80:83], v123 offset:16384
  ds_read_b128 v[84:87], v123 offset:17408
  s_waitcnt lgkmcnt(8)
  v_mfma_f32_16x16x32_bf16 v[40:43], v[104:107], v[72:75], v[40:43]
  ds_read_b64_tr_b16 v[96:97], v121 offset:18432
  v_mfma_f32_16x16x32_bf16 v[44:47], v[104:107], v[76:79], v[44:47]
  ds_read_b64_tr_b16 v[98:99], v121 offset:23040
  s_waitcnt lgkmcnt(8)
  v_mfma_f32_16x16x32_bf16 v[48:51], v[108:111], v[72:75], v[48:51]
  ds_read_b64_tr_b16 v[100:101], v121 offset:18464
  v_mfma_f32_16x16x32_bf16 v[52:55], v[108:111], v[76:79], v[52:55]
  ds_read_b64_tr_b16 v[102:103], v121 offset:23072
  s_waitcnt lgkmcnt(8)
  v_mfma_f32_16x16x32_bf16 v[56:59], v[112:115], v[72:75], v[56:59]
  ds_read_b64_tr_b16 v[104:105], v121 offset:18496
  v_mfma_f32_16x16x32_bf16 v[60:63], v[112:115], v[76:79], v[60:63]
  ds_read_b64_tr_b16 v[106:107], v121 offset:23104
  s_waitcnt lgkmcnt(8)
  v_mfma_f32_16x16x32_bf16 v[64:67], v[116:119], v[72:75], v[64:67]
  ds_read_b64_tr_b16 v[108:109], v121 offset:18528
  v_mfma_f32_16x16x32_bf16 v[68:71], v[116:119], v[76:79], v[68:71]
  ds_read_b64_tr_b16 v[110:111], v121 offset:23136
  s_waitcnt lgkmcnt(6)
  v_mfma_f32_16x16x32_bf16 v[0:3], v[96:99], v[80:83], v[0:3]
  ds_read_b64_tr_b16 v[112:113], v121 offset:18560
  v_mfma_f32_16x16x32_bf16 v[4:7], v[96:99], v[84:87], v[4:7]
  ds_read_b64_tr_b16 v[114:115], v121 offset:23168
  s_waitcnt lgkmcnt(6)
  v_mfma_f32_16x16x32_bf16 v[8:11], v[100:103], v[80:83], v[8:11]
  ds_read_b64_tr_b16 v[116:117], v121 offset:18592
  v_mfma_f32_16x16x32_bf16 v[12:15], v[100:103], v[84:87], v[12:15]
  ds_read_b64_tr_b16 v[118:119], v121 offset:23200
  s_waitcnt lgkmcnt(6)
  v_mfma_f32_16x16x32_bf16 v[16:19], v[104:107], v[80:83], v[16:19]
  ds_read_b64_tr_b16 v[96:97], v121 offset:18624
  v_mfma_f32_16x16x32_bf16 v[20:23], v[104:107], v[84:87], v[20:23]
  ds_read_b64_tr_b16 v[98:99], v121 offset:23232
  s_waitcnt lgkmcnt(6)
  v_mfma_f32_16x16x32_bf16 v[24:27], v[108:111], v[80:83], v[24:27]
  ds_read_b64_tr_b16 v[100:101], v121 offset:18656
  v_mfma_f32_16x16x32_bf16 v[28:31], v[108:111], v[84:87], v[28:31]
  ds_read_b64_tr_b16 v[102:103], v121 offset:23264
  s_waitcnt lgkmcnt(6)
  v_mfma_f32_16x16x32_bf16 v[32:35], v[112:115], v[80:83], v[32:35]
  ds_read_b64_tr_b16 v[104:105], v121 offset:18688
  v_mfma_f32_16x16x32_bf16 v[36:39], v[112:115], v[84:87], v[36:39]
  ds_read_b64_tr_b16 v[106:107], v121 offset:23296
  s_barrier
  ds_read_b128 v[88:91], v123 offset:24576
  ds_read_b128 v[92:95], v123 offset:25600
  s_waitcnt lgkmcnt(8)
  v_mfma_f32_16x16x32_bf16 v[40:43], v[116:119], v[80:83], v[40:43]
  ds_read_b64_tr_b16 v[108:109], v121 offset:27648
  v_mfma_f32_16x16x32_bf16 v[44:47], v[116:119], v[84:87], v[44:47]
  ds_read_b64_tr_b16 v[110:111], v121 offset:32256
  s_waitcnt lgkmcnt(8)
  v_mfma_f32_16x16x32_bf16 v[48:51], v[96:99], v[80:83], v[48:51]
  ds_read_b64_tr_b16 v[112:113], v121 offset:27680
  v_mfma_f32_16x16x32_bf16 v[52:55], v[96:99], v[84:87], v[52:55]
  ds_read_b64_tr_b16 v[114:115], v121 offset:32288
  s_waitcnt lgkmcnt(8)
  v_mfma_f32_16x16x32_bf16 v[56:59], v[100:103], v[80:83], v[56:59]
  ds_read_b64_tr_b16 v[116:117], v121 offset:27712
  v_mfma_f32_16x16x32_bf16 v[60:63], v[100:103], v[84:87], v[60:63]
  ds_read_b64_tr_b16 v[118:119], v121 offset:32320
  s_waitcnt lgkmcnt(8)
  v_mfma_f32_16x16x32_bf16 v[64:67], v[104:107], v[80:83], v[64:67]
  ds_read_b64_tr_b16 v[96:97], v121 offset:27744
  v_mfma_f32_16x16x32_bf16 v[68:71], v[104:107], v[84:87], v[68:71]
  ds_read_b64_tr_b16 v[98:99], v121 offset:32352
  s_waitcnt lgkmcnt(6)
  v_mfma_f32_16x16x32_bf16 v[0:3], v[108:111], v[88:91], v[0:3]
  ds_read_b64_tr_b16 v[100:101], v121 offset:27776
  v_mfma_f32_16x16x32_bf16 v[4:7], v[108:111], v[92:95], v[4:7]
  ds_read_b64_tr_b16 v[102:103], v121 offset:32384
  s_waitcnt lgkmcnt(6)
  v_mfma_f32_16x16x32_bf16 v[8:11], v[112:115], v[88:91], v[8:11]
  ds_read_b64_tr_b16 v[104:105], v121 offset:27808
  v_mfma_f32_16x16x32_bf16 v[12:15], v[112:115], v[92:95], v[12:15]
  ds_read_b64_tr_b16 v[106:107], v121 offset:32416
  s_waitcnt lgkmcnt(6)
  v_mfma_f32_16x16x32_bf16 v[16:19], v[116:119], v[88:91], v[16:19]
  ds_read_b64_tr_b16 v[108:109], v121 offset:27840
  v_mfma_f32_16x16x32_bf16 v[20:23], v[116:119], v[92:95], v[20:23]
  ds_read_b64_tr_b16 v[110:111], v121 offset:32448
  s_waitcnt lgkmcnt(6)
  v_mfma_f32_16x16x32_bf16 v[24:27], v[96:99], v[88:91], v[24:27]
  ds_read_b64_tr_b16 v[112:113], v121 offset:27872
  v_mfma_f32_16x16x32_bf16 v[28:31], v[96:99], v[92:95], v[28:31]
  ds_read_b64_tr_b16 v[114:115], v121 offset:32480
  s_waitcnt lgkmcnt(6)
  v_mfma_f32_16x16x32_bf16 v[32:35], v[100:103], v[88:91], v[32:35]
  ds_read_b64_tr_b16 v[116:117], v121 offset:27904
  v_mfma_f32_16x16x32_bf16 v[36:39], v[100:103], v[92:95], v[36:39]
  ds_read_b64_tr_b16 v[118:119], v121 offset:32512
  s_barrier
  ds_read_b128 v[72:75], v123 offset:32768
  ds_read_b128 v[76:79], v123 offset:33792
  s_waitcnt lgkmcnt(8)
  v_mfma_f32_16x16x32_bf16 v[40:43], v[104:107], v[88:91], v[40:43]
  ds_read_b64_tr_b16 v[96:97], v122 offset:0
  v_mfma_f32_16x16x32_bf16 v[44:47], v[104:107], v[92:95], v[44:47]
  ds_read_b64_tr_b16 v[98:99], v122 offset:4608
  s_waitcnt lgkmcnt(8)
  v_mfma_f32_16x16x32_bf16 v[48:51], v[108:111], v[88:91], v[48:51]
  ds_read_b64_tr_b16 v[100:101], v122 offset:32
  v_mfma_f32_16x16x32_bf16 v[52:55], v[108:111], v[92:95], v[52:55]
  ds_read_b64_tr_b16 v[102:103], v122 offset:4640
  s_waitcnt lgkmcnt(8)
  v_mfma_f32_16x16x32_bf16 v[56:59], v[112:115], v[88:91], v[56:59]
  ds_read_b64_tr_b16 v[104:105], v122 offset:64
  v_mfma_f32_16x16x32_bf16 v[60:63], v[112:115], v[92:95], v[60:63]
  ds_read_b64_tr_b16 v[106:107], v122 offset:4672
  s_waitcnt lgkmcnt(8)
  v_mfma_f32_16x16x32_bf16 v[64:67], v[116:119], v[88:91], v[64:67]
  ds_read_b64_tr_b16 v[108:109], v122 offset:96
  v_mfma_f32_16x16x32_bf16 v[68:71], v[116:119], v[92:95], v[68:71]
  ds_read_b64_tr_b16 v[110:111], v122 offset:4704
  s_waitcnt lgkmcnt(6)
  v_mfma_f32_16x16x32_bf16 v[0:3], v[96:99], v[72:75], v[0:3]
  ds_read_b64_tr_b16 v[112:113], v122 offset:128
  v_mfma_f32_16x16x32_bf16 v[4:7], v[96:99], v[76:79], v[4:7]
  ds_read_b64_tr_b16 v[114:115], v122 offset:4736
  s_waitcnt lgkmcnt(6)
  v_mfma_f32_16x16x32_bf16 v[8:11], v[100:103], v[72:75], v[8:11]
  ds_read_b64_tr_b16 v[116:117], v122 offset:160
  v_mfma_f32_16x16x32_bf16 v[12:15], v[100:103], v[76:79], v[12:15]
  ds_read_b64_tr_b16 v[118:119], v122 offset:4768
  s_waitcnt lgkmcnt(6)
  v_mfma_f32_16x16x32_bf16 v[16:19], v[104:107], v[72:75], v[16:19]
  ds_read_b64_tr_b16 v[96:97], v122 offset:192
  v_mfma_f32_16x16x32_bf16 v[20:23], v[104:107], v[76:79], v[20:23]
  ds_read_b64_tr_b16 v[98:99], v122 offset:4800
  s_waitcnt lgkmcnt(6)
  v_mfma_f32_16x16x32_bf16 v[24:27], v[108:111], v[72:75], v[24:27]
  ds_read_b64_tr_b16 v[100:101], v122 offset:224
  v_mfma_f32_16x16x32_bf16 v[28:31], v[108:111], v[76:79], v[28:31]
  ds_read_b64_tr_b16 v[102:103], v122 offset:4832
  s_waitcnt lgkmcnt(6)
  v_mfma_f32_16x16x32_bf16 v[32:35], v[112:115], v[72:75], v[32:35]
  ds_read_b64_tr_b16 v[104:105], v122 offset:256
  v_mfma_f32_16x16x32_bf16 v[36:39], v[112:115], v[76:79], v[36:39]
  ds_read_b64_tr_b16 v[106:107], v122 offset:4864
  s_barrier
  ds_read2st64_b64 v[80:83], v125 offset0:80 offset1:81
  ds_read2st64_b64 v[84:87], v125 offset0:82 offset1:83
  s_waitcnt lgkmcnt(8)
  v_mfma_f32_16x16x32_bf16 v[40:43], v[116:119], v[72:75], v[40:43]
  ds_read_b64_tr_b16 v[108:109], v122 offset:9216
  v_mfma_f32_16x16x32_bf16 v[44:47], v[116:119], v[76:79], v[44:47]
  ds_read_b64_tr_b16 v[110:111], v122 offset:13824
  s_waitcnt lgkmcnt(8)
  v_mfma_f32_16x16x32_bf16 v[48:51], v[96:99], v[72:75], v[48:51]
  ds_read_b64_tr_b16 v[112:113], v122 offset:9248
  v_mfma_f32_16x16x32_bf16 v[52:55], v[96:99], v[76:79], v[52:55]
  ds_read_b64_tr_b16 v[114:115], v122 offset:13856
  s_waitcnt lgkmcnt(8)
  v_mfma_f32_16x16x32_bf16 v[56:59], v[100:103], v[72:75], v[56:59]
  ds_read_b64_tr_b16 v[116:117], v122 offset:9280
  v_mfma_f32_16x16x32_bf16 v[60:63], v[100:103], v[76:79], v[60:63]
  ds_read_b64_tr_b16 v[118:119], v122 offset:13888
  s_waitcnt lgkmcnt(8)
  v_mfma_f32_16x16x32_bf16 v[64:67], v[104:107], v[72:75], v[64:67]
  ds_read_b64_tr_b16 v[96:97], v122 offset:9312
  v_mfma_f32_16x16x32_bf16 v[68:71], v[104:107], v[76:79], v[68:71]
  ds_read_b64_tr_b16 v[98:99], v122 offset:13920
  s_waitcnt lgkmcnt(6)
  v_mfma_f32_16x16x32_bf16 v[0:3], v[108:111], v[80:83], v[0:3]
  ds_read_b64_tr_b16 v[100:101], v122 offset:9344
  v_mfma_f32_16x16x32_bf16 v[4:7], v[108:111], v[84:87], v[4:7]
  ds_read_b64_tr_b16 v[102:103], v122 offset:13952
  s_waitcnt lgkmcnt(6)
  v_mfma_f32_16x16x32_bf16 v[8:11], v[112:115], v[80:83], v[8:11]
  ds_read_b64_tr_b16 v[104:105], v122 offset:9376
  v_mfma_f32_16x16x32_bf16 v[12:15], v[112:115], v[84:87], v[12:15]
  ds_read_b64_tr_b16 v[106:107], v122 offset:13984
  s_waitcnt lgkmcnt(6)
  v_mfma_f32_16x16x32_bf16 v[16:19], v[116:119], v[80:83], v[16:19]
  ds_read_b64_tr_b16 v[108:109], v122 offset:9408
  v_mfma_f32_16x16x32_bf16 v[20:23], v[116:119], v[84:87], v[20:23]
  ds_read_b64_tr_b16 v[110:111], v122 offset:14016
  s_waitcnt lgkmcnt(6)
  v_mfma_f32_16x16x32_bf16 v[24:27], v[96:99], v[80:83], v[24:27]
  ds_read_b64_tr_b16 v[112:113], v122 offset:9440
  v_mfma_f32_16x16x32_bf16 v[28:31], v[96:99], v[84:87], v[28:31]
  ds_read_b64_tr_b16 v[114:115], v122 offset:14048
  s_waitcnt lgkmcnt(6)
  v_mfma_f32_16x16x32_bf16 v[32:35], v[100:103], v[80:83], v[32:35]
  ds_read_b64_tr_b16 v[116:117], v122 offset:9472
  v_mfma_f32_16x16x32_bf16 v[36:39], v[100:103], v[84:87], v[36:39]
  ds_read_b64_tr_b16 v[118:119], v122 offset:14080
  s_barrier
  ds_read_b128 v[88:91], v123 offset:49152
  ds_read_b128 v[92:95], v123 offset:50176
  s_waitcnt lgkmcnt(8)
  v_mfma_f32_16x16x32_bf16 v[40:43], v[104:107], v[80:83], v[40:43]
  ds_read_b64_tr_b16 v[96:97], v122 offset:18432
  v_mfma_f32_16x16x32_bf16 v[44:47], v[104:107], v[84:87], v[44:47]
  ds_read_b64_tr_b16 v[98:99], v122 offset:23040
  s_waitcnt lgkmcnt(8)
  v_mfma_f32_16x16x32_bf16 v[48:51], v[108:111], v[80:83], v[48:51]
  ds_read_b64_tr_b16 v[100:101], v122 offset:18464
  v_mfma_f32_16x16x32_bf16 v[52:55], v[108:111], v[84:87], v[52:55]
  ds_read_b64_tr_b16 v[102:103], v122 offset:23072
  s_waitcnt lgkmcnt(8)
  v_mfma_f32_16x16x32_bf16 v[56:59], v[112:115], v[80:83], v[56:59]
  ds_read_b64_tr_b16 v[104:105], v122 offset:18496
  v_mfma_f32_16x16x32_bf16 v[60:63], v[112:115], v[84:87], v[60:63]
  ds_read_b64_tr_b16 v[106:107], v122 offset:23104
  s_waitcnt lgkmcnt(8)
  v_mfma_f32_16x16x32_bf16 v[64:67], v[116:119], v[80:83], v[64:67]
  ds_read_b64_tr_b16 v[108:109], v122 offset:18528
  v_mfma_f32_16x16x32_bf16 v[68:71], v[116:119], v[84:87], v[68:71]
  ds_read_b64_tr_b16 v[110:111], v122 offset:23136
  s_waitcnt lgkmcnt(6)
  v_mfma_f32_16x16x32_bf16 v[0:3], v[96:99], v[88:91], v[0:3]
  ds_read_b64_tr_b16 v[112:113], v122 offset:18560
  v_mfma_f32_16x16x32_bf16 v[4:7], v[96:99], v[92:95], v[4:7]
  ds_read_b64_tr_b16 v[114:115], v122 offset:23168
  s_waitcnt lgkmcnt(6)
  v_mfma_f32_16x16x32_bf16 v[8:11], v[100:103], v[88:91], v[8:11]
  ds_read_b64_tr_b16 v[116:117], v122 offset:18592
  v_mfma_f32_16x16x32_bf16 v[12:15], v[100:103], v[92:95], v[12:15]
  ds_read_b64_tr_b16 v[118:119], v122 offset:23200
  s_waitcnt lgkmcnt(6)
  v_mfma_f32_16x16x32_bf16 v[16:19], v[104:107], v[88:91], v[16:19]
  ds_read_b64_tr_b16 v[96:97], v122 offset:18624
  v_mfma_f32_16x16x32_bf16 v[20:23], v[104:107], v[92:95], v[20:23]
  ds_read_b64_tr_b16 v[98:99], v122 offset:23232
  s_waitcnt lgkmcnt(6)
  v_mfma_f32_16x16x32_bf16 v[24:27], v[108:111], v[88:91], v[24:27]
  ds_read_b64_tr_b16 v[100:101], v122 offset:18656
  v_mfma_f32_16x16x32_bf16 v[28:31], v[108:111], v[92:95], v[28:31]
  ds_read_b64_tr_b16 v[102:103], v122 offset:23264
  s_waitcnt lgkmcnt(6)
  v_mfma_f32_16x16x32_bf16 v[32:35], v[112:115], v[88:91], v[32:35]
  ds_read_b64_tr_b16 v[104:105], v122 offset:18688
  v_mfma_f32_16x16x32_bf16 v[36:39], v[112:115], v[92:95], v[36:39]
  ds_read_b64_tr_b16 v[106:107], v122 offset:23296
  s_barrier
  ds_read_b128 v[72:75], v123 offset:57344
  ds_read_b128 v[76:79], v123 offset:58368
  s_waitcnt lgkmcnt(8)
  v_mfma_f32_16x16x32_bf16 v[40:43], v[116:119], v[88:91], v[40:43]
  ds_read_b64_tr_b16 v[108:109], v122 offset:27648
  v_mfma_f32_16x16x32_bf16 v[44:47], v[116:119], v[92:95], v[44:47]
  ds_read_b64_tr_b16 v[110:111], v122 offset:32256
  s_waitcnt lgkmcnt(8)
  v_mfma_f32_16x16x32_bf16 v[48:51], v[96:99], v[88:91], v[48:51]
  ds_read_b64_tr_b16 v[112:113], v122 offset:27680
  v_mfma_f32_16x16x32_bf16 v[52:55], v[96:99], v[92:95], v[52:55]
  ds_read_b64_tr_b16 v[114:115], v122 offset:32288
  s_waitcnt lgkmcnt(8)
  v_mfma_f32_16x16x32_bf16 v[56:59], v[100:103], v[88:91], v[56:59]
  ds_read_b64_tr_b16 v[116:117], v122 offset:27712
  v_mfma_f32_16x16x32_bf16 v[60:63], v[100:103], v[92:95], v[60:63]
  ds_read_b64_tr_b16 v[118:119], v122 offset:32320
  s_waitcnt lgkmcnt(8)
  v_mfma_f32_16x16x32_bf16 v[64:67], v[104:107], v[88:91], v[64:67]
  ds_read_b64_tr_b16 v[96:97], v122 offset:27744
  v_mfma_f32_16x16x32_bf16 v[68:71], v[104:107], v[92:95], v[68:71]
  ds_read_b64_tr_b16 v[98:99], v122 offset:32352
  s_waitcnt lgkmcnt(6)
  v_mfma_f32_16x16x32_bf16 v[0:3], v[108:111], v[72:75], v[0:3]
  ds_read_b64_tr_b16 v[100:101], v122 offset:27776
  v_mfma_f32_16x16x32_bf16 v[4:7], v[108:111], v[76:79], v[4:7]
  ds_read_b64_tr_b16 v[102:103], v122 offset:32384
  s_waitcnt lgkmcnt(6)
  v_mfma_f32_16x16x32_bf16 v[8:11], v[112:115], v[72:75], v[8:11]
  ds_read_b64_tr_b16 v[104:105], v122 offset:27808
  v_mfma_f32_16x16x32_bf16 v[12:15], v[112:115], v[76:79], v[12:15]
  ds_read_b64_tr_b16 v[106:107], v122 offset:32416
  s_waitcnt lgkmcnt(6)
  v_mfma_f32_16x16x32_bf16 v[16:19], v[116:119], v[72:75], v[16:19]
  ds_read_b64_tr_b16 v[108:109], v122 offset:27840
  v_mfma_f32_16x16x32_bf16 v[20:23], v[116:119], v[76:79], v[20:23]
  ds_read_b64_tr_b16 v[110:111], v122 offset:32448
  s_waitcnt lgkmcnt(6)
  v_mfma_f32_16x16x32_bf16 v[24:27], v[96:99], v[72:75], v[24:27]
  ds_read_b64_tr_b16 v[112:113], v122 offset:27872
  v_mfma_f32_16x16x32_bf16 v[28:31], v[96:99], v[76:79], v[28:31]
  ds_read_b64_tr_b16 v[114:115], v122 offset:32480
  s_waitcnt lgkmcnt(6)
  v_mfma_f32_16x16x32_bf16 v[32:35], v[100:103], v[72:75], v[32:35]
  ds_read_b64_tr_b16 v[116:117], v122 offset:27904
  v_mfma_f32_16x16x32_bf16 v[36:39], v[100:103], v[76:79], v[36:39]
  ds_read_b64_tr_b16 v[118:119], v122 offset:32512
  s_barrier
  ds_read_b128 v[80:83], v123 offset:0
  ds_read_b128 v[84:87], v123 offset:1024
  s_waitcnt lgkmcnt(8)
  v_mfma_f32_16x16x32_bf16 v[40:43], v[104:107], v[72:75], v[40:43]
  ds_read_b64_tr_b16 v[96:97], v121 offset:0
  v_mfma_f32_16x16x32_bf16 v[44:47], v[104:107], v[76:79], v[44:47]
  ds_read_b64_tr_b16 v[98:99], v121 offset:4608
  s_waitcnt lgkmcnt(8)
  v_mfma_f32_16x16x32_bf16 v[48:51], v[108:111], v[72:75], v[48:51]
  ds_read_b64_tr_b16 v[100:101], v121 offset:32
  v_mfma_f32_16x16x32_bf16 v[52:55], v[108:111], v[76:79], v[52:55]
  ds_read_b64_tr_b16 v[102:103], v121 offset:4640
  s_waitcnt lgkmcnt(8)
  v_mfma_f32_16x16x32_bf16 v[56:59], v[112:115], v[72:75], v[56:59]
  ds_read_b64_tr_b16 v[104:105], v121 offset:64
  v_mfma_f32_16x16x32_bf16 v[60:63], v[112:115], v[76:79], v[60:63]
  ds_read_b64_tr_b16 v[106:107], v121 offset:4672
  s_waitcnt lgkmcnt(8)
  v_mfma_f32_16x16x32_bf16 v[64:67], v[116:119], v[72:75], v[64:67]
  ds_read_b64_tr_b16 v[108:109], v121 offset:96
  v_mfma_f32_16x16x32_bf16 v[68:71], v[116:119], v[76:79], v[68:71]
  ds_read_b64_tr_b16 v[110:111], v121 offset:4704
  s_waitcnt lgkmcnt(6)
  v_mfma_f32_16x16x32_bf16 v[0:3], v[96:99], v[80:83], v[0:3]
  ds_read_b64_tr_b16 v[112:113], v121 offset:128
  v_mfma_f32_16x16x32_bf16 v[4:7], v[96:99], v[84:87], v[4:7]
  ds_read_b64_tr_b16 v[114:115], v121 offset:4736
  s_waitcnt lgkmcnt(6)
  v_mfma_f32_16x16x32_bf16 v[8:11], v[100:103], v[80:83], v[8:11]
  ds_read_b64_tr_b16 v[116:117], v121 offset:160
  v_mfma_f32_16x16x32_bf16 v[12:15], v[100:103], v[84:87], v[12:15]
  ds_read_b64_tr_b16 v[118:119], v121 offset:4768
  s_waitcnt lgkmcnt(6)
  v_mfma_f32_16x16x32_bf16 v[16:19], v[104:107], v[80:83], v[16:19]
  ds_read_b64_tr_b16 v[96:97], v121 offset:192
  v_mfma_f32_16x16x32_bf16 v[20:23], v[104:107], v[84:87], v[20:23]
  ds_read_b64_tr_b16 v[98:99], v121 offset:4800
  s_waitcnt lgkmcnt(6)
  v_mfma_f32_16x16x32_bf16 v[24:27], v[108:111], v[80:83], v[24:27]
  ds_read_b64_tr_b16 v[100:101], v121 offset:224
  v_mfma_f32_16x16x32_bf16 v[28:31], v[108:111], v[84:87], v[28:31]
  ds_read_b64_tr_b16 v[102:103], v121 offset:4832
  s_waitcnt lgkmcnt(6)
  v_mfma_f32_16x16x32_bf16 v[32:35], v[112:115], v[80:83], v[32:35]
  ds_read_b64_tr_b16 v[104:105], v121 offset:256
  v_mfma_f32_16x16x32_bf16 v[36:39], v[112:115], v[84:87], v[36:39]
  ds_read_b64_tr_b16 v[106:107], v121 offset:4864
  s_barrier
  ds_read_b128 v[88:91], v123 offset:8192
  ds_read_b128 v[92:95], v123 offset:9216
  s_waitcnt lgkmcnt(8)
  v_mfma_f32_16x16x32_bf16 v[40:43], v[116:119], v[80:83], v[40:43]
  ds_read_b64_tr_b16 v[108:109], v121 offset:9216
  v_mfma_f32_16x16x32_bf16 v[44:47], v[116:119], v[84:87], v[44:47]
  ds_read_b64_tr_b16 v[110:111], v121 offset:13824
  s_waitcnt lgkmcnt(8)
  v_mfma_f32_16x16x32_bf16 v[48:51], v[96:99], v[80:83], v[48:51]
  ds_read_b64_tr_b16 v[112:113], v121 offset:9248
  v_mfma_f32_16x16x32_bf16 v[52:55], v[96:99], v[84:87], v[52:55]
  ds_read_b64_tr_b16 v[114:115], v121 offset:13856
  s_waitcnt lgkmcnt(8)
  v_mfma_f32_16x16x32_bf16 v[56:59], v[100:103], v[80:83], v[56:59]
  ds_read_b64_tr_b16 v[116:117], v121 offset:9280
  v_mfma_f32_16x16x32_bf16 v[60:63], v[100:103], v[84:87], v[60:63]
  ds_read_b64_tr_b16 v[118:119], v121 offset:13888
  s_waitcnt lgkmcnt(8)
  v_mfma_f32_16x16x32_bf16 v[64:67], v[104:107], v[80:83], v[64:67]
  ds_read_b64_tr_b16 v[96:97], v121 offset:9312
  v_mfma_f32_16x16x32_bf16 v[68:71], v[104:107], v[84:87], v[68:71]
  ds_read_b64_tr_b16 v[98:99], v121 offset:13920
  s_waitcnt lgkmcnt(6)
  v_mfma_f32_16x16x32_bf16 v[0:3], v[108:111], v[88:91], v[0:3]
  ds_read_b64_tr_b16 v[100:101], v121 offset:9344
  v_mfma_f32_16x16x32_bf16 v[4:7], v[108:111], v[92:95], v[4:7]
  ds_read_b64_tr_b16 v[102:103], v121 offset:13952
  s_waitcnt lgkmcnt(6)
  v_mfma_f32_16x16x32_bf16 v[8:11], v[112:115], v[88:91], v[8:11]
  ds_read_b64_tr_b16 v[104:105], v121 offset:9376
  v_mfma_f32_16x16x32_bf16 v[12:15], v[112:115], v[92:95], v[12:15]
  ds_read_b64_tr_b16 v[106:107], v121 offset:13984
  s_waitcnt lgkmcnt(6)
  v_mfma_f32_16x16x32_bf16 v[16:19], v[116:119], v[88:91], v[16:19]
  ds_read_b64_tr_b16 v[108:109], v121 offset:9408
  v_mfma_f32_16x16x32_bf16 v[20:23], v[116:119], v[92:95], v[20:23]
  ds_read_b64_tr_b16 v[110:111], v121 offset:14016
  s_waitcnt lgkmcnt(6)
  v_mfma_f32_16x16x32_bf16 v[24:27], v[96:99], v[88:91], v[24:27]
  ds_read_b64_tr_b16 v[112:113], v121 offset:9440
  v_mfma_f32_16x16x32_bf16 v[28:31], v[96:99], v[92:95], v[28:31]
  ds_read_b64_tr_b16 v[114:115], v121 offset:14048
  s_waitcnt lgkmcnt(6)
  v_mfma_f32_16x16x32_bf16 v[32:35], v[100:103], v[88:91], v[32:35]
  ds_read_b64_tr_b16 v[116:117], v121 offset:9472
  v_mfma_f32_16x16x32_bf16 v[36:39], v[100:103], v[92:95], v[36:39]
  ds_read_b64_tr_b16 v[118:119], v121 offset:14080
  s_barrier
  ds_read_b128 v[72:75], v123 offset:16384
  ds_read_b128 v[76:79], v123 offset:17408
  s_waitcnt lgkmcnt(8)
  v_mfma_f32_16x16x32_bf16 v[40:43], v[104:107], v[88:91], v[40:43]
  ds_read_b64_tr_b16 v[96:97], v121 offset:18432
  v_mfma_f32_16x16x32_bf16 v[44:47], v[104:107], v[92:95], v[44:47]
  ds_read_b64_tr_b16 v[98:99], v121 offset:23040
  s_waitcnt lgkmcnt(8)
  v_mfma_f32_16x16x32_bf16 v[48:51], v[108:111], v[88:91], v[48:51]
  ds_read_b64_tr_b16 v[100:101], v121 offset:18464
  v_mfma_f32_16x16x32_bf16 v[52:55], v[108:111], v[92:95], v[52:55]
  ds_read_b64_tr_b16 v[102:103], v121 offset:23072
  s_waitcnt lgkmcnt(8)
  v_mfma_f32_16x16x32_bf16 v[56:59], v[112:115], v[88:91], v[56:59]
  ds_read_b64_tr_b16 v[104:105], v121 offset:18496
  v_mfma_f32_16x16x32_bf16 v[60:63], v[112:115], v[92:95], v[60:63]
  ds_read_b64_tr_b16 v[106:107], v121 offset:23104
  s_waitcnt lgkmcnt(8)
  v_mfma_f32_16x16x32_bf16 v[64:67], v[116:119], v[88:91], v[64:67]
  ds_read_b64_tr_b16 v[108:109], v121 offset:18528
  v_mfma_f32_16x16x32_bf16 v[68:71], v[116:119], v[92:95], v[68:71]
  ds_read_b64_tr_b16 v[110:111], v121 offset:23136
  s_waitcnt lgkmcnt(6)
  v_mfma_f32_16x16x32_bf16 v[0:3], v[96:99], v[72:75], v[0:3]
  ds_read_b64_tr_b16 v[112:113], v121 offset:18560
  v_mfma_f32_16x16x32_bf16 v[4:7], v[96:99], v[76:79], v[4:7]
  ds_read_b64_tr_b16 v[114:115], v121 offset:23168
  s_waitcnt lgkmcnt(6)
  v_mfma_f32_16x16x32_bf16 v[8:11], v[100:103], v[72:75], v[8:11]
  ds_read_b64_tr_b16 v[116:117], v121 offset:18592
  v_mfma_f32_16x16x32_bf16 v[12:15], v[100:103], v[76:79], v[12:15]
  ds_read_b64_tr_b16 v[118:119], v121 offset:23200
  s_waitcnt lgkmcnt(6)
  v_mfma_f32_16x16x32_bf16 v[16:19], v[104:107], v[72:75], v[16:19]
  ds_read_b64_tr_b16 v[96:97], v121 offset:18624
  v_mfma_f32_16x16x32_bf16 v[20:23], v[104:107], v[76:79], v[20:23]
  ds_read_b64_tr_b16 v[98:99], v121 offset:23232
  s_waitcnt lgkmcnt(6)
  v_mfma_f32_16x16x32_bf16 v[24:27], v[108:111], v[72:75], v[24:27]
  ds_read_b64_tr_b16 v[100:101], v121 offset:18656
  v_mfma_f32_16x16x32_bf16 v[28:31], v[108:111], v[76:79], v[28:31]
  ds_read_b64_tr_b16 v[102:103], v121 offset:23264
  s_waitcnt lgkmcnt(6)
  v_mfma_f32_16x16x32_bf16 v[32:35], v[112:115], v[72:75], v[32:35]
  ds_read_b64_tr_b16 v[104:105], v121 offset:18688
  v_mfma_f32_16x16x32_bf16 v[36:39], v[112:115], v[76:79], v[36:39]
  ds_read_b64_tr_b16 v[106:107], v121 offset:23296
  s_barrier
  ds_read_b128 v[80:83], v123 offset:24576
  ds_read_b128 v[84:87], v123 offset:25600
  s_waitcnt lgkmcnt(8)
  v_mfma_f32_16x16x32_bf16 v[40:43], v[116:119], v[72:75], v[40:43]
  ds_read_b64_tr_b16 v[108:109], v121 offset:27648
  v_mfma_f32_16x16x32_bf16 v[44:47], v[116:119], v[76:79], v[44:47]
  ds_read_b64_tr_b16 v[110:111], v121 offset:32256
  s_waitcnt lgkmcnt(8)
  v_mfma_f32_16x16x32_bf16 v[48:51], v[96:99], v[72:75], v[48:51]
  ds_read_b64_tr_b16 v[112:113], v121 offset:27680
  v_mfma_f32_16x16x32_bf16 v[52:55], v[96:99], v[76:79], v[52:55]
  ds_read_b64_tr_b16 v[114:115], v121 offset:32288
  s_waitcnt lgkmcnt(8)
  v_mfma_f32_16x16x32_bf16 v[56:59], v[100:103], v[72:75], v[56:59]
  ds_read_b64_tr_b16 v[116:117], v121 offset:27712
  v_mfma_f32_16x16x32_bf16 v[60:63], v[100:103], v[76:79], v[60:63]
  ds_read_b64_tr_b16 v[118:119], v121 offset:32320
  s_waitcnt lgkmcnt(8)
  v_mfma_f32_16x16x32_bf16 v[64:67], v[104:107], v[72:75], v[64:67]
  ds_read_b64_tr_b16 v[96:97], v121 offset:27744
  v_mfma_f32_16x16x32_bf16 v[68:71], v[104:107], v[76:79], v[68:71]
  ds_read_b64_tr_b16 v[98:99], v121 offset:32352
  s_waitcnt lgkmcnt(6)
  v_mfma_f32_16x16x32_bf16 v[0:3], v[108:111], v[80:83], v[0:3]
  ds_read_b64_tr_b16 v[100:101], v121 offset:27776
  v_mfma_f32_16x16x32_bf16 v[4:7], v[108:111], v[84:87], v[4:7]
  ds_read_b64_tr_b16 v[102:103], v121 offset:32384
  s_waitcnt lgkmcnt(6)
  v_mfma_f32_16x16x32_bf16 v[8:11], v[112:115], v[80:83], v[8:11]
  ds_read_b64_tr_b16 v[104:105], v121 offset:27808
  v_mfma_f32_16x16x32_bf16 v[12:15], v[112:115], v[84:87], v[12:15]
  ds_read_b64_tr_b16 v[106:107], v121 offset:32416
  s_waitcnt lgkmcnt(6)
  v_mfma_f32_16x16x32_bf16 v[16:19], v[116:119], v[80:83], v[16:19]
  ds_read_b64_tr_b16 v[108:109], v121 offset:27840
  v_mfma_f32_16x16x32_bf16 v[20:23], v[116:119], v[84:87], v[20:23]
  ds_read_b64_tr_b16 v[110:111], v121 offset:32448
  s_waitcnt lgkmcnt(6)
  v_mfma_f32_16x16x32_bf16 v[24:27], v[96:99], v[80:83], v[24:27]
  ds_read_b64_tr_b16 v[112:113], v121 offset:27872
  v_mfma_f32_16x16x32_bf16 v[28:31], v[96:99], v[84:87], v[28:31]
  ds_read_b64_tr_b16 v[114:115], v121 offset:32480
  s_waitcnt lgkmcnt(6)
  v_mfma_f32_16x16x32_bf16 v[32:35], v[100:103], v[80:83], v[32:35]
  ds_read_b64_tr_b16 v[116:117], v121 offset:27904
  v_mfma_f32_16x16x32_bf16 v[36:39], v[100:103], v[84:87], v[36:39]
  ds_read_b64_tr_b16 v[118:119], v121 offset:32512
  s_barrier
  ds_read_b128 v[88:91], v123 offset:32768
  ds_read_b128 v[92:95], v123 offset:33792
  s_waitcnt lgkmcnt(8)
  v_mfma_f32_16x16x32_bf16 v[40:43], v[104:107], v[80:83], v[40:43]
  ds_read_b64_tr_b16 v[96:97], v122 offset:0
  v_mfma_f32_16x16x32_bf16 v[44:47], v[104:107], v[84:87], v[44:47]
  ds_read_b64_tr_b16 v[98:99], v122 offset:4608
  s_waitcnt lgkmcnt(8)
  v_mfma_f32_16x16x32_bf16 v[48:51], v[108:111], v[80:83], v[48:51]
  ds_read_b64_tr_b16 v[100:101], v122 offset:32
  v_mfma_f32_16x16x32_bf16 v[52:55], v[108:111], v[84:87], v[52:55]
  ds_read_b64_tr_b16 v[102:103], v122 offset:4640
  s_waitcnt lgkmcnt(8)
  v_mfma_f32_16x16x32_bf16 v[56:59], v[112:115], v[80:83], v[56:59]
  ds_read_b64_tr_b16 v[104:105], v122 offset:64
  v_mfma_f32_16x16x32_bf16 v[60:63], v[112:115], v[84:87], v[60:63]
  ds_read_b64_tr_b16 v[106:107], v122 offset:4672
  s_waitcnt lgkmcnt(8)
  v_mfma_f32_16x16x32_bf16 v[64:67], v[116:119], v[80:83], v[64:67]
  ds_read_b64_tr_b16 v[108:109], v122 offset:96
  v_mfma_f32_16x16x32_bf16 v[68:71], v[116:119], v[84:87], v[68:71]
  ds_read_b64_tr_b16 v[110:111], v122 offset:4704
  s_waitcnt lgkmcnt(6)
  v_mfma_f32_16x16x32_bf16 v[0:3], v[96:99], v[88:91], v[0:3]
  ds_read_b64_tr_b16 v[112:113], v122 offset:128
  v_mfma_f32_16x16x32_bf16 v[4:7], v[96:99], v[92:95], v[4:7]
  ds_read_b64_tr_b16 v[114:115], v122 offset:4736
  s_waitcnt lgkmcnt(6)
  v_mfma_f32_16x16x32_bf16 v[8:11], v[100:103], v[88:91], v[8:11]
  ds_read_b64_tr_b16 v[116:117], v122 offset:160
  v_mfma_f32_16x16x32_bf16 v[12:15], v[100:103], v[92:95], v[12:15]
  ds_read_b64_tr_b16 v[118:119], v122 offset:4768
  s_waitcnt lgkmcnt(6)
  v_mfma_f32_16x16x32_bf16 v[16:19], v[104:107], v[88:91], v[16:19]
  ds_read_b64_tr_b16 v[96:97], v122 offset:192
  v_mfma_f32_16x16x32_bf16 v[20:23], v[104:107], v[92:95], v[20:23]
  ds_read_b64_tr_b16 v[98:99], v122 offset:4800
  s_waitcnt lgkmcnt(6)
  v_mfma_f32_16x16x32_bf16 v[24:27], v[108:111], v[88:91], v[24:27]
  ds_read_b64_tr_b16 v[100:101], v122 offset:224
  v_mfma_f32_16x16x32_bf16 v[28:31], v[108:111], v[92:95], v[28:31]
  ds_read_b64_tr_b16 v[102:103], v122 offset:4832
  s_waitcnt lgkmcnt(6)
  v_mfma_f32_16x16x32_bf16 v[32:35], v[112:115], v[88:91], v[32:35]
  ds_read_b64_tr_b16 v[104:105], v122 offset:256
  v_mfma_f32_16x16x32_bf16 v[36:39], v[112:115], v[92:95], v[36:39]
  ds_read_b64_tr_b16 v[106:107], v122 offset:4864
  s_barrier
  ds_read_b128 v[72:75], v123 offset:40960
  ds_read_b128 v[76:79], v123 offset:41984
  s_waitcnt lgkmcnt(8)
  v_mfma_f32_16x16x32_bf16 v[40:43], v[116:119], v[88:91], v[40:43]
  ds_read_b64_tr_b16 v[108:109], v122 offset:9216
  v_mfma_f32_16x16x32_bf16 v[44:47], v[116:119], v[92:95], v[44:47]
  ds_read_b64_tr_b16 v[110:111], v122 offset:13824
  s_waitcnt lgkmcnt(8)
  v_mfma_f32_16x16x32_bf16 v[48:51], v[96:99], v[88:91], v[48:51]
  ds_read_b64_tr_b16 v[112:113], v122 offset:9248
  v_mfma_f32_16x16x32_bf16 v[52:55], v[96:99], v[92:95], v[52:55]
  ds_read_b64_tr_b16 v[114:115], v122 offset:13856
  s_waitcnt lgkmcnt(8)
  v_mfma_f32_16x16x32_bf16 v[56:59], v[100:103], v[88:91], v[56:59]
  ds_read_b64_tr_b16 v[116:117], v122 offset:9280
  v_mfma_f32_16x16x32_bf16 v[60:63], v[100:103], v[92:95], v[60:63]
  ds_read_b64_tr_b16 v[118:119], v122 offset:13888
  s_waitcnt lgkmcnt(8)
  v_mfma_f32_16x16x32_bf16 v[64:67], v[104:107], v[88:91], v[64:67]
  ds_read_b64_tr_b16 v[96:97], v122 offset:9312
  v_mfma_f32_16x16x32_bf16 v[68:71], v[104:107], v[92:95], v[68:71]
  ds_read_b64_tr_b16 v[98:99], v122 offset:13920
  s_waitcnt lgkmcnt(6)
  v_mfma_f32_16x16x32_bf16 v[0:3], v[108:111], v[72:75], v[0:3]
  ds_read_b64_tr_b16 v[100:101], v122 offset:9344
  v_mfma_f32_16x16x32_bf16 v[4:7], v[108:111], v[76:79], v[4:7]
  ds_read_b64_tr_b16 v[102:103], v122 offset:13952
  s_waitcnt lgkmcnt(6)
  v_mfma_f32_16x16x32_bf16 v[8:11], v[112:115], v[72:75], v[8:11]
  ds_read_b64_tr_b16 v[104:105], v122 offset:9376
  v_mfma_f32_16x16x32_bf16 v[12:15], v[112:115], v[76:79], v[12:15]
  ds_read_b64_tr_b16 v[106:107], v122 offset:13984
  s_waitcnt lgkmcnt(6)
  v_mfma_f32_16x16x32_bf16 v[16:19], v[116:119], v[72:75], v[16:19]
  ds_read_b64_tr_b16 v[108:109], v122 offset:9408
  v_mfma_f32_16x16x32_bf16 v[20:23], v[116:119], v[76:79], v[20:23]
  ds_read_b64_tr_b16 v[110:111], v122 offset:14016
  s_waitcnt lgkmcnt(6)
  v_mfma_f32_16x16x32_bf16 v[24:27], v[96:99], v[72:75], v[24:27]
  ds_read_b64_tr_b16 v[112:113], v122 offset:9440
  v_mfma_f32_16x16x32_bf16 v[28:31], v[96:99], v[76:79], v[28:31]
  ds_read_b64_tr_b16 v[114:115], v122 offset:14048
  s_waitcnt lgkmcnt(6)
  v_mfma_f32_16x16x32_bf16 v[32:35], v[100:103], v[72:75], v[32:35]
  ds_read_b64_tr_b16 v[116:117], v122 offset:9472
  v_mfma_f32_16x16x32_bf16 v[36:39], v[100:103], v[76:79], v[36:39]
  ds_read_b64_tr_b16 v[118:119], v122 offset:14080
  s_barrier
  ds_read2st64_b64 v[80:83], v125 offset0:96 offset1:97
  ds_read2st64_b64 v[84:87], v125 offset0:98 offset1:99
  s_waitcnt lgkmcnt(8)
  v_mfma_f32_16x16x32_bf16 v[40:43], v[104:107], v[72:75], v[40:43]
  ds_read_b64_tr_b16 v[96:97], v122 offset:18432
  v_mfma_f32_16x16x32_bf16 v[44:47], v[104:107], v[76:79], v[44:47]
  ds_read_b64_tr_b16 v[98:99], v122 offset:23040
  s_waitcnt lgkmcnt(8)
  v_mfma_f32_16x16x32_bf16 v[48:51], v[108:111], v[72:75], v[48:51]
  ds_read_b64_tr_b16 v[100:101], v122 offset:18464
  v_mfma_f32_16x16x32_bf16 v[52:55], v[108:111], v[76:79], v[52:55]
  ds_read_b64_tr_b16 v[102:103], v122 offset:23072
  s_waitcnt lgkmcnt(8)
  v_mfma_f32_16x16x32_bf16 v[56:59], v[112:115], v[72:75], v[56:59]
  ds_read_b64_tr_b16 v[104:105], v122 offset:18496
  v_mfma_f32_16x16x32_bf16 v[60:63], v[112:115], v[76:79], v[60:63]
  ds_read_b64_tr_b16 v[106:107], v122 offset:23104
  s_waitcnt lgkmcnt(8)
  v_mfma_f32_16x16x32_bf16 v[64:67], v[116:119], v[72:75], v[64:67]
  ds_read_b64_tr_b16 v[108:109], v122 offset:18528
  v_mfma_f32_16x16x32_bf16 v[68:71], v[116:119], v[76:79], v[68:71]
  ds_read_b64_tr_b16 v[110:111], v122 offset:23136
  s_waitcnt lgkmcnt(6)
  v_mfma_f32_16x16x32_bf16 v[0:3], v[96:99], v[80:83], v[0:3]
  ds_read_b64_tr_b16 v[112:113], v122 offset:18560
  v_mfma_f32_16x16x32_bf16 v[4:7], v[96:99], v[84:87], v[4:7]
  ds_read_b64_tr_b16 v[114:115], v122 offset:23168
  s_waitcnt lgkmcnt(6)
  v_mfma_f32_16x16x32_bf16 v[8:11], v[100:103], v[80:83], v[8:11]
  ds_read_b64_tr_b16 v[116:117], v122 offset:18592
  v_mfma_f32_16x16x32_bf16 v[12:15], v[100:103], v[84:87], v[12:15]
  ds_read_b64_tr_b16 v[118:119], v122 offset:23200
  s_waitcnt lgkmcnt(6)
  v_mfma_f32_16x16x32_bf16 v[16:19], v[104:107], v[80:83], v[16:19]
  ds_read_b64_tr_b16 v[96:97], v122 offset:18624
  v_mfma_f32_16x16x32_bf16 v[20:23], v[104:107], v[84:87], v[20:23]
  ds_read_b64_tr_b16 v[98:99], v122 offset:23232
  s_waitcnt lgkmcnt(6)
  v_mfma_f32_16x16x32_bf16 v[24:27], v[108:111], v[80:83], v[24:27]
  ds_read_b64_tr_b16 v[100:101], v122 offset:18656
  v_mfma_f32_16x16x32_bf16 v[28:31], v[108:111], v[84:87], v[28:31]
  ds_read_b64_tr_b16 v[102:103], v122 offset:23264
  s_waitcnt lgkmcnt(6)
  v_mfma_f32_16x16x32_bf16 v[32:35], v[112:115], v[80:83], v[32:35]
  ds_read_b64_tr_b16 v[104:105], v122 offset:18688
  v_mfma_f32_16x16x32_bf16 v[36:39], v[112:115], v[84:87], v[36:39]
  ds_read_b64_tr_b16 v[106:107], v122 offset:23296
  s_barrier
  ds_read_b128 v[88:91], v123 offset:57344
  ds_read_b128 v[92:95], v123 offset:58368
  s_waitcnt lgkmcnt(8)
  v_mfma_f32_16x16x32_bf16 v[40:43], v[116:119], v[80:83], v[40:43]
  ds_read_b64_tr_b16 v[108:109], v122 offset:27648
  v_mfma_f32_16x16x32_bf16 v[44:47], v[116:119], v[84:87], v[44:47]
  ds_read_b64_tr_b16 v[110:111], v122 offset:32256
  s_waitcnt lgkmcnt(8)
  v_mfma_f32_16x16x32_bf16 v[48:51], v[96:99], v[80:83], v[48:51]
  ds_read_b64_tr_b16 v[112:113], v122 offset:27680
  v_mfma_f32_16x16x32_bf16 v[52:55], v[96:99], v[84:87], v[52:55]
  ds_read_b64_tr_b16 v[114:115], v122 offset:32288
  s_waitcnt lgkmcnt(8)
  v_mfma_f32_16x16x32_bf16 v[56:59], v[100:103], v[80:83], v[56:59]
  ds_read_b64_tr_b16 v[116:117], v122 offset:27712
  v_mfma_f32_16x16x32_bf16 v[60:63], v[100:103], v[84:87], v[60:63]
  ds_read_b64_tr_b16 v[118:119], v122 offset:32320
  s_waitcnt lgkmcnt(8)
  v_mfma_f32_16x16x32_bf16 v[64:67], v[104:107], v[80:83], v[64:67]
  ds_read_b64_tr_b16 v[96:97], v122 offset:27744
  v_mfma_f32_16x16x32_bf16 v[68:71], v[104:107], v[84:87], v[68:71]
  ds_read_b64_tr_b16 v[98:99], v122 offset:32352
  s_waitcnt lgkmcnt(6)
  v_mfma_f32_16x16x32_bf16 v[0:3], v[108:111], v[88:91], v[0:3]
  ds_read_b64_tr_b16 v[100:101], v122 offset:27776
  v_mfma_f32_16x16x32_bf16 v[4:7], v[108:111], v[92:95], v[4:7]
  ds_read_b64_tr_b16 v[102:103], v122 offset:32384
  s_waitcnt lgkmcnt(6)
  v_mfma_f32_16x16x32_bf16 v[8:11], v[112:115], v[88:91], v[8:11]
  ds_read_b64_tr_b16 v[104:105], v122 offset:27808
  v_mfma_f32_16x16x32_bf16 v[12:15], v[112:115], v[92:95], v[12:15]
  ds_read_b64_tr_b16 v[106:107], v122 offset:32416
  s_waitcnt lgkmcnt(6)
  v_mfma_f32_16x16x32_bf16 v[16:19], v[116:119], v[88:91], v[16:19]
  ds_read_b64_tr_b16 v[108:109], v122 offset:27840
  v_mfma_f32_16x16x32_bf16 v[20:23], v[116:119], v[92:95], v[20:23]
  ds_read_b64_tr_b16 v[110:111], v122 offset:32448
  s_waitcnt lgkmcnt(6)
  v_mfma_f32_16x16x32_bf16 v[24:27], v[96:99], v[88:91], v[24:27]
  ds_read_b64_tr_b16 v[112:113], v122 offset:27872
  v_mfma_f32_16x16x32_bf16 v[28:31], v[96:99], v[92:95], v[28:31]
  ds_read_b64_tr_b16 v[114:115], v122 offset:32480
  s_waitcnt lgkmcnt(6)
  v_mfma_f32_16x16x32_bf16 v[32:35], v[100:103], v[88:91], v[32:35]
  ds_read_b64_tr_b16 v[116:117], v122 offset:27904
  v_mfma_f32_16x16x32_bf16 v[36:39], v[100:103], v[92:95], v[36:39]
  ds_read_b64_tr_b16 v[118:119], v122 offset:32512
  s_barrier
  ds_read_b128 v[72:75], v123 offset:0
  ds_read_b128 v[76:79], v123 offset:1024
  s_waitcnt lgkmcnt(8)
  v_mfma_f32_16x16x32_bf16 v[40:43], v[104:107], v[88:91], v[40:43]
  ds_read_b64_tr_b16 v[96:97], v121 offset:0
  v_mfma_f32_16x16x32_bf16 v[44:47], v[104:107], v[92:95], v[44:47]
  ds_read_b64_tr_b16 v[98:99], v121 offset:4608
  s_waitcnt lgkmcnt(8)
  v_mfma_f32_16x16x32_bf16 v[48:51], v[108:111], v[88:91], v[48:51]
  ds_read_b64_tr_b16 v[100:101], v121 offset:32
  v_mfma_f32_16x16x32_bf16 v[52:55], v[108:111], v[92:95], v[52:55]
  ds_read_b64_tr_b16 v[102:103], v121 offset:4640
  s_waitcnt lgkmcnt(8)
  v_mfma_f32_16x16x32_bf16 v[56:59], v[112:115], v[88:91], v[56:59]
  ds_read_b64_tr_b16 v[104:105], v121 offset:64
  v_mfma_f32_16x16x32_bf16 v[60:63], v[112:115], v[92:95], v[60:63]
  ds_read_b64_tr_b16 v[106:107], v121 offset:4672
  s_waitcnt lgkmcnt(8)
  v_mfma_f32_16x16x32_bf16 v[64:67], v[116:119], v[88:91], v[64:67]
  ds_read_b64_tr_b16 v[108:109], v121 offset:96
  v_mfma_f32_16x16x32_bf16 v[68:71], v[116:119], v[92:95], v[68:71]
  ds_read_b64_tr_b16 v[110:111], v121 offset:4704
  s_waitcnt lgkmcnt(6)
  v_mfma_f32_16x16x32_bf16 v[0:3], v[96:99], v[72:75], v[0:3]
  ds_read_b64_tr_b16 v[112:113], v121 offset:128
  v_mfma_f32_16x16x32_bf16 v[4:7], v[96:99], v[76:79], v[4:7]
  ds_read_b64_tr_b16 v[114:115], v121 offset:4736
  s_waitcnt lgkmcnt(6)
  v_mfma_f32_16x16x32_bf16 v[8:11], v[100:103], v[72:75], v[8:11]
  ds_read_b64_tr_b16 v[116:117], v121 offset:160
  v_mfma_f32_16x16x32_bf16 v[12:15], v[100:103], v[76:79], v[12:15]
  ds_read_b64_tr_b16 v[118:119], v121 offset:4768
  s_waitcnt lgkmcnt(6)
  v_mfma_f32_16x16x32_bf16 v[16:19], v[104:107], v[72:75], v[16:19]
  ds_read_b64_tr_b16 v[96:97], v121 offset:192
  v_mfma_f32_16x16x32_bf16 v[20:23], v[104:107], v[76:79], v[20:23]
  ds_read_b64_tr_b16 v[98:99], v121 offset:4800
  s_waitcnt lgkmcnt(6)
  v_mfma_f32_16x16x32_bf16 v[24:27], v[108:111], v[72:75], v[24:27]
  ds_read_b64_tr_b16 v[100:101], v121 offset:224
  v_mfma_f32_16x16x32_bf16 v[28:31], v[108:111], v[76:79], v[28:31]
  ds_read_b64_tr_b16 v[102:103], v121 offset:4832
  s_waitcnt lgkmcnt(6)
  v_mfma_f32_16x16x32_bf16 v[32:35], v[112:115], v[72:75], v[32:35]
  ds_read_b64_tr_b16 v[104:105], v121 offset:256
  v_mfma_f32_16x16x32_bf16 v[36:39], v[112:115], v[76:79], v[36:39]
  ds_read_b64_tr_b16 v[106:107], v121 offset:4864
  s_barrier
  ds_read_b128 v[80:83], v123 offset:8192
  ds_read_b128 v[84:87], v123 offset:9216
  s_waitcnt lgkmcnt(8)
  v_mfma_f32_16x16x32_bf16 v[40:43], v[116:119], v[72:75], v[40:43]
  ds_read_b64_tr_b16 v[108:109], v121 offset:9216
  v_mfma_f32_16x16x32_bf16 v[44:47], v[116:119], v[76:79], v[44:47]
  ds_read_b64_tr_b16 v[110:111], v121 offset:13824
  s_waitcnt lgkmcnt(8)
  v_mfma_f32_16x16x32_bf16 v[48:51], v[96:99], v[72:75], v[48:51]
  ds_read_b64_tr_b16 v[112:113], v121 offset:9248
  v_mfma_f32_16x16x32_bf16 v[52:55], v[96:99], v[76:79], v[52:55]
  ds_read_b64_tr_b16 v[114:115], v121 offset:13856
  s_waitcnt lgkmcnt(8)
  v_mfma_f32_16x16x32_bf16 v[56:59], v[100:103], v[72:75], v[56:59]
  ds_read_b64_tr_b16 v[116:117], v121 offset:9280
  v_mfma_f32_16x16x32_bf16 v[60:63], v[100:103], v[76:79], v[60:63]
  ds_read_b64_tr_b16 v[118:119], v121 offset:13888
  s_waitcnt lgkmcnt(8)
  v_mfma_f32_16x16x32_bf16 v[64:67], v[104:107], v[72:75], v[64:67]
  ds_read_b64_tr_b16 v[96:97], v121 offset:9312
  v_mfma_f32_16x16x32_bf16 v[68:71], v[104:107], v[76:79], v[68:71]
  ds_read_b64_tr_b16 v[98:99], v121 offset:13920
  s_waitcnt lgkmcnt(6)
  v_mfma_f32_16x16x32_bf16 v[0:3], v[108:111], v[80:83], v[0:3]
  ds_read_b64_tr_b16 v[100:101], v121 offset:9344
  v_mfma_f32_16x16x32_bf16 v[4:7], v[108:111], v[84:87], v[4:7]
  ds_read_b64_tr_b16 v[102:103], v121 offset:13952
  s_waitcnt lgkmcnt(6)
  v_mfma_f32_16x16x32_bf16 v[8:11], v[112:115], v[80:83], v[8:11]
  ds_read_b64_tr_b16 v[104:105], v121 offset:9376
  v_mfma_f32_16x16x32_bf16 v[12:15], v[112:115], v[84:87], v[12:15]
  ds_read_b64_tr_b16 v[106:107], v121 offset:13984
  s_waitcnt lgkmcnt(6)
  v_mfma_f32_16x16x32_bf16 v[16:19], v[116:119], v[80:83], v[16:19]
  ds_read_b64_tr_b16 v[108:109], v121 offset:9408
  v_mfma_f32_16x16x32_bf16 v[20:23], v[116:119], v[84:87], v[20:23]
  ds_read_b64_tr_b16 v[110:111], v121 offset:14016
  s_waitcnt lgkmcnt(6)
  v_mfma_f32_16x16x32_bf16 v[24:27], v[96:99], v[80:83], v[24:27]
  ds_read_b64_tr_b16 v[112:113], v121 offset:9440
  v_mfma_f32_16x16x32_bf16 v[28:31], v[96:99], v[84:87], v[28:31]
  ds_read_b64_tr_b16 v[114:115], v121 offset:14048
  s_waitcnt lgkmcnt(6)
  v_mfma_f32_16x16x32_bf16 v[32:35], v[100:103], v[80:83], v[32:35]
  ds_read_b64_tr_b16 v[116:117], v121 offset:9472
  v_mfma_f32_16x16x32_bf16 v[36:39], v[100:103], v[84:87], v[36:39]
  ds_read_b64_tr_b16 v[118:119], v121 offset:14080
  s_barrier
  ds_read_b128 v[88:91], v123 offset:16384
  ds_read_b128 v[92:95], v123 offset:17408
  s_waitcnt lgkmcnt(8)
  v_mfma_f32_16x16x32_bf16 v[40:43], v[104:107], v[80:83], v[40:43]
  ds_read_b64_tr_b16 v[96:97], v121 offset:18432
  v_mfma_f32_16x16x32_bf16 v[44:47], v[104:107], v[84:87], v[44:47]
  ds_read_b64_tr_b16 v[98:99], v121 offset:23040
  s_waitcnt lgkmcnt(8)
  v_mfma_f32_16x16x32_bf16 v[48:51], v[108:111], v[80:83], v[48:51]
  ds_read_b64_tr_b16 v[100:101], v121 offset:18464
  v_mfma_f32_16x16x32_bf16 v[52:55], v[108:111], v[84:87], v[52:55]
  ds_read_b64_tr_b16 v[102:103], v121 offset:23072
  s_waitcnt lgkmcnt(8)
  v_mfma_f32_16x16x32_bf16 v[56:59], v[112:115], v[80:83], v[56:59]
  ds_read_b64_tr_b16 v[104:105], v121 offset:18496
  v_mfma_f32_16x16x32_bf16 v[60:63], v[112:115], v[84:87], v[60:63]
  ds_read_b64_tr_b16 v[106:107], v121 offset:23104
  s_waitcnt lgkmcnt(8)
  v_mfma_f32_16x16x32_bf16 v[64:67], v[116:119], v[80:83], v[64:67]
  ds_read_b64_tr_b16 v[108:109], v121 offset:18528
  v_mfma_f32_16x16x32_bf16 v[68:71], v[116:119], v[84:87], v[68:71]
  ds_read_b64_tr_b16 v[110:111], v121 offset:23136
  s_waitcnt lgkmcnt(6)
  v_mfma_f32_16x16x32_bf16 v[0:3], v[96:99], v[88:91], v[0:3]
  ds_read_b64_tr_b16 v[112:113], v121 offset:18560
  v_mfma_f32_16x16x32_bf16 v[4:7], v[96:99], v[92:95], v[4:7]
  ds_read_b64_tr_b16 v[114:115], v121 offset:23168
  s_waitcnt lgkmcnt(6)
  v_mfma_f32_16x16x32_bf16 v[8:11], v[100:103], v[88:91], v[8:11]
  ds_read_b64_tr_b16 v[116:117], v121 offset:18592
  v_mfma_f32_16x16x32_bf16 v[12:15], v[100:103], v[92:95], v[12:15]
  ds_read_b64_tr_b16 v[118:119], v121 offset:23200
  s_waitcnt lgkmcnt(6)
  v_mfma_f32_16x16x32_bf16 v[16:19], v[104:107], v[88:91], v[16:19]
  ds_read_b64_tr_b16 v[96:97], v121 offset:18624
  v_mfma_f32_16x16x32_bf16 v[20:23], v[104:107], v[92:95], v[20:23]
  ds_read_b64_tr_b16 v[98:99], v121 offset:23232
  s_waitcnt lgkmcnt(6)
  v_mfma_f32_16x16x32_bf16 v[24:27], v[108:111], v[88:91], v[24:27]
  ds_read_b64_tr_b16 v[100:101], v121 offset:18656
  v_mfma_f32_16x16x32_bf16 v[28:31], v[108:111], v[92:95], v[28:31]
  ds_read_b64_tr_b16 v[102:103], v121 offset:23264
  s_waitcnt lgkmcnt(6)
  v_mfma_f32_16x16x32_bf16 v[32:35], v[112:115], v[88:91], v[32:35]
  ds_read_b64_tr_b16 v[104:105], v121 offset:18688
  v_mfma_f32_16x16x32_bf16 v[36:39], v[112:115], v[92:95], v[36:39]
  ds_read_b64_tr_b16 v[106:107], v121 offset:23296
  s_barrier
  ds_read_b128 v[72:75], v123 offset:24576
  ds_read_b128 v[76:79], v123 offset:25600
  s_waitcnt lgkmcnt(8)
  v_mfma_f32_16x16x32_bf16 v[40:43], v[116:119], v[88:91], v[40:43]
  ds_read_b64_tr_b16 v[108:109], v121 offset:27648
  v_mfma_f32_16x16x32_bf16 v[44:47], v[116:119], v[92:95], v[44:47]
  ds_read_b64_tr_b16 v[110:111], v121 offset:32256
  s_waitcnt lgkmcnt(8)
  v_mfma_f32_16x16x32_bf16 v[48:51], v[96:99], v[88:91], v[48:51]
  ds_read_b64_tr_b16 v[112:113], v121 offset:27680
  v_mfma_f32_16x16x32_bf16 v[52:55], v[96:99], v[92:95], v[52:55]
  ds_read_b64_tr_b16 v[114:115], v121 offset:32288
  s_waitcnt lgkmcnt(8)
  v_mfma_f32_16x16x32_bf16 v[56:59], v[100:103], v[88:91], v[56:59]
  ds_read_b64_tr_b16 v[116:117], v121 offset:27712
  v_mfma_f32_16x16x32_bf16 v[60:63], v[100:103], v[92:95], v[60:63]
  ds_read_b64_tr_b16 v[118:119], v121 offset:32320
  s_waitcnt lgkmcnt(8)
  v_mfma_f32_16x16x32_bf16 v[64:67], v[104:107], v[88:91], v[64:67]
  ds_read_b64_tr_b16 v[96:97], v121 offset:27744
  v_mfma_f32_16x16x32_bf16 v[68:71], v[104:107], v[92:95], v[68:71]
  ds_read_b64_tr_b16 v[98:99], v121 offset:32352
  s_waitcnt lgkmcnt(6)
  v_mfma_f32_16x16x32_bf16 v[0:3], v[108:111], v[72:75], v[0:3]
  ds_read_b64_tr_b16 v[100:101], v121 offset:27776
  v_mfma_f32_16x16x32_bf16 v[4:7], v[108:111], v[76:79], v[4:7]
  ds_read_b64_tr_b16 v[102:103], v121 offset:32384
  s_waitcnt lgkmcnt(6)
  v_mfma_f32_16x16x32_bf16 v[8:11], v[112:115], v[72:75], v[8:11]
  ds_read_b64_tr_b16 v[104:105], v121 offset:27808
  v_mfma_f32_16x16x32_bf16 v[12:15], v[112:115], v[76:79], v[12:15]
  ds_read_b64_tr_b16 v[106:107], v121 offset:32416
  s_waitcnt lgkmcnt(6)
  v_mfma_f32_16x16x32_bf16 v[16:19], v[116:119], v[72:75], v[16:19]
  ds_read_b64_tr_b16 v[108:109], v121 offset:27840
  v_mfma_f32_16x16x32_bf16 v[20:23], v[116:119], v[76:79], v[20:23]
  ds_read_b64_tr_b16 v[110:111], v121 offset:32448
  s_waitcnt lgkmcnt(6)
  v_mfma_f32_16x16x32_bf16 v[24:27], v[96:99], v[72:75], v[24:27]
  ds_read_b64_tr_b16 v[112:113], v121 offset:27872
  v_mfma_f32_16x16x32_bf16 v[28:31], v[96:99], v[76:79], v[28:31]
  ds_read_b64_tr_b16 v[114:115], v121 offset:32480
  s_waitcnt lgkmcnt(6)
  v_mfma_f32_16x16x32_bf16 v[32:35], v[100:103], v[72:75], v[32:35]
  ds_read_b64_tr_b16 v[116:117], v121 offset:27904
  v_mfma_f32_16x16x32_bf16 v[36:39], v[100:103], v[76:79], v[36:39]
  ds_read_b64_tr_b16 v[118:119], v121 offset:32512
  s_barrier
  ds_read_b128 v[80:83], v123 offset:32768
  ds_read_b128 v[84:87], v123 offset:33792
  s_waitcnt lgkmcnt(8)
  v_mfma_f32_16x16x32_bf16 v[40:43], v[104:107], v[72:75], v[40:43]
  ds_read_b64_tr_b16 v[96:97], v122 offset:0
  v_mfma_f32_16x16x32_bf16 v[44:47], v[104:107], v[76:79], v[44:47]
  ds_read_b64_tr_b16 v[98:99], v122 offset:4608
  s_waitcnt lgkmcnt(8)
  v_mfma_f32_16x16x32_bf16 v[48:51], v[108:111], v[72:75], v[48:51]
  ds_read_b64_tr_b16 v[100:101], v122 offset:32
  v_mfma_f32_16x16x32_bf16 v[52:55], v[108:111], v[76:79], v[52:55]
  ds_read_b64_tr_b16 v[102:103], v122 offset:4640
  s_waitcnt lgkmcnt(8)
  v_mfma_f32_16x16x32_bf16 v[56:59], v[112:115], v[72:75], v[56:59]
  ds_read_b64_tr_b16 v[104:105], v122 offset:64
  v_mfma_f32_16x16x32_bf16 v[60:63], v[112:115], v[76:79], v[60:63]
  ds_read_b64_tr_b16 v[106:107], v122 offset:4672
  s_waitcnt lgkmcnt(8)
  v_mfma_f32_16x16x32_bf16 v[64:67], v[116:119], v[72:75], v[64:67]
  ds_read_b64_tr_b16 v[108:109], v122 offset:96
  v_mfma_f32_16x16x32_bf16 v[68:71], v[116:119], v[76:79], v[68:71]
  ds_read_b64_tr_b16 v[110:111], v122 offset:4704
  s_waitcnt lgkmcnt(6)
  v_mfma_f32_16x16x32_bf16 v[0:3], v[96:99], v[80:83], v[0:3]
  ds_read_b64_tr_b16 v[112:113], v122 offset:128
  v_mfma_f32_16x16x32_bf16 v[4:7], v[96:99], v[84:87], v[4:7]
  ds_read_b64_tr_b16 v[114:115], v122 offset:4736
  s_waitcnt lgkmcnt(6)
  v_mfma_f32_16x16x32_bf16 v[8:11], v[100:103], v[80:83], v[8:11]
  ds_read_b64_tr_b16 v[116:117], v122 offset:160
  v_mfma_f32_16x16x32_bf16 v[12:15], v[100:103], v[84:87], v[12:15]
  ds_read_b64_tr_b16 v[118:119], v122 offset:4768
  s_waitcnt lgkmcnt(6)
  v_mfma_f32_16x16x32_bf16 v[16:19], v[104:107], v[80:83], v[16:19]
  ds_read_b64_tr_b16 v[96:97], v122 offset:192
  v_mfma_f32_16x16x32_bf16 v[20:23], v[104:107], v[84:87], v[20:23]
  ds_read_b64_tr_b16 v[98:99], v122 offset:4800
  s_waitcnt lgkmcnt(6)
  v_mfma_f32_16x16x32_bf16 v[24:27], v[108:111], v[80:83], v[24:27]
  ds_read_b64_tr_b16 v[100:101], v122 offset:224
  v_mfma_f32_16x16x32_bf16 v[28:31], v[108:111], v[84:87], v[28:31]
  ds_read_b64_tr_b16 v[102:103], v122 offset:4832
  s_waitcnt lgkmcnt(6)
  v_mfma_f32_16x16x32_bf16 v[32:35], v[112:115], v[80:83], v[32:35]
  ds_read_b64_tr_b16 v[104:105], v122 offset:256
  v_mfma_f32_16x16x32_bf16 v[36:39], v[112:115], v[84:87], v[36:39]
  ds_read_b64_tr_b16 v[106:107], v122 offset:4864
  s_barrier
  ds_read_b128 v[88:91], v123 offset:40960
  ds_read_b128 v[92:95], v123 offset:41984
  s_waitcnt lgkmcnt(8)
  v_mfma_f32_16x16x32_bf16 v[40:43], v[116:119], v[80:83], v[40:43]
  ds_read_b64_tr_b16 v[108:109], v122 offset:9216
  v_mfma_f32_16x16x32_bf16 v[44:47], v[116:119], v[84:87], v[44:47]
  ds_read_b64_tr_b16 v[110:111], v122 offset:13824
  s_waitcnt lgkmcnt(8)
  v_mfma_f32_16x16x32_bf16 v[48:51], v[96:99], v[80:83], v[48:51]
  ds_read_b64_tr_b16 v[112:113], v122 offset:9248
  v_mfma_f32_16x16x32_bf16 v[52:55], v[96:99], v[84:87], v[52:55]
  ds_read_b64_tr_b16 v[114:115], v122 offset:13856
  s_waitcnt lgkmcnt(8)
  v_mfma_f32_16x16x32_bf16 v[56:59], v[100:103], v[80:83], v[56:59]
  ds_read_b64_tr_b16 v[116:117], v122 offset:9280
  v_mfma_f32_16x16x32_bf16 v[60:63], v[100:103], v[84:87], v[60:63]
  ds_read_b64_tr_b16 v[118:119], v122 offset:13888
  s_waitcnt lgkmcnt(8)
  v_mfma_f32_16x16x32_bf16 v[64:67], v[104:107], v[80:83], v[64:67]
  ds_read_b64_tr_b16 v[96:97], v122 offset:9312
  v_mfma_f32_16x16x32_bf16 v[68:71], v[104:107], v[84:87], v[68:71]
  ds_read_b64_tr_b16 v[98:99], v122 offset:13920
  s_waitcnt lgkmcnt(6)
  v_mfma_f32_16x16x32_bf16 v[0:3], v[108:111], v[88:91], v[0:3]
  ds_read_b64_tr_b16 v[100:101], v122 offset:9344
  v_mfma_f32_16x16x32_bf16 v[4:7], v[108:111], v[92:95], v[4:7]
  ds_read_b64_tr_b16 v[102:103], v122 offset:13952
  s_waitcnt lgkmcnt(6)
  v_mfma_f32_16x16x32_bf16 v[8:11], v[112:115], v[88:91], v[8:11]
  ds_read_b64_tr_b16 v[104:105], v122 offset:9376
  v_mfma_f32_16x16x32_bf16 v[12:15], v[112:115], v[92:95], v[12:15]
  ds_read_b64_tr_b16 v[106:107], v122 offset:13984
  s_waitcnt lgkmcnt(6)
  v_mfma_f32_16x16x32_bf16 v[16:19], v[116:119], v[88:91], v[16:19]
  ds_read_b64_tr_b16 v[108:109], v122 offset:9408
  v_mfma_f32_16x16x32_bf16 v[20:23], v[116:119], v[92:95], v[20:23]
  ds_read_b64_tr_b16 v[110:111], v122 offset:14016
  s_waitcnt lgkmcnt(6)
  v_mfma_f32_16x16x32_bf16 v[24:27], v[96:99], v[88:91], v[24:27]
  ds_read_b64_tr_b16 v[112:113], v122 offset:9440
  v_mfma_f32_16x16x32_bf16 v[28:31], v[96:99], v[92:95], v[28:31]
  ds_read_b64_tr_b16 v[114:115], v122 offset:14048
  s_waitcnt lgkmcnt(6)
  v_mfma_f32_16x16x32_bf16 v[32:35], v[100:103], v[88:91], v[32:35]
  ds_read_b64_tr_b16 v[116:117], v122 offset:9472
  v_mfma_f32_16x16x32_bf16 v[36:39], v[100:103], v[92:95], v[36:39]
  ds_read_b64_tr_b16 v[118:119], v122 offset:14080
  s_barrier
  ds_read_b128 v[72:75], v123 offset:49152
  ds_read_b128 v[76:79], v123 offset:50176
  s_waitcnt lgkmcnt(8)
  v_mfma_f32_16x16x32_bf16 v[40:43], v[104:107], v[88:91], v[40:43]
  ds_read_b64_tr_b16 v[96:97], v122 offset:18432
  v_mfma_f32_16x16x32_bf16 v[44:47], v[104:107], v[92:95], v[44:47]
  ds_read_b64_tr_b16 v[98:99], v122 offset:23040
  s_waitcnt lgkmcnt(8)
  v_mfma_f32_16x16x32_bf16 v[48:51], v[108:111], v[88:91], v[48:51]
  ds_read_b64_tr_b16 v[100:101], v122 offset:18464
  v_mfma_f32_16x16x32_bf16 v[52:55], v[108:111], v[92:95], v[52:55]
  ds_read_b64_tr_b16 v[102:103], v122 offset:23072
  s_waitcnt lgkmcnt(8)
  v_mfma_f32_16x16x32_bf16 v[56:59], v[112:115], v[88:91], v[56:59]
  ds_read_b64_tr_b16 v[104:105], v122 offset:18496
  v_mfma_f32_16x16x32_bf16 v[60:63], v[112:115], v[92:95], v[60:63]
  ds_read_b64_tr_b16 v[106:107], v122 offset:23104
  s_waitcnt lgkmcnt(8)
  v_mfma_f32_16x16x32_bf16 v[64:67], v[116:119], v[88:91], v[64:67]
  ds_read_b64_tr_b16 v[108:109], v122 offset:18528
  v_mfma_f32_16x16x32_bf16 v[68:71], v[116:119], v[92:95], v[68:71]
  ds_read_b64_tr_b16 v[110:111], v122 offset:23136
  s_waitcnt lgkmcnt(6)
  v_mfma_f32_16x16x32_bf16 v[0:3], v[96:99], v[72:75], v[0:3]
  ds_read_b64_tr_b16 v[112:113], v122 offset:18560
  v_mfma_f32_16x16x32_bf16 v[4:7], v[96:99], v[76:79], v[4:7]
  ds_read_b64_tr_b16 v[114:115], v122 offset:23168
  s_waitcnt lgkmcnt(6)
  v_mfma_f32_16x16x32_bf16 v[8:11], v[100:103], v[72:75], v[8:11]
  ds_read_b64_tr_b16 v[116:117], v122 offset:18592
  v_mfma_f32_16x16x32_bf16 v[12:15], v[100:103], v[76:79], v[12:15]
  ds_read_b64_tr_b16 v[118:119], v122 offset:23200
  s_waitcnt lgkmcnt(6)
  v_mfma_f32_16x16x32_bf16 v[16:19], v[104:107], v[72:75], v[16:19]
  ds_read_b64_tr_b16 v[96:97], v122 offset:18624
  v_mfma_f32_16x16x32_bf16 v[20:23], v[104:107], v[76:79], v[20:23]
  ds_read_b64_tr_b16 v[98:99], v122 offset:23232
  s_waitcnt lgkmcnt(6)
  v_mfma_f32_16x16x32_bf16 v[24:27], v[108:111], v[72:75], v[24:27]
  ds_read_b64_tr_b16 v[100:101], v122 offset:18656
  v_mfma_f32_16x16x32_bf16 v[28:31], v[108:111], v[76:79], v[28:31]
  ds_read_b64_tr_b16 v[102:103], v122 offset:23264
  s_waitcnt lgkmcnt(6)
  v_mfma_f32_16x16x32_bf16 v[32:35], v[112:115], v[72:75], v[32:35]
  ds_read_b64_tr_b16 v[104:105], v122 offset:18688
  v_mfma_f32_16x16x32_bf16 v[36:39], v[112:115], v[76:79], v[36:39]
  ds_read_b64_tr_b16 v[106:107], v122 offset:23296
  s_barrier
  ds_read2st64_b64 v[80:83], v125 offset0:112 offset1:113
  ds_read2st64_b64 v[84:87], v125 offset0:114 offset1:115
  s_waitcnt lgkmcnt(8)
  v_mfma_f32_16x16x32_bf16 v[40:43], v[116:119], v[72:75], v[40:43]
  ds_read_b64_tr_b16 v[108:109], v122 offset:27648
  v_mfma_f32_16x16x32_bf16 v[44:47], v[116:119], v[76:79], v[44:47]
  ds_read_b64_tr_b16 v[110:111], v122 offset:32256
  s_waitcnt lgkmcnt(8)
  v_mfma_f32_16x16x32_bf16 v[48:51], v[96:99], v[72:75], v[48:51]
  ds_read_b64_tr_b16 v[112:113], v122 offset:27680
  v_mfma_f32_16x16x32_bf16 v[52:55], v[96:99], v[76:79], v[52:55]
  ds_read_b64_tr_b16 v[114:115], v122 offset:32288
  s_waitcnt lgkmcnt(8)
  v_mfma_f32_16x16x32_bf16 v[56:59], v[100:103], v[72:75], v[56:59]
  ds_read_b64_tr_b16 v[116:117], v122 offset:27712
  v_mfma_f32_16x16x32_bf16 v[60:63], v[100:103], v[76:79], v[60:63]
  ds_read_b64_tr_b16 v[118:119], v122 offset:32320
  s_waitcnt lgkmcnt(8)
  v_mfma_f32_16x16x32_bf16 v[64:67], v[104:107], v[72:75], v[64:67]
  ds_read_b64_tr_b16 v[96:97], v122 offset:27744
  v_mfma_f32_16x16x32_bf16 v[68:71], v[104:107], v[76:79], v[68:71]
  ds_read_b64_tr_b16 v[98:99], v122 offset:32352
  s_waitcnt lgkmcnt(6)
  v_mfma_f32_16x16x32_bf16 v[0:3], v[108:111], v[80:83], v[0:3]
  ds_read_b64_tr_b16 v[100:101], v122 offset:27776
  v_mfma_f32_16x16x32_bf16 v[4:7], v[108:111], v[84:87], v[4:7]
  ds_read_b64_tr_b16 v[102:103], v122 offset:32384
  s_waitcnt lgkmcnt(6)
  v_mfma_f32_16x16x32_bf16 v[8:11], v[112:115], v[80:83], v[8:11]
  ds_read_b64_tr_b16 v[104:105], v122 offset:27808
  v_mfma_f32_16x16x32_bf16 v[12:15], v[112:115], v[84:87], v[12:15]
  ds_read_b64_tr_b16 v[106:107], v122 offset:32416
  s_waitcnt lgkmcnt(6)
  v_mfma_f32_16x16x32_bf16 v[16:19], v[116:119], v[80:83], v[16:19]
  ds_read_b64_tr_b16 v[108:109], v122 offset:27840
  v_mfma_f32_16x16x32_bf16 v[20:23], v[116:119], v[84:87], v[20:23]
  ds_read_b64_tr_b16 v[110:111], v122 offset:32448
  s_waitcnt lgkmcnt(6)
  v_mfma_f32_16x16x32_bf16 v[24:27], v[96:99], v[80:83], v[24:27]
  ds_read_b64_tr_b16 v[112:113], v122 offset:27872
  v_mfma_f32_16x16x32_bf16 v[28:31], v[96:99], v[84:87], v[28:31]
  ds_read_b64_tr_b16 v[114:115], v122 offset:32480
  s_waitcnt lgkmcnt(6)
  v_mfma_f32_16x16x32_bf16 v[32:35], v[100:103], v[80:83], v[32:35]
  ds_read_b64_tr_b16 v[116:117], v122 offset:27904
  v_mfma_f32_16x16x32_bf16 v[36:39], v[100:103], v[84:87], v[36:39]
  ds_read_b64_tr_b16 v[118:119], v122 offset:32512
  s_barrier
  ds_read_b128 v[88:91], v123 offset:0
  ds_read_b128 v[92:95], v123 offset:1024
  s_waitcnt lgkmcnt(8)
  v_mfma_f32_16x16x32_bf16 v[40:43], v[104:107], v[80:83], v[40:43]
  ds_read_b64_tr_b16 v[96:97], v121 offset:0
  v_mfma_f32_16x16x32_bf16 v[44:47], v[104:107], v[84:87], v[44:47]
  ds_read_b64_tr_b16 v[98:99], v121 offset:4608
  s_waitcnt lgkmcnt(8)
  v_mfma_f32_16x16x32_bf16 v[48:51], v[108:111], v[80:83], v[48:51]
  ds_read_b64_tr_b16 v[100:101], v121 offset:32
  v_mfma_f32_16x16x32_bf16 v[52:55], v[108:111], v[84:87], v[52:55]
  ds_read_b64_tr_b16 v[102:103], v121 offset:4640
  s_waitcnt lgkmcnt(8)
  v_mfma_f32_16x16x32_bf16 v[56:59], v[112:115], v[80:83], v[56:59]
  ds_read_b64_tr_b16 v[104:105], v121 offset:64
  v_mfma_f32_16x16x32_bf16 v[60:63], v[112:115], v[84:87], v[60:63]
  ds_read_b64_tr_b16 v[106:107], v121 offset:4672
  s_waitcnt lgkmcnt(8)
  v_mfma_f32_16x16x32_bf16 v[64:67], v[116:119], v[80:83], v[64:67]
  ds_read_b64_tr_b16 v[108:109], v121 offset:96
  v_mfma_f32_16x16x32_bf16 v[68:71], v[116:119], v[84:87], v[68:71]
  ds_read_b64_tr_b16 v[110:111], v121 offset:4704
  s_waitcnt lgkmcnt(6)
  v_mfma_f32_16x16x32_bf16 v[0:3], v[96:99], v[88:91], v[0:3]
  ds_read_b64_tr_b16 v[112:113], v121 offset:128
  v_mfma_f32_16x16x32_bf16 v[4:7], v[96:99], v[92:95], v[4:7]
  ds_read_b64_tr_b16 v[114:115], v121 offset:4736
  s_waitcnt lgkmcnt(6)
  v_mfma_f32_16x16x32_bf16 v[8:11], v[100:103], v[88:91], v[8:11]
  ds_read_b64_tr_b16 v[116:117], v121 offset:160
  v_mfma_f32_16x16x32_bf16 v[12:15], v[100:103], v[92:95], v[12:15]
  ds_read_b64_tr_b16 v[118:119], v121 offset:4768
  s_waitcnt lgkmcnt(6)
  v_mfma_f32_16x16x32_bf16 v[16:19], v[104:107], v[88:91], v[16:19]
  ds_read_b64_tr_b16 v[96:97], v121 offset:192
  v_mfma_f32_16x16x32_bf16 v[20:23], v[104:107], v[92:95], v[20:23]
  ds_read_b64_tr_b16 v[98:99], v121 offset:4800
  s_waitcnt lgkmcnt(6)
  v_mfma_f32_16x16x32_bf16 v[24:27], v[108:111], v[88:91], v[24:27]
  ds_read_b64_tr_b16 v[100:101], v121 offset:224
  v_mfma_f32_16x16x32_bf16 v[28:31], v[108:111], v[92:95], v[28:31]
  ds_read_b64_tr_b16 v[102:103], v121 offset:4832
  s_waitcnt lgkmcnt(6)
  v_mfma_f32_16x16x32_bf16 v[32:35], v[112:115], v[88:91], v[32:35]
  ds_read_b64_tr_b16 v[104:105], v121 offset:256
  v_mfma_f32_16x16x32_bf16 v[36:39], v[112:115], v[92:95], v[36:39]
  ds_read_b64_tr_b16 v[106:107], v121 offset:4864
  s_barrier
  ds_read_b128 v[72:75], v123 offset:8192
  ds_read_b128 v[76:79], v123 offset:9216
  s_waitcnt lgkmcnt(8)
  v_mfma_f32_16x16x32_bf16 v[40:43], v[116:119], v[88:91], v[40:43]
  ds_read_b64_tr_b16 v[108:109], v121 offset:9216
  v_mfma_f32_16x16x32_bf16 v[44:47], v[116:119], v[92:95], v[44:47]
  ds_read_b64_tr_b16 v[110:111], v121 offset:13824
  s_waitcnt lgkmcnt(8)
  v_mfma_f32_16x16x32_bf16 v[48:51], v[96:99], v[88:91], v[48:51]
  ds_read_b64_tr_b16 v[112:113], v121 offset:9248
  v_mfma_f32_16x16x32_bf16 v[52:55], v[96:99], v[92:95], v[52:55]
  ds_read_b64_tr_b16 v[114:115], v121 offset:13856
  s_waitcnt lgkmcnt(8)
  v_mfma_f32_16x16x32_bf16 v[56:59], v[100:103], v[88:91], v[56:59]
  ds_read_b64_tr_b16 v[116:117], v121 offset:9280
  v_mfma_f32_16x16x32_bf16 v[60:63], v[100:103], v[92:95], v[60:63]
  ds_read_b64_tr_b16 v[118:119], v121 offset:13888
  s_waitcnt lgkmcnt(8)
  v_mfma_f32_16x16x32_bf16 v[64:67], v[104:107], v[88:91], v[64:67]
  ds_read_b64_tr_b16 v[96:97], v121 offset:9312
  v_mfma_f32_16x16x32_bf16 v[68:71], v[104:107], v[92:95], v[68:71]
  ds_read_b64_tr_b16 v[98:99], v121 offset:13920
  s_waitcnt lgkmcnt(6)
  v_mfma_f32_16x16x32_bf16 v[0:3], v[108:111], v[72:75], v[0:3]
  ds_read_b64_tr_b16 v[100:101], v121 offset:9344
  v_mfma_f32_16x16x32_bf16 v[4:7], v[108:111], v[76:79], v[4:7]
  ds_read_b64_tr_b16 v[102:103], v121 offset:13952
  s_waitcnt lgkmcnt(6)
  v_mfma_f32_16x16x32_bf16 v[8:11], v[112:115], v[72:75], v[8:11]
  ds_read_b64_tr_b16 v[104:105], v121 offset:9376
  v_mfma_f32_16x16x32_bf16 v[12:15], v[112:115], v[76:79], v[12:15]
  ds_read_b64_tr_b16 v[106:107], v121 offset:13984
  s_waitcnt lgkmcnt(6)
  v_mfma_f32_16x16x32_bf16 v[16:19], v[116:119], v[72:75], v[16:19]
  ds_read_b64_tr_b16 v[108:109], v121 offset:9408
  v_mfma_f32_16x16x32_bf16 v[20:23], v[116:119], v[76:79], v[20:23]
  ds_read_b64_tr_b16 v[110:111], v121 offset:14016
  s_waitcnt lgkmcnt(6)
  v_mfma_f32_16x16x32_bf16 v[24:27], v[96:99], v[72:75], v[24:27]
  ds_read_b64_tr_b16 v[112:113], v121 offset:9440
  v_mfma_f32_16x16x32_bf16 v[28:31], v[96:99], v[76:79], v[28:31]
  ds_read_b64_tr_b16 v[114:115], v121 offset:14048
  s_waitcnt lgkmcnt(6)
  v_mfma_f32_16x16x32_bf16 v[32:35], v[100:103], v[72:75], v[32:35]
  ds_read_b64_tr_b16 v[116:117], v121 offset:9472
  v_mfma_f32_16x16x32_bf16 v[36:39], v[100:103], v[76:79], v[36:39]
  ds_read_b64_tr_b16 v[118:119], v121 offset:14080
  s_barrier
  ds_read_b128 v[80:83], v123 offset:16384
  ds_read_b128 v[84:87], v123 offset:17408
  ds_read_b128 v[88:91], v123 offset:24576
  ds_read_b128 v[92:95], v123 offset:25600
  s_waitcnt lgkmcnt(10)
  v_mfma_f32_16x16x32_bf16 v[40:43], v[104:107], v[72:75], v[40:43]
  ds_read_b64_tr_b16 v[96:97], v121 offset:18432
  v_mfma_f32_16x16x32_bf16 v[44:47], v[104:107], v[76:79], v[44:47]
  ds_read_b64_tr_b16 v[98:99], v121 offset:23040
  s_waitcnt lgkmcnt(10)
  v_mfma_f32_16x16x32_bf16 v[48:51], v[108:111], v[72:75], v[48:51]
  ds_read_b64_tr_b16 v[100:101], v121 offset:27648
  v_mfma_f32_16x16x32_bf16 v[52:55], v[108:111], v[76:79], v[52:55]
  ds_read_b64_tr_b16 v[102:103], v121 offset:32256
  s_waitcnt lgkmcnt(10)
  v_mfma_f32_16x16x32_bf16 v[56:59], v[112:115], v[72:75], v[56:59]
  ds_read_b64_tr_b16 v[104:105], v121 offset:18464
  v_mfma_f32_16x16x32_bf16 v[60:63], v[112:115], v[76:79], v[60:63]
  ds_read_b64_tr_b16 v[106:107], v121 offset:23072
  s_waitcnt lgkmcnt(10)
  v_mfma_f32_16x16x32_bf16 v[64:67], v[116:119], v[72:75], v[64:67]
  ds_read_b64_tr_b16 v[108:109], v121 offset:27680
  v_mfma_f32_16x16x32_bf16 v[68:71], v[116:119], v[76:79], v[68:71]
  ds_read_b64_tr_b16 v[110:111], v121 offset:32288
  s_waitcnt lgkmcnt(6)
  v_mfma_f32_16x16x32_bf16 v[0:3], v[96:99], v[80:83], v[0:3]
  ds_read_b64_tr_b16 v[112:113], v121 offset:18496
  v_mfma_f32_16x16x32_bf16 v[4:7], v[96:99], v[84:87], v[4:7]
  ds_read_b64_tr_b16 v[114:115], v121 offset:23104
  s_waitcnt lgkmcnt(6)
  v_mfma_f32_16x16x32_bf16 v[0:3], v[100:103], v[88:91], v[0:3]
  ds_read_b64_tr_b16 v[116:117], v121 offset:27712
  v_mfma_f32_16x16x32_bf16 v[4:7], v[100:103], v[92:95], v[4:7]
  ds_read_b64_tr_b16 v[118:119], v121 offset:32320
  s_waitcnt lgkmcnt(6)
  v_mfma_f32_16x16x32_bf16 v[8:11], v[104:107], v[80:83], v[8:11]
  ds_read_b64_tr_b16 v[96:97], v121 offset:18528
  v_mfma_f32_16x16x32_bf16 v[12:15], v[104:107], v[84:87], v[12:15]
  ds_read_b64_tr_b16 v[98:99], v121 offset:23136
  s_waitcnt lgkmcnt(6)
  v_mfma_f32_16x16x32_bf16 v[8:11], v[108:111], v[88:91], v[8:11]
  ds_read_b64_tr_b16 v[100:101], v121 offset:27744
  v_cvt_pk_bf16_f32 v0, v0, v1
  v_cvt_pk_bf16_f32 v1, v2, v3
  v_mfma_f32_16x16x32_bf16 v[12:15], v[108:111], v[92:95], v[12:15]
  ds_read_b64_tr_b16 v[102:103], v121 offset:32352
  v_cvt_pk_bf16_f32 v2, v4, v5
  v_cvt_pk_bf16_f32 v3, v6, v7
  s_waitcnt lgkmcnt(6)
  v_mfma_f32_16x16x32_bf16 v[16:19], v[112:115], v[80:83], v[16:19]
  ds_read_b64_tr_b16 v[104:105], v121 offset:18560
  v_permlane16_swap_b32 v0, v2
  v_permlane16_swap_b32 v1, v3
  v_mfma_f32_16x16x32_bf16 v[20:23], v[112:115], v[84:87], v[20:23]
  ds_read_b64_tr_b16 v[106:107], v121 offset:23168
  buffer_store_dwordx4 v[0:3], v120, s[20:23], s38 offen offset:0 sc0 sc1
  s_waitcnt lgkmcnt(6)
  v_mfma_f32_16x16x32_bf16 v[16:19], v[116:119], v[88:91], v[16:19]
  ds_read_b64_tr_b16 v[108:109], v121 offset:27776
  v_cvt_pk_bf16_f32 v8, v8, v9
  v_cvt_pk_bf16_f32 v9, v10, v11
  v_mfma_f32_16x16x32_bf16 v[20:23], v[116:119], v[92:95], v[20:23]
  ds_read_b64_tr_b16 v[110:111], v121 offset:32384
  v_cvt_pk_bf16_f32 v10, v12, v13
  v_cvt_pk_bf16_f32 v11, v14, v15
  s_waitcnt lgkmcnt(6)
  v_mfma_f32_16x16x32_bf16 v[24:27], v[96:99], v[80:83], v[24:27]
  ds_read_b64_tr_b16 v[112:113], v121 offset:18592
  v_permlane16_swap_b32 v8, v10
  v_permlane16_swap_b32 v9, v11
  v_mfma_f32_16x16x32_bf16 v[28:31], v[96:99], v[84:87], v[28:31]
  ds_read_b64_tr_b16 v[114:115], v121 offset:23200
  buffer_store_dwordx4 v[8:11], v120, s[20:23], s38 offen offset:1024 sc0 sc1
  s_waitcnt lgkmcnt(6)
  v_mfma_f32_16x16x32_bf16 v[24:27], v[100:103], v[88:91], v[24:27]
  ds_read_b64_tr_b16 v[116:117], v121 offset:27808
  v_cvt_pk_bf16_f32 v16, v16, v17
  v_cvt_pk_bf16_f32 v17, v18, v19
  v_mfma_f32_16x16x32_bf16 v[28:31], v[100:103], v[92:95], v[28:31]
  ds_read_b64_tr_b16 v[118:119], v121 offset:32416
  v_cvt_pk_bf16_f32 v18, v20, v21
  v_cvt_pk_bf16_f32 v19, v22, v23
  s_waitcnt lgkmcnt(6)
  v_mfma_f32_16x16x32_bf16 v[32:35], v[104:107], v[80:83], v[32:35]
  ds_read_b64_tr_b16 v[96:97], v121 offset:18624
  v_permlane16_swap_b32 v16, v18
  v_permlane16_swap_b32 v17, v19
  v_mfma_f32_16x16x32_bf16 v[36:39], v[104:107], v[84:87], v[36:39]
  ds_read_b64_tr_b16 v[98:99], v121 offset:23232
  buffer_store_dwordx4 v[16:19], v120, s[20:23], s38 offen offset:2048 sc0 sc1
  s_waitcnt lgkmcnt(6)
  v_mfma_f32_16x16x32_bf16 v[32:35], v[108:111], v[88:91], v[32:35]
  ds_read_b64_tr_b16 v[100:101], v121 offset:27840
  v_cvt_pk_bf16_f32 v24, v24, v25
  v_cvt_pk_bf16_f32 v25, v26, v27
  v_mfma_f32_16x16x32_bf16 v[36:39], v[108:111], v[92:95], v[36:39]
  ds_read_b64_tr_b16 v[102:103], v121 offset:32448
  v_cvt_pk_bf16_f32 v26, v28, v29
  v_cvt_pk_bf16_f32 v27, v30, v31
  s_waitcnt lgkmcnt(6)
  v_mfma_f32_16x16x32_bf16 v[40:43], v[112:115], v[80:83], v[40:43]
  ds_read_b64_tr_b16 v[104:105], v121 offset:18656
  v_permlane16_swap_b32 v24, v26
  v_permlane16_swap_b32 v25, v27
  v_mfma_f32_16x16x32_bf16 v[44:47], v[112:115], v[84:87], v[44:47]
  ds_read_b64_tr_b16 v[106:107], v121 offset:23264
  buffer_store_dwordx4 v[24:27], v120, s[20:23], s38 offen offset:3072 sc0 sc1
  s_waitcnt lgkmcnt(6)
  v_mfma_f32_16x16x32_bf16 v[40:43], v[116:119], v[88:91], v[40:43]
  ds_read_b64_tr_b16 v[108:109], v121 offset:27872
  v_cvt_pk_bf16_f32 v32, v32, v33
  v_cvt_pk_bf16_f32 v33, v34, v35
  v_mfma_f32_16x16x32_bf16 v[44:47], v[116:119], v[92:95], v[44:47]
  ds_read_b64_tr_b16 v[110:111], v121 offset:32480
  v_cvt_pk_bf16_f32 v34, v36, v37
  v_cvt_pk_bf16_f32 v35, v38, v39
  s_waitcnt lgkmcnt(6)
  v_mfma_f32_16x16x32_bf16 v[48:51], v[96:99], v[80:83], v[48:51]
  ds_read_b64_tr_b16 v[112:113], v121 offset:18688
  v_permlane16_swap_b32 v32, v34
  v_permlane16_swap_b32 v33, v35
  v_mfma_f32_16x16x32_bf16 v[52:55], v[96:99], v[84:87], v[52:55]
  ds_read_b64_tr_b16 v[114:115], v121 offset:23296
  s_add_u32 s38, s38, 4096
  buffer_store_dwordx4 v[32:35], v120, s[20:23], s38 offen offset:0 sc0 sc1
  s_waitcnt lgkmcnt(6)
  v_mfma_f32_16x16x32_bf16 v[48:51], v[100:103], v[88:91], v[48:51]
  ds_read_b64_tr_b16 v[116:117], v121 offset:27904
  v_cvt_pk_bf16_f32 v40, v40, v41
  v_cvt_pk_bf16_f32 v41, v42, v43
  v_mfma_f32_16x16x32_bf16 v[52:55], v[100:103], v[92:95], v[52:55]
  ds_read_b64_tr_b16 v[118:119], v121 offset:32512
  v_cvt_pk_bf16_f32 v42, v44, v45
  v_cvt_pk_bf16_f32 v43, v46, v47
  s_waitcnt lgkmcnt(6)
  v_mfma_f32_16x16x32_bf16 v[56:59], v[104:107], v[80:83], v[56:59]
  v_permlane16_swap_b32 v40, v42
  v_permlane16_swap_b32 v41, v43
  v_mfma_f32_16x16x32_bf16 v[60:63], v[104:107], v[84:87], v[60:63]
  buffer_store_dwordx4 v[40:43], v120, s[20:23], s38 offen offset:1024 sc0 sc1
  s_waitcnt lgkmcnt(4)
  v_mfma_f32_16x16x32_bf16 v[56:59], v[108:111], v[88:91], v[56:59]
  v_cvt_pk_bf16_f32 v48, v48, v49
  v_cvt_pk_bf16_f32 v49, v50, v51
  v_mfma_f32_16x16x32_bf16 v[60:63], v[108:111], v[92:95], v[60:63]
  v_cvt_pk_bf16_f32 v50, v52, v53
  v_cvt_pk_bf16_f32 v51, v54, v55
  s_waitcnt lgkmcnt(2)
  v_mfma_f32_16x16x32_bf16 v[64:67], v[112:115], v[80:83], v[64:67]
  v_permlane16_swap_b32 v48, v50
  v_permlane16_swap_b32 v49, v51
  v_mfma_f32_16x16x32_bf16 v[68:71], v[112:115], v[84:87], v[68:71]
  buffer_store_dwordx4 v[48:51], v120, s[20:23], s38 offen offset:2048 sc0 sc1
  s_waitcnt lgkmcnt(0)
  v_mfma_f32_16x16x32_bf16 v[64:67], v[116:119], v[88:91], v[64:67]
  v_cvt_pk_bf16_f32 v56, v56, v57
  v_cvt_pk_bf16_f32 v57, v58, v59
  v_mfma_f32_16x16x32_bf16 v[68:71], v[116:119], v[92:95], v[68:71]
  v_cvt_pk_bf16_f32 v58, v60, v61
  v_cvt_pk_bf16_f32 v59, v62, v63
  s_nop 0
  v_permlane16_swap_b32 v56, v58
  v_permlane16_swap_b32 v57, v59
  buffer_store_dwordx4 v[56:59], v120, s[20:23], s38 offen offset:3072 sc0 sc1
  v_cvt_pk_bf16_f32 v64, v64, v65
  v_cvt_pk_bf16_f32 v65, v66, v67
  v_cvt_pk_bf16_f32 v66, v68, v69
  v_cvt_pk_bf16_f32 v67, v70, v71
  s_nop 0
  v_permlane16_swap_b32 v64, v66
  v_permlane16_swap_b32 v65, v67
  s_add_u32 s38, s38, 4096
  buffer_store_dwordx4 v[64:67], v120, s[20:23], s38 offen offset:0 sc0 sc1
  s_endpgm
k5_down_kernel_ld2:
  v_and_b32 v6, 255, v0
  v_add_u32 v2, 0, v6
  v_mul_u32_u24 v3, 3641, v2
  v_lshrrev_b32 v3, 16, v3
  v_mul_u32_u24 v3, 864, v3
  v_lshl_add_u32 v8, v2, 4, v3
  v_add_u32 v2, 256, v6
  v_mul_u32_u24 v3, 3641, v2
  v_lshrrev_b32 v3, 16, v3
  v_mul_u32_u24 v3, 864, v3
  v_lshl_add_u32 v9, v2, 4, v3
  v_add_u32 v2, 512, v6
  v_mul_u32_u24 v3, 3641, v2
  v_lshrrev_b32 v3, 16, v3
  v_mul_u32_u24 v3, 864, v3
  v_lshl_add_u32 v10, v2, 4, v3
  v_add_u32 v2, 768, v6
  v_mul_u32_u24 v3, 3641, v2
  v_lshrrev_b32 v3, 16, v3
  v_mul_u32_u24 v3, 864, v3
  v_lshl_add_u32 v11, v2, 4, v3
  v_add_u32 v2, 1024, v6
  v_mul_u32_u24 v3, 3641, v2
  v_lshrrev_b32 v3, 16, v3
  v_mul_u32_u24 v3, 864, v3
  v_lshl_add_u32 v12, v2, 4, v3
  v_add_u32 v2, 1280, v6
  v_mul_u32_u24 v3, 3641, v2
  v_lshrrev_b32 v3, 16, v3
  v_mul_u32_u24 v3, 864, v3
  v_lshl_add_u32 v13, v2, 4, v3
  v_add_u32 v2, 1536, v6
  v_mul_u32_u24 v3, 3641, v2
  v_lshrrev_b32 v3, 16, v3
  v_mul_u32_u24 v3, 864, v3
  v_lshl_add_u32 v14, v2, 4, v3
  v_add_u32 v2, 1792, v6
  v_mul_u32_u24 v3, 3641, v2
  v_lshrrev_b32 v3, 16, v3
  v_mul_u32_u24 v3, 864, v3
  v_lshl_add_u32 v15, v2, 4, v3
  v_add_u32 v2, 2048, v6
  v_mul_u32_u24 v3, 3641, v2
  v_lshrrev_b32 v3, 16, v3
  v_mul_u32_u24 v3, 864, v3
  v_lshl_add_u32 v16, v2, 4, v3
  s_lshl_b32 s43, s31, 10
  s_lshl_b32 s42, s31, 11
  s_add_u32 s42, s42, 73728
  s_mul_i32 s32, s28, 1327104
  s_mul_i32 s33, s41, 288
  s_add_u32 s32, s32, s33
  s_mul_i32 s35, s34, 294912
  s_mul_i32 s36, s28, 36864
  s_add_u32 s35, s35, s36
  s_add_u32 s36, s35, 146432
  s_waitcnt lgkmcnt(0)
  s_mov_b32 s12, s6
  s_mov_b32 s13, s7
  s_mov_b32 s14, 0x510000
  s_mov_b32 s15, 0x20000
  s_add_u32 s16, s4, 0x1000000
  s_addc_u32 s17, s5, 0
  s_mov_b32 s18, 0x1200000
  s_mov_b32 s19, 0x20000
  s_add_u32 m0, s43, 0
  s_nop 0
  buffer_load_dwordx4 v8, s[12:15], s32 offen lds
  s_add_u32 m0, s43, 4096
  s_nop 0
  buffer_load_dwordx4 v9, s[12:15], s32 offen lds
  s_add_u32 m0, s43, 8192
  s_nop 0
  buffer_load_dwordx4 v10, s[12:15], s32 offen lds
  s_add_u32 m0, s42, 0
  s_nop 0
  buffer_load_dwordx4 v120, s[16:19], s35 offen  lds
  buffer_load_dwordx4 v120, s[16:19], s36 offen offset:1024  lds
  s_add_u32 s35, s35, 1024
  s_add_u32 s36, s36, 1024
  s_add_u32 m0, s43, 12288
  s_nop 0
  buffer_load_dwordx4 v11, s[12:15], s32 offen lds
  s_add_u32 m0, s43, 16384
  s_nop 0
  buffer_load_dwordx4 v12, s[12:15], s32 offen lds
  s_add_u32 m0, s42, 8192
  s_nop 0
  buffer_load_dwordx4 v120, s[16:19], s35 offen  lds
  buffer_load_dwordx4 v120, s[16:19], s36 offen offset:1024  lds
  s_add_u32 s35, s35, 1024
  s_add_u32 s36, s36, 1024
  s_add_u32 m0, s43, 20480
  s_nop 0
  buffer_load_dwordx4 v13, s[12:15], s32 offen lds
  s_add_u32 m0, s43, 24576
  s_nop 0
  buffer_load_dwordx4 v14, s[12:15], s32 offen lds
  s_add_u32 m0, s42, 16384
  s_nop 0
  buffer_load_dwordx4 v120, s[16:19], s35 offen  lds
  buffer_load_dwordx4 v120, s[16:19], s36 offen offset:1024  lds
  s_add_u32 s35, s35, 1024
  s_add_u32 s36, s36, 1024
  s_waitcnt vmcnt(8)
  s_barrier
  s_add_u32 m0, s43, 28672
  s_nop 0
  buffer_load_dwordx4 v15, s[12:15], s32 offen lds
  s_add_u32 m0, s43, 32768
  s_nop 0
  buffer_load_dwordx4 v16, s[12:15], s32 offen lds
  s_add_u32 m0, s42, 24576
  s_nop 0
  buffer_load_dwordx4 v120, s[16:19], s35 offen  lds
  buffer_load_dwordx4 v120, s[16:19], s36 offen offset:1024  lds
  s_add_u32 s35, s35, 1024
  s_add_u32 s36, s36, 1024
  s_add_u32 m0, s43, 36864
  s_add_u32 s32, s32, 147456
  buffer_load_dwordx4 v8, s[12:15], s32 offen lds
  s_add_u32 m0, s43, 40960
  s_nop 0
  buffer_load_dwordx4 v9, s[12:15], s32 offen lds
  s_add_u32 m0, s43, 45056
  s_nop 0
  buffer_load_dwordx4 v10, s[12:15], s32 offen lds
  s_add_u32 m0, s42, 32768
  s_nop 0
  buffer_load_dwordx4 v120, s[16:19], s35 offen  lds
  buffer_load_dwordx4 v120, s[16:19], s36 offen offset:1024  lds
  s_add_u32 s35, s35, 1024
  s_add_u32 s36, s36, 1024
  s_waitcnt vmcnt(13)
  s_barrier
  s_add_u32 m0, s43, 49152
  s_nop 0
  buffer_load_dwordx4 v11, s[12:15], s32 offen lds
  s_add_u32 m0, s43, 53248
  s_nop 0
  buffer_load_dwordx4 v12, s[12:15], s32 offen lds
  s_add_u32 m0, s42, 40960
  s_nop 0
  buffer_load_dwordx4 v120, s[16:19], s35 offen  lds
  buffer_load_dwordx4 v120, s[16:19], s36 offen offset:1024  lds
  s_add_u32 s35, s35, 1024
  s_add_u32 s36, s36, 1024
  s_add_u32 m0, s43, 57344
  s_nop 0
  buffer_load_dwordx4 v13, s[12:15], s32 offen lds
  s_add_u32 m0, s43, 61440
  s_nop 0
  buffer_load_dwordx4 v14, s[12:15], s32 offen lds
  s_add_u32 m0, s42, 49152
  s_nop 0
  buffer_load_dwordx4 v120, s[16:19], s35 offen  lds
  buffer_load_dwordx4 v120, s[16:19], s36 offen offset:1024  lds
  s_add_u32 s35, s35, 1024
  s_add_u32 s36, s36, 1024
  s_waitcnt vmcnt(17)
  s_barrier
  s_add_u32 m0, s43, 65536
  s_nop 0
  buffer_load_dwordx4 v15, s[12:15], s32 offen lds
  s_add_u32 m0, s43, 69632
  s_nop 0
  buffer_load_dwordx4 v16, s[12:15], s32 offen lds
  s_add_u32 m0, s42, 57344
  s_nop 0
  buffer_load_dwordx4 v120, s[16:19], s35 offen  lds
  buffer_load_dwordx4 v120, s[16:19], s36 offen offset:1024  lds
  s_add_u32 s35, s35, 1024
  s_add_u32 s36, s36, 1024
  s_waitcnt vmcnt(17)
  s_barrier
  s_add_u32 m0, s43, 0
  s_add_u32 s32, s32, 147456
  buffer_load_dwordx4 v8, s[12:15], s32 offen lds
  s_add_u32 m0, s43, 4096
  s_nop 0
  buffer_load_dwordx4 v9, s[12:15], s32 offen lds
  s_add_u32 m0, s43, 8192
  s_nop 0
  buffer_load_dwordx4 v10, s[12:15], s32 offen lds
  s_add_u32 m0, s42, 0
  s_nop 0
  buffer_load_dwordx4 v120, s[16:19], s35 offen  lds
  buffer_load_dwordx4 v120, s[16:19], s36 offen offset:1024  lds
  s_add_u32 s35, s35, 1024
  s_add_u32 s36, s36, 1024
  s_waitcnt vmcnt(17)
  s_barrier
  s_add_u32 m0, s43, 12288
  s_nop 0
  buffer_load_dwordx4 v11, s[12:15], s32 offen lds
  s_add_u32 m0, s43, 16384
  s_nop 0
  buffer_load_dwordx4 v12, s[12:15], s32 offen lds
  s_add_u32 m0, s42, 8192
  s_nop 0
  buffer_load_dwordx4 v120, s[16:19], s35 offen  lds
  buffer_load_dwordx4 v120, s[16:19], s36 offen offset:1024  lds
  s_add_u32 s35, s35, 1024
  s_add_u32 s36, s36, 1024
  s_waitcnt vmcnt(17)
  s_barrier
  s_add_u32 m0, s43, 20480
  s_nop 0
  buffer_load_dwordx4 v13, s[12:15], s32 offen lds
  s_add_u32 m0, s43, 24576
  s_nop 0
  buffer_load_dwordx4 v14, s[12:15], s32 offen lds
  s_add_u32 m0, s42, 16384
  s_nop 0
  buffer_load_dwordx4 v120, s[16:19], s35 offen  lds
  buffer_load_dwordx4 v120, s[16:19], s36 offen offset:1024  lds
  s_add_u32 s35, s35, 1024
  s_add_u32 s36, s36, 1024
  s_add_u32 m0, s43, 28672
  s_nop 0
  buffer_load_dwordx4 v15, s[12:15], s32 offen lds
  s_add_u32 m0, s43, 32768
  s_nop 0
  buffer_load_dwordx4 v16, s[12:15], s32 offen lds
  s_add_u32 m0, s42, 24576
  s_nop 0
  buffer_load_dwordx4 v120, s[16:19], s35 offen  lds
  buffer_load_dwordx4 v120, s[16:19], s36 offen offset:1024  lds
  s_add_u32 s35, s35, 1024
  s_add_u32 s36, s36, 1024
  s_waitcnt vmcnt(21)
  s_barrier
  s_waitcnt vmcnt(17)
  s_barrier
  s_add_u32 m0, s43, 36864
  s_add_u32 s32, s32, 147456
  buffer_load_dwordx4 v8, s[12:15], s32 offen lds
  s_add_u32 m0, s43, 40960
  s_nop 0
  buffer_load_dwordx4 v9, s[12:15], s32 offen lds
  s_add_u32 m0, s43, 45056
  s_nop 0
  buffer_load_dwordx4 v10, s[12:15], s32 offen lds
  s_add_u32 m0, s42, 32768
  s_nop 0
  buffer_load_dwordx4 v120, s[16:19], s35 offen  lds
  buffer_load_dwordx4 v120, s[16:19], s36 offen offset:1024  lds
  s_add_u32 s35, s35, 1024
  s_add_u32 s36, s36, 1024
  s_waitcnt vmcnt(17)
  s_barrier
  s_add_u32 m0, s43, 49152
  s_nop 0
  buffer_load_dwordx4 v11, s[12:15], s32 offen lds
  s_add_u32 m0, s43, 53248
  s_nop 0
  buffer_load_dwordx4 v12, s[12:15], s32 offen lds
  s_add_u32 m0, s42, 40960
  s_nop 0
  buffer_load_dwordx4 v120, s[16:19], s35 offen  lds
  buffer_load_dwordx4 v120, s[16:19], s36 offen offset:1024  lds
  s_add_u32 s35, s35, 1024
  s_add_u32 s36, s36, 1024
  s_waitcnt vmcnt(17)
  s_barrier
  s_add_u32 m0, s43, 57344
  s_nop 0
  buffer_load_dwordx4 v13, s[12:15], s32 offen lds
  s_add_u32 m0, s43, 61440
  s_nop 0
  buffer_load_dwordx4 v14, s[12:15], s32 offen lds
  s_add_u32 m0, s42, 49152
  s_nop 0
  buffer_load_dwordx4 v120, s[16:19], s35 offen  lds
  buffer_load_dwordx4 v120, s[16:19], s36 offen offset:1024  lds
  s_add_u32 s35, s35, 1024
  s_add_u32 s36, s36, 1024
  s_add_u32 m0, s43, 65536
  s_nop 0
  buffer_load_dwordx4 v15, s[12:15], s32 offen lds
  s_add_u32 m0, s43, 69632
  s_nop 0
  buffer_load_dwordx4 v16, s[12:15], s32 offen lds
  s_add_u32 m0, s42, 57344
  s_nop 0
  buffer_load_dwordx4 v120, s[16:19], s35 offen  lds
  buffer_load_dwordx4 v120, s[16:19], s36 offen offset:1024  lds
  s_add_u32 s35, s35, 1024
  s_add_u32 s36, s36, 1024
  s_waitcnt vmcnt(21)
  s_barrier
  s_waitcnt vmcnt(17)
  s_barrier
  s_add_u32 m0, s43, 0
  s_add_u32 s32, s32, 147456
  buffer_load_dwordx4 v8, s[12:15], s32 offen lds
  s_add_u32 m0, s43, 4096
  s_nop 0
  buffer_load_dwordx4 v9, s[12:15], s32 offen lds
  s_add_u32 m0, s43, 8192
  s_nop 0
  buffer_load_dwordx4 v10, s[12:15], s32 offen lds
  s_add_u32 m0, s42, 0
  s_nop 0
  buffer_load_dwordx4 v120, s[16:19], s35 offen  lds
  buffer_load_dwordx4 v120, s[16:19], s36 offen offset:1024  lds
  s_add_u32 s35, s35, 1024
  s_add_u32 s36, s36, 1024
  s_waitcnt vmcnt(17)
  s_barrier
  s_add_u32 m0, s43, 12288
  s_nop 0
  buffer_load_dwordx4 v11, s[12:15], s32 offen lds
  s_add_u32 m0, s43, 16384
  s_nop 0
  buffer_load_dwordx4 v12, s[12:15], s32 offen lds
  s_add_u32 m0, s42, 8192
  s_nop 0
  buffer_load_dwordx4 v120, s[16:19], s35 offen  lds
  buffer_load_dwordx4 v120, s[16:19], s36 offen offset:1024  lds
  s_add_u32 s35, s35, 1024
  s_add_u32 s36, s36, 1024
  s_waitcnt vmcnt(17)
  s_barrier
  s_add_u32 m0, s43, 20480
  s_nop 0
  buffer_load_dwordx4 v13, s[12:15], s32 offen lds
  s_add_u32 m0, s43, 24576
  s_nop 0
  buffer_load_dwordx4 v14, s[12:15], s32 offen lds
  s_add_u32 m0, s42, 16384
  s_nop 0
  buffer_load_dwordx4 v120, s[16:19], s35 offen  lds
  buffer_load_dwordx4 v120, s[16:19], s36 offen offset:1024  lds
  s_add_u32 s35, s35, 1024
  s_add_u32 s36, s36, 1024
  s_add_u32 m0, s43, 28672
  s_nop 0
  buffer_load_dwordx4 v15, s[12:15], s32 offen lds
  s_add_u32 m0, s43, 32768
  s_nop 0
  buffer_load_dwordx4 v16, s[12:15], s32 offen lds
  s_add_u32 m0, s42, 24576
  s_nop 0
  buffer_load_dwordx4 v120, s[16:19], s35 offen  lds
  buffer_load_dwordx4 v120, s[16:19], s36 offen offset:1024  lds
  s_add_u32 s35, s35, 1024
  s_add_u32 s36, s36, 1024
  s_waitcnt vmcnt(21)
  s_barrier
  s_waitcnt vmcnt(17)
  s_barrier
  s_add_u32 m0, s43, 36864
  s_add_u32 s32, s32, 147456
  buffer_load_dwordx4 v8, s[12:15], s32 offen lds
  s_add_u32 m0, s43, 40960
  s_nop 0
  buffer_load_dwordx4 v9, s[12:15], s32 offen lds
  s_add_u32 m0, s43, 45056
  s_nop 0
  buffer_load_dwordx4 v10, s[12:15], s32 offen lds
  s_add_u32 m0, s42, 32768
  s_nop 0
  buffer_load_dwordx4 v120, s[16:19], s35 offen  lds
  buffer_load_dwordx4 v120, s[16:19], s36 offen offset:1024  lds
  s_add_u32 s35, s35, 1024
  s_add_u32 s36, s36, 1024
  s_waitcnt vmcnt(17)
  s_barrier
  s_add_u32 m0, s43, 49152
  s_nop 0
  buffer_load_dwordx4 v11, s[12:15], s32 offen lds
  s_add_u32 m0, s43, 53248
  s_nop 0
  buffer_load_dwordx4 v12, s[12:15], s32 offen lds
  s_add_u32 m0, s42, 40960
  s_nop 0
  buffer_load_dwordx4 v120, s[16:19], s35 offen  lds
  buffer_load_dwordx4 v120, s[16:19], s36 offen offset:1024  lds
  s_add_u32 s35, s35, 1024
  s_add_u32 s36, s36, 1024
  s_waitcnt vmcnt(17)
  s_barrier
  s_add_u32 m0, s43, 57344
  s_nop 0
  buffer_load_dwordx4 v13, s[12:15], s32 offen lds
  s_add_u32 m0, s43, 61440
  s_nop 0
  buffer_load_dwordx4 v14, s[12:15], s32 offen lds
  s_add_u32 m0, s42, 49152
  s_nop 0
  buffer_load_dwordx4 v120, s[16:19], s35 offen  lds
  buffer_load_dwordx4 v120, s[16:19], s36 offen offset:1024  lds
  s_add_u32 s35, s35, 1024
  s_add_u32 s36, s36, 1024
  s_add_u32 m0, s43, 65536
  s_nop 0
  buffer_load_dwordx4 v15, s[12:15], s32 offen lds
  s_add_u32 m0, s43, 69632
  s_nop 0
  buffer_load_dwordx4 v16, s[12:15], s32 offen lds
  s_add_u32 m0, s42, 57344
  s_nop 0
  buffer_load_dwordx4 v120, s[16:19], s35 offen  lds
  buffer_load_dwordx4 v120, s[16:19], s36 offen offset:1024  lds
  s_add_u32 s35, s35, 1024
  s_add_u32 s36, s36, 1024
  s_waitcnt vmcnt(21)
  s_barrier
  s_waitcnt vmcnt(17)
  s_barrier
  s_add_u32 m0, s43, 0
  s_add_u32 s32, s32, 147456
  buffer_load_dwordx4 v8, s[12:15], s32 offen lds
  s_add_u32 m0, s43, 4096
  s_nop 0
  buffer_load_dwordx4 v9, s[12:15], s32 offen lds
  s_add_u32 m0, s43, 8192
  s_nop 0
  buffer_load_dwordx4 v10, s[12:15], s32 offen lds
  s_add_u32 m0, s42, 0
  s_nop 0
  buffer_load_dwordx4 v120, s[16:19], s35 offen  lds
  buffer_load_dwordx4 v120, s[16:19], s36 offen offset:1024  lds
  s_add_u32 s35, s35, 1024
  s_add_u32 s36, s36, 1024
  s_waitcnt vmcnt(17)
  s_barrier
  s_add_u32 m0, s43, 12288
  s_nop 0
  buffer_load_dwordx4 v11, s[12:15], s32 offen lds
  s_add_u32 m0, s43, 16384
  s_nop 0
  buffer_load_dwordx4 v12, s[12:15], s32 offen lds
  s_add_u32 m0, s42, 8192
  s_nop 0
  buffer_load_dwordx4 v120, s[16:19], s35 offen  lds
  buffer_load_dwordx4 v120, s[16:19], s36 offen offset:1024  lds
  s_add_u32 s35, s35, 1024
  s_add_u32 s36, s36, 1024
  s_waitcnt vmcnt(17)
  s_barrier
  s_add_u32 m0, s43, 20480
  s_nop 0
  buffer_load_dwordx4 v13, s[12:15], s32 offen lds
  s_add_u32 m0, s43, 24576
  s_nop 0
  buffer_load_dwordx4 v14, s[12:15], s32 offen lds
  s_add_u32 m0, s42, 16384
  s_nop 0
  buffer_load_dwordx4 v120, s[16:19], s35 offen  lds
  buffer_load_dwordx4 v120, s[16:19], s36 offen offset:1024  lds
  s_add_u32 s35, s35, 1024
  s_add_u32 s36, s36, 1024
  s_add_u32 m0, s43, 28672
  s_nop 0
  buffer_load_dwordx4 v15, s[12:15], s32 offen lds
  s_add_u32 m0, s43, 32768
  s_nop 0
  buffer_load_dwordx4 v16, s[12:15], s32 offen lds
  s_add_u32 m0, s42, 24576
  s_nop 0
  buffer_load_dwordx4 v120, s[16:19], s35 offen  lds
  buffer_load_dwordx4 v120, s[16:19], s36 offen offset:1024  lds
  s_add_u32 s35, s35, 1024
  s_add_u32 s36, s36, 1024
  s_waitcnt vmcnt(21)
  s_barrier
  s_waitcnt vmcnt(17)
  s_barrier
  s_add_u32 m0, s43, 36864
  s_add_u32 s32, s32, 147456
  buffer_load_dwordx4 v8, s[12:15], s32 offen lds
  s_add_u32 m0, s43, 40960
  s_nop 0
  buffer_load_dwordx4 v9, s[12:15], s32 offen lds
  s_add_u32 m0, s43, 45056
  s_nop 0
  buffer_load_dwordx4 v10, s[12:15], s32 offen lds
  s_add_u32 m0, s42, 32768
  s_nop 0
  buffer_load_dwordx4 v120, s[16:19], s35 offen  lds
  buffer_load_dwordx4 v120, s[16:19], s36 offen offset:1024  lds
  s_add_u32 s35, s35, 1024
  s_add_u32 s36, s36, 1024
  s_waitcnt vmcnt(17)
  s_barrier
  s_add_u32 m0, s43, 49152
  s_nop 0
  buffer_load_dwordx4 v11, s[12:15], s32 offen lds
  s_add_u32 m0, s43, 53248
  s_nop 0
  buffer_load_dwordx4 v12, s[12:15], s32 offen lds
  s_add_u32 m0, s42, 40960
  s_nop 0
  buffer_load_dwordx4 v120, s[16:19], s35 offen  lds
  buffer_load_dwordx4 v120, s[16:19], s36 offen offset:1024  lds
  s_add_u32 s35, s35, 1024
  s_add_u32 s36, s36, 1024
  s_waitcnt vmcnt(17)
  s_barrier
  s_add_u32 m0, s43, 57344
  s_nop 0
  buffer_load_dwordx4 v13, s[12:15], s32 offen lds
  s_add_u32 m0, s43, 61440
  s_nop 0
  buffer_load_dwordx4 v14, s[12:15], s32 offen lds
  s_add_u32 m0, s42, 49152
  s_nop 0
  buffer_load_dwordx4 v120, s[16:19], s35 offen  lds
  buffer_load_dwordx4 v120, s[16:19], s36 offen offset:1024  lds
  s_add_u32 s35, s35, 1024
  s_add_u32 s36, s36, 1024
  s_add_u32 m0, s43, 65536
  s_nop 0
  buffer_load_dwordx4 v15, s[12:15], s32 offen lds
  s_add_u32 m0, s43, 69632
  s_nop 0
  buffer_load_dwordx4 v16, s[12:15], s32 offen lds
  s_add_u32 m0, s42, 57344
  s_nop 0
  buffer_load_dwordx4 v120, s[16:19], s35 offen  lds
  buffer_load_dwordx4 v120, s[16:19], s36 offen offset:1024  lds
  s_add_u32 s35, s35, 1024
  s_add_u32 s36, s36, 1024
  s_waitcnt vmcnt(21)
  s_barrier
  s_waitcnt vmcnt(17)
  s_barrier
  s_add_u32 m0, s43, 0
  s_add_u32 s32, s32, 147456
  buffer_load_dwordx4 v8, s[12:15], s32 offen lds
  s_add_u32 m0, s43, 4096
  s_nop 0
  buffer_load_dwordx4 v9, s[12:15], s32 offen lds
  s_add_u32 m0, s43, 8192
  s_nop 0
  buffer_load_dwordx4 v10, s[12:15], s32 offen lds
  s_add_u32 m0, s42, 0
  s_nop 0
  buffer_load_dwordx4 v120, s[16:19], s35 offen  lds
  buffer_load_dwordx4 v120, s[16:19], s36 offen offset:1024  lds
  s_add_u32 s35, s35, 1024
  s_add_u32 s36, s36, 1024
  s_waitcnt vmcnt(17)
  s_barrier
  s_add_u32 m0, s43, 12288
  s_nop 0
  buffer_load_dwordx4 v11, s[12:15], s32 offen lds
  s_add_u32 m0, s43, 16384
  s_nop 0
  buffer_load_dwordx4 v12, s[12:15], s32 offen lds
  s_add_u32 m0, s42, 8192
  s_nop 0
  buffer_load_dwordx4 v120, s[16:19], s35 offen  lds
  buffer_load_dwordx4 v120, s[16:19], s36 offen offset:1024  lds
  s_add_u32 s35, s35, 1024
  s_add_u32 s36, s36, 1024
  s_waitcnt vmcnt(17)
  s_barrier
  s_add_u32 m0, s43, 20480
  s_nop 0
  buffer_load_dwordx4 v13, s[12:15], s32 offen lds
  s_add_u32 m0, s43, 24576
  s_nop 0
  buffer_load_dwordx4 v14, s[12:15], s32 offen lds
  s_add_u32 m0, s42, 16384
  s_nop 0
  buffer_load_dwordx4 v120, s[16:19], s35 offen  lds
  buffer_load_dwordx4 v120, s[16:19], s36 offen offset:1024  lds
  s_add_u32 s35, s35, 1024
  s_add_u32 s36, s36, 1024
  s_add_u32 m0, s43, 28672
  s_nop 0
  buffer_load_dwordx4 v15, s[12:15], s32 offen lds
  s_add_u32 m0, s43, 32768
  s_nop 0
  buffer_load_dwordx4 v16, s[12:15], s32 offen lds
  s_add_u32 m0, s42, 24576
  s_nop 0
  buffer_load_dwordx4 v120, s[16:19], s35 offen  lds
  buffer_load_dwordx4 v120, s[16:19], s36 offen offset:1024  lds
  s_add_u32 s35, s35, 1024
  s_add_u32 s36, s36, 1024
  s_add_u32 s20, s4, 0xa00000
  s_addc_u32 s21, s5, 0
  s_mov_b32 s22, 0x240000
  s_mov_b32 s23, 0x20000
  s_lshr_b32 s38, s2, 3
  s_lshl_b32 s38, s38, 2
  s_add_u32 s38, s38, s31
  s_mul_i32 s38, s38, 18
  s_and_b32 s39, s2, 4
  s_mul_i32 s39, s39, 72
  s_add_u32 s39, s39, s28
  s_lshl_b32 s39, s39, 12
  v_add_u32 v4, s38, v1
  v_lshrrev_b32 v5, 5, v4
  v_and_b32 v4, 31, v4
  v_lshlrev_b32 v5, 14, v5
  v_lshl_add_u32 v4, v4, 7, v5
  s_mov_b64 exec, 0x3ffff
  buffer_load_dword v4, v4, s[20:23], s39 offen
  s_mov_b64 exec, -1
  s_waitcnt vmcnt(22)
  s_barrier
  s_waitcnt vmcnt(18)
  s_barrier
  s_waitcnt vmcnt(13)
  s_barrier
  s_waitcnt vmcnt(9)
  s_barrier
  s_waitcnt vmcnt(1)
  s_barrier
  v_and_b32 v0, 63, v0
  s_cmp_ge_u32 s2, 16
  s_cbranch_scc1 k5_down_kernel_cpf5
  s_getpc_b64 s[84:85]
k5_down_kernel_here6:
  s_add_u32 s84, s84, k6_fin_kernel-k5_down_kernel_here6
  s_addc_u32 s85, s85, 0
  s_mov_b32 s86, k6_fin_kernel_eoc-k6_fin_kernel
  s_mov_b32 s87, 0x20000
  v_lshlrev_b32 v2, 6, v0
  buffer_load_dword v3, v2, s[84:87], 0 offen
k5_down_kernel_cpf5:
k5_down_kernel_end1:
  s_endpgm
k5_down_kernel_eoc:
.globl k6_fin_kernel
.p2align 8
.type k6_fin_kernel,@function
k6_fin_kernel:
  s_load_dwordx2 s[4:5], s[0:1], 88
  s_load_dwordx2 s[6:7], s[0:1], 72
  s_cmp_ge_u32 s2, 576
  s_cbranch_scc1 k6_fin_kernel_end1
  v_lshlrev_b32 v1, 4, v0
  s_lshr_b32 s28, s2, 3
  s_lshl_b32 s28, s28, 2
  s_and_b32 s29, s2, 3
  s_add_u32 s28, s28, s29
  s_and_b32 s29, s2, 4
  s_mul_i32 s29, s29, 72
  s_add_u32 s2, s28, s29
  s_lshl_b32 s28, s2, 12
  s_mul_i32 s29, s2, 7282
  s_lshr_b32 s29, s29, 16
  s_mul_i32 s30, s29, 9
  s_sub_u32 s30, s2, s30
  v_lshrrev_b32 v2, 5, v0
  v_lshlrev_b32 v3, 5, v2
  v_bfe_u32 v4, v0, 4, 1
  v_and_b32 v5, 3, v0
  v_lshl_add_u32 v4, v4, 2, v5
  v_bfe_u32 v5, v0, 2, 2
  v_lshl_add_u32 v4, v4, 5, v5
  v_mul_u32_u24 v4, 1152, v4
  v_lshl_add_u32 v4, v2, 4, v4
  s_and_b32 s31, s29, 7
  s_lshl_b32 s31, s31, 8
  s_lshr_b32 s32, s29, 3
  s_lshl_b32 s32, s32, 2
  s_add_u32 s31, s31, s32
  s_mul_i32 s31, s31, 1152
  s_mul_i32 s32, s30, 128
  s_add_u32 s31, s31, s32
  s_mul_i32 s32, s30, 256
  s_add_u32 s32, s32, 28672
  s_waitcnt lgkmcnt(0)
  s_add_u32 s8, s4, 0x2400000
  s_addc_u32 s9, s5, 0
  s_mov_b32 s10, 0x900000
  s_mov_b32 s11, 0x20000
  s_add_u32 s16, s4, 0xa00000
  s_addc_u32 s17, s5, 0
  s_mov_b32 s18, 0x240000
  s_mov_b32 s19, 0x20000
  s_mov_b32 s12, s4
  s_mov_b32 s13, s5
  s_mov_b32 s14, 0x10000
  s_mov_b32 s15, 0x20000
  s_mov_b32 s20, s6
  s_mov_b32 s21, s7
  s_mov_b32 s22, 0x240000
  s_mov_b32 s23, 0x20000
  buffer_load_dwordx4 v[24:27], v1, s[16:19], s28 offen
  buffer_load_dwordx4 v[8:11], v1, s[8:11], s28 offen
  s_add_u32 s28, s28, 2359296
  buffer_load_dwordx4 v[12:15], v1, s[8:11], s28 offen
  s_add_u32 s28, s28, 2359296
  buffer_load_dwordx4 v[16:19], v1, s[8:11], s28 offen
  s_add_u32 s28, s28, 2359296
  buffer_load_dwordx4 v[20:23], v1, s[8:11], s28 offen
  buffer_load_dwordx4 v[28:31], v3, s[12:15], s32 offen
  buffer_load_dwordx4 v[32:35], v3, s[12:15], s32 offen offset:16
  s_waitcnt vmcnt(0)
  v_lshlrev_b32 v36, 16, v8
  v_and_b32 v37, 0xffff0000, v8
  v_lshlrev_b32 v38, 16, v12
  v_and_b32 v39, 0xffff0000, v12
  v_add_f32 v36, v36, v38
  v_add_f32 v37, v37, v39
  v_lshlrev_b32 v38, 16, v16
  v_and_b32 v39, 0xffff0000, v16
  v_add_f32 v36, v36, v38
  v_add_f32 v37, v37, v39
  v_lshlrev_b32 v38, 16, v20
  v_and_b32 v39, 0xffff0000, v20
  v_add_f32 v36, v36, v38
  v_add_f32 v37, v37, v39
  v_lshlrev_b32 v38, 16, v24
  v_and_b32 v39, 0xffff0000, v24
  v_fmac_f32 v38, v36, v28
  v_fmac_f32 v39, v37, v29
  v_cvt_pk_bf16_f32 v40, v38, v39
  v_lshlrev_b32 v36, 16, v9
  v_and_b32 v37, 0xffff0000, v9
  v_lshlrev_b32 v38, 16, v13
  v_and_b32 v39, 0xffff0000, v13
  v_add_f32 v36, v36, v38
  v_add_f32 v37, v37, v39
  v_lshlrev_b32 v38, 16, v17
  v_and_b32 v39, 0xffff0000, v17
  v_add_f32 v36, v36, v38
  v_add_f32 v37, v37, v39
  v_lshlrev_b32 v38, 16, v21
  v_and_b32 v39, 0xffff0000, v21
  v_add_f32 v36, v36, v38
  v_add_f32 v37, v37, v39
  v_lshlrev_b32 v38, 16, v25
  v_and_b32 v39, 0xffff0000, v25
  v_fmac_f32 v38, v36, v30
  v_fmac_f32 v39, v37, v31
  v_cvt_pk_bf16_f32 v41, v38, v39
  v_lshlrev_b32 v36, 16, v10
  v_and_b32 v37, 0xffff0000, v10
  v_lshlrev_b32 v38, 16, v14
  v_and_b32 v39, 0xffff0000, v14
  v_add_f32 v36, v36, v38
  v_add_f32 v37, v37, v39
  v_lshlrev_b32 v38, 16, v18
  v_and_b32 v39, 0xffff0000, v18
  v_add_f32 v36, v36, v38
  v_add_f32 v37, v37, v39
  v_lshlrev_b32 v38, 16, v22
  v_and_b32 v39, 0xffff0000, v22
  v_add_f32 v36, v36, v38
  v_add_f32 v37, v37, v39
  v_lshlrev_b32 v38, 16, v26
  v_and_b32 v39, 0xffff0000, v26
  v_fmac_f32 v38, v36, v32
  v_fmac_f32 v39, v37, v33
  v_cvt_pk_bf16_f32 v42, v38, v39
  v_lshlrev_b32 v36, 16, v11
  v_and_b32 v37, 0xffff0000, v11
  v_lshlrev_b32 v38, 16, v15
  v_and_b32 v39, 0xffff0000, v15
  v_add_f32 v36, v36, v38
  v_add_f32 v37, v37, v39
  v_lshlrev_b32 v38, 16, v19
  v_and_b32 v39, 0xffff0000, v19
  v_add_f32 v36, v36, v38
  v_add_f32 v37, v37, v39
  v_lshlrev_b32 v38, 16, v23
  v_and_b32 v39, 0xffff0000, v23
  v_add_f32 v36, v36, v38
  v_add_f32 v37, v37, v39
  v_lshlrev_b32 v38, 16, v27
  v_and_b32 v39, 0xffff0000, v27
  v_fmac_f32 v38, v36, v34
  v_fmac_f32 v39, v37, v35
  v_cvt_pk_bf16_f32 v43, v38, v39
  buffer_store_dwordx4 v[40:43], v4, s[20:23], s31 offen
k6_fin_kernel_end1:
  s_endpgm
k6_fin_kernel_eoc:
.section .rodata,"a"
.p2align 6
.amdhsa_kernel k0_prep_kernel
  .amdhsa_next_free_vgpr 76
  .amdhsa_next_free_sgpr 96
  .amdhsa_accum_offset 76
  .amdhsa_group_segment_fixed_size 0
  .amdhsa_kernarg_size 96
  .amdhsa_user_sgpr_count 2
  .amdhsa_user_sgpr_kernarg_segment_ptr 1
  .amdhsa_system_sgpr_workgroup_id_x 1
  .amdhsa_float_denorm_mode_32 3
.end_amdhsa_kernel
.p2align 6
.amdhsa_kernel k1_rdft_kernel
  .amdhsa_next_free_vgpr 116
  .amdhsa_next_free_sgpr 96
  .amdhsa_accum_offset 116
  .amdhsa_group_segment_fixed_size 0
  .amdhsa_kernarg_size 96
  .amdhsa_user_sgpr_count 2
  .amdhsa_user_sgpr_kernarg_segment_ptr 1
  .amdhsa_system_sgpr_workgroup_id_x 1
  .amdhsa_float_denorm_mode_32 3
.end_amdhsa_kernel
.p2align 6
.amdhsa_kernel k2_sfft_kernel
  .amdhsa_next_free_vgpr 172
  .amdhsa_next_free_sgpr 96
  .amdhsa_accum_offset 172
  .amdhsa_group_segment_fixed_size 0
  .amdhsa_kernarg_size 96
  .amdhsa_user_sgpr_count 2
  .amdhsa_user_sgpr_kernarg_segment_ptr 1
  .amdhsa_system_sgpr_workgroup_id_x 1
  .amdhsa_float_denorm_mode_32 3
.end_amdhsa_kernel
.p2align 6
.amdhsa_kernel k3_irdft_kernel
  .amdhsa_next_free_vgpr 128
  .amdhsa_next_free_sgpr 96
  .amdhsa_accum_offset 128
  .amdhsa_group_segment_fixed_size 0
  .amdhsa_kernarg_size 96
  .amdhsa_user_sgpr_count 2
  .amdhsa_user_sgpr_kernarg_segment_ptr 1
  .amdhsa_system_sgpr_workgroup_id_x 1
  .amdhsa_float_denorm_mode_32 3
.end_amdhsa_kernel
.p2align 6
.amdhsa_kernel k4_up_kernel
  .amdhsa_next_free_vgpr 512
  .amdhsa_next_free_sgpr 96
  .amdhsa_accum_offset 256
  .amdhsa_group_segment_fixed_size 0
  .amdhsa_kernarg_size 96
  .amdhsa_user_sgpr_count 2
  .amdhsa_user_sgpr_kernarg_segment_ptr 1
  .amdhsa_system_sgpr_workgroup_id_x 1
  .amdhsa_float_denorm_mode_32 3
.end_amdhsa_kernel
.p2align 6
.amdhsa_kernel k5_down_kernel
  .amdhsa_next_free_vgpr 136
  .amdhsa_next_free_sgpr 96
  .amdhsa_accum_offset 136
  .amdhsa_group_segment_fixed_size 0
  .amdhsa_kernarg_size 96
  .amdhsa_user_sgpr_count 2
  .amdhsa_user_sgpr_kernarg_segment_ptr 1
  .amdhsa_system_sgpr_workgroup_id_x 1
  .amdhsa_float_denorm_mode_32 3
.end_amdhsa_kernel
.p2align 6
.amdhsa_kernel k6_fin_kernel
  .amdhsa_next_free_vgpr 48
  .amdhsa_next_free_sgpr 96
  .amdhsa_accum_offset 48
  .amdhsa_group_segment_fixed_size 0
  .amdhsa_kernarg_size 96
  .amdhsa_user_sgpr_count 2
  .amdhsa_user_sgpr_kernarg_segment_ptr 1
  .amdhsa_system_sgpr_workgroup_id_x 1
  .amdhsa_float_denorm_mode_32 3
.end_amdhsa_kernel
```
